```python
import torch

def _softmax(x, axis=-1):
    return torch.softmax(x, dim=axis)

def _gelu(x):
    return torch.nn.functional.gelu(x, approximate='tanh')

def _silu(x):
    return torch.nn.functional.silu(x)

def _sigmoid(x):
    return torch.sigmoid(x)

def _layernorm(x, axis=-1, eps=1e-05):
    m = x.mean(dim=axis, keepdim=True)
    v = x.var(dim=axis, keepdim=True, unbiased=False)
    return (x - m) / torch.sqrt(v + eps)

def _scatter_add(tgt, idx, src, axis=0):
    return tgt.clone().index_add_(axis, idx, src)

def _segment_sum(src, seg, n):
    out = torch.zeros((n,) + src.shape[1:], dtype=src.dtype)
    return out.index_add_(0, seg, src)

def _pad(x, pw):
    flat = tuple((v for pair in reversed(pw) for v in pair))
    return torch.nn.functional.pad(x, flat)
kernel_name = 'adaLN_cond__grouped_kv_mqa__glu_gated_glu__prompt'

def setup_inputs():

    _w = lambda a: (lambda t: t.to(torch.bfloat16) if t.is_floating_point() else t)(torch.as_tensor(a))

    def _A_setup():
        B, S, D, H = (1, 2048, 512, 32)
        Dh = D // H
        return {'x': _w((lambda *s: torch.randn(*s, dtype=torch.bfloat16) * 0.05)(B, S, D)), 'wq': _w((lambda *s: torch.randn(*s, dtype=torch.bfloat16) * 0.05)(D, H * Dh)), 'wk': _w((lambda *s: torch.randn(*s, dtype=torch.bfloat16) * 0.05)(D, Dh)), 'wv': _w((lambda *s: torch.randn(*s, dtype=torch.bfloat16) * 0.05)(D, Dh)), 'wo': _w((lambda *s: torch.randn(*s, dtype=torch.bfloat16) * 0.05)(H * Dh, D))}
    _A_in = _A_setup()

    def _B_setup():
        B, S, D, F = (1, 2048, 512, 1792)
        return {'x': _w((lambda *s: torch.randn(*s, dtype=torch.bfloat16) * 0.05)(B, S, D)), 'w_gate': _w((lambda *s: torch.randn(*s, dtype=torch.bfloat16) * 0.05)(D, F)), 'w_up': _w((lambda *s: torch.randn(*s, dtype=torch.bfloat16) * 0.05)(D, F)), 'w_down': _w((lambda *s: torch.randn(*s, dtype=torch.bfloat16) * 0.05)(F, D))}
    _B_in = _B_setup()
    return {'A_x': _A_in['x'], 'A_wq': _A_in['wq'], 'A_wk': _A_in['wk'], 'A_wv': _A_in['wv'], 'A_wo': _A_in['wo'], 'B_x': _B_in['x'], 'B_w_gate': _B_in['w_gate'], 'B_w_up': _B_in['w_up'], 'B_w_down': _B_in['w_down'], 'c': _w((lambda *s: torch.randn(*s, dtype=torch.bfloat16) * 0.1)(1, 512) * 8.0), 'w_mod': _w((lambda *s: torch.randn(*s, dtype=torch.bfloat16) * 0.1)(512, 6 * 512) * 512 ** (-0.5) * 8.0)}

def reference(A_x, A_wq, A_wk, A_wv, A_wo, B_x, B_w_gate, B_w_up, B_w_down, c, w_mod):

    def _A_ref(x, wq, wk, wv, wo):
        B, S, D = x.shape
        H = 32
        Dh = D // H
        q = (lambda x, *d: x.permute(*d))((x @ wq).reshape(B, S, H, Dh), 0, 2, 1, 3)
        k = x @ wk
        v = x @ wv
        scores = torch.einsum('bhqd,bkd->bhqk', q, k) * Dh ** (-0.5)
        p = _softmax(scores, axis=-1)
        o = torch.einsum('bhqk,bkd->bhqd', p, v)
        return (lambda x, *d: x.permute(*d))(o, 0, 2, 1, 3).reshape(B, S, H * Dh) @ wo

    def _B_ref(x, w_gate, w_up, w_down):
        g = torch.einsum('bsd,df->bsf', x, w_gate)
        u = torch.einsum('bsd,df->bsf', x, w_up)
        h = _sigmoid(g) * u
        return torch.einsum('bsf,fd->bsd', h, w_down)
    x = A_x
    mod = (_silu(c) @ w_mod).reshape(c.shape[0], 6, 1, -1)
    sa, ca, ga, sb, cb, gb = (mod[:, 0].clone(), mod[:, 1].clone(), mod[:, 2].clone(), mod[:, 3].clone(), mod[:, 4].clone(), mod[:, 5].clone())
    h = _layernorm(x, axis=-1) * (1 + ca) + sa
    x = x + ga * _A_ref(h, A_wq, A_wk, A_wv, A_wo)
    h = _layernorm(x, axis=-1) * (1 + cb) + sb
    x = x + gb * _B_ref(h, B_w_gate, B_w_up, B_w_down)
    return x
```

```asm
; @launch grid=(256,1,1) block=(512,1,1) lds=163840
.amdgcn_target "amdgcn-amd-amdhsa--gfx950"
.text
.globl adaLN_cond__grouped_kv_mqa__glu_gated_glu__prompt_kernel
.p2align 12
.fill 832, 4, 0xbf800000
.p2align 8
.type adaLN_cond__grouped_kv_mqa__glu_gated_glu__prompt_kernel,@function
adaLN_cond__grouped_kv_mqa__glu_gated_glu__prompt_kernel:
    s_cmp_ge_u32 s2, 256
    s_cbranch_scc1 END
    s_load_dwordx16 s[64:79], s[0:1], 0
    s_load_dwordx8 s[80:87], s[0:1], 64
    s_load_dwordx4 s[88:91], s[0:1], 96
    s_lshr_b32 s4, s2, 3
    s_getpc_b64 s[60:61]
    s_lshl_b32 s62, s4, 6
    v_cmp_gt_u32 vcc, 19, v0
    v_lshl_add_u32 v254, v0, 11, s62
    s_mov_b64 exec, vcc
    global_load_dword v254, v254, s[60:61] offset:1024
    s_mov_b64 exec, -1
    v_lshrrev_b32 v2, 6, v0
    v_and_b32 v1, 63, v0
    s_and_b32 s3, s2, 7
    v_readfirstlane_b32 s5, v2
    v_lshlrev_b32 v6, 4, v1
    s_lshr_b32 s99, s4, 2
    s_lshl_b32 s35, s3, 3
    s_add_u32 s34, s99, s35
    s_lshl_b32 s36, s34, 15
    s_and_b32 s37, s4, 3
    s_add_u32 s33, s5, s37
    s_and_b32 s33, s33, 3
    s_lshl_b32 s35, s33, 12
    s_add_u32 s35, s35, s36
    s_lshr_b32 s32, s37, 1
    s_lshl_b32 s32, s32, 14
    s_add_u32 s35, s35, s32
    s_xor_b32 s32, s35, 16384
    s_cmp_lg_u32 s5, 0
    s_cbranch_scc1 L_W1
    v_lshrrev_b32 v221, 1, v1
    v_mul_u32_u24 v220, 24576, v221
    v_and_b32 v224, 1, v1
    v_lshl_add_u32 v220, v224, 4, v220
    v_lshlrev_b32 v221, 3, v221
    s_lshr_b32 s38, s4, 3
    s_mul_i32 s39, s38, 786432
    s_lshl_b32 s40, s3, 8
    s_and_b32 s41, s4, 7
    s_lshl_b32 s41, s41, 5
    s_add_u32 s40, s40, s41
    s_add_u32 s39, s39, s40
    s_lshl_b32 s41, s38, 8
    v_mov_b32 v216, 0xffbfffbf
    v_mov_b32 v217, v216
    v_mov_b32 v218, v216
    v_mov_b32 v219, v216
    s_lshl_b32 s42, s2, 9
    s_add_u32 s42, s42, 65536
    s_waitcnt lgkmcnt(0)
    s_mov_b32 s8, s90
    s_mov_b32 s9, s91
    s_mov_b32 s10, 16777216
    s_mov_b32 s11, 0x00020000
    s_mov_b32 exec_hi, 0
    buffer_store_dwordx4 v[216:219], v6, s[8:11], s42 offen sc1
    s_mov_b32 exec_hi, -1
    s_mov_b32 s16, s84
    s_mov_b32 s17, s85
    s_mov_b32 s18, 3145728
    s_mov_b32 s19, 0x00020000
    s_mov_b32 s12, s82
    s_mov_b32 s13, s83
    s_mov_b32 s14, 1024
    s_mov_b32 s15, 0x00020000
    buffer_load_dwordx2 v[222:223], v221, s[12:15], s41 offen
    buffer_load_dwordx4 v[176:179], v220, s[16:19], s39 offen nt
    s_add_u32 s39, s39, 6144
    buffer_load_dwordx4 v[180:183], v220, s[16:19], s39 offen nt
    s_add_u32 s39, s39, 6144
    buffer_load_dwordx4 v[184:187], v220, s[16:19], s39 offen nt
    s_add_u32 s39, s39, 6144
    buffer_load_dwordx4 v[188:191], v220, s[16:19], s39 offen nt
    s_mov_b32 s20, s64
    s_mov_b32 s21, s65
    s_mov_b32 s22, 2097152
    s_mov_b32 s23, 0x00020000
    buffer_load_dwordx4 v[16:19], v6, s[20:23], s35 offen offset:0 nt
    buffer_load_dwordx4 v[20:23], v6, s[20:23], s35 offen offset:1024 nt
    buffer_load_dwordx4 v[24:27], v6, s[20:23], s35 offen offset:2048 nt
    buffer_load_dwordx4 v[28:31], v6, s[20:23], s35 offen offset:3072 nt
    buffer_load_dwordx4 v[32:35], v6, s[20:23], s32 offen offset:0 nt
    buffer_load_dwordx4 v[36:39], v6, s[20:23], s32 offen offset:1024 nt
    buffer_load_dwordx4 v[40:43], v6, s[20:23], s32 offen offset:2048 nt
    buffer_load_dwordx4 v[44:47], v6, s[20:23], s32 offen offset:3072 nt
    s_lshl_b32 s38, s38, 12
    s_lshl_b32 s40, s40, 1
    s_add_u32 s38, s38, s40
    s_add_u32 s0, s38, 4096
    s_branch L_C0
L_W1:
    s_waitcnt lgkmcnt(0)
    s_cmp_lg_u32 s5, 2
    s_cbranch_scc1 L_C1
    s_mov_b32 s16, s72
    s_mov_b32 s17, s73
    s_mov_b32 s18, 524288
    s_mov_b32 s19, 0x00020000
    v_lshrrev_b32 v220, 2, v1
    v_lshlrev_b32 v220, 10, v220
    v_and_b32 v221, 3, v1
    v_lshl_add_u32 v220, v221, 4, v220
    s_lshr_b32 s38, s2, 4
    s_lshl_b32 s38, s38, 15
    s_and_b32 s39, s2, 15
    s_lshl_b32 s39, s39, 6
    s_add_u32 s38, s38, s39
    s_mov_b32 m0, 152576
    s_add_u32 s39, s38, 16384
    buffer_load_dwordx4 v220, s[16:19], s38 offen nt lds
    s_mov_b32 m0, 153600
    s_nop 0
    buffer_load_dwordx4 v220, s[16:19], s39 offen nt lds
L_C1:
L_C0:
    s_load_dword s6, s[90:91], 0
    s_lshr_b32 s42, s4, 1
    s_lshl_b32 s42, s42, 3
    s_add_u32 s42, s42, s5
    s_lshl_b32 s42, s42, 7
    s_bitcmp1_b32 s37, 0
    s_cselect_b32 s28, s70, s68
    s_cselect_b32 s29, s71, s69
    s_mov_b32 s30, 16384
    s_mov_b32 s31, 0x00020000
    s_add_u32 s62, s28, s42
    s_addc_u32 s63, s29, 0
    s_load_dwordx2 vcc, s[62:63], 60
    s_mov_b32 s58, 0x0c0c0400
    s_mov_b32 s59, 0x04000c0c
    s_mov_b32 s7, 200000
    s_movk_i32 s98, 0
    s_mov_b32 s8, s90
    s_mov_b32 s9, s91
    s_mov_b32 s10, 16777216
    s_mov_b32 s11, 0x00020000
    s_mov_b32 s20, s64
    s_mov_b32 s21, s65
    s_mov_b32 s22, 2097152
    s_mov_b32 s23, 0x00020000
    s_mov_b32 s60, 0x3f803f80
    s_mov_b32 s61, s60
    s_mov_b64 s[62:63], 0
    v_pk_mov_b32 v[52:53], s[62:63], s[62:63]
    s_mov_b32 exec_lo, 0x10001
    s_mov_b32 exec_hi, 0x10001
    v_pk_mov_b32 v[52:53], s[60:61], s[60:61]
    s_mov_b64 exec, -1
    v_pk_mov_b32 v[54:55], v[52:53], v[52:53]
    v_pk_mov_b32 v[60:61], v[52:53], v[52:53]
    v_pk_mov_b32 v[62:63], v[52:53], v[52:53]
    v_pk_mov_b32 v[240:241], s[62:63], s[62:63]
    v_pk_mov_b32 v[242:243], s[62:63], s[62:63]
    v_mov_b32 v13, 0xdddddddd
    s_lshl_b32 s60, s5, 11
    s_add_u32 s60, s60, 131072
    v_add_u32 v8, s60, v6
    s_lshl_b32 s60, s5, 10
    s_add_u32 s60, s60, 122880
    v_lshl_add_u32 v252, v1, 2, s60
    s_cmp_lt_u32 s5, 4
    s_cselect_b32 s62, 128, 0
    s_add_u32 s62, s62, 122880
    s_and_b32 s60, s5, 3
    s_lshl_b32 s61, s60, 9
    s_add_u32 s61, s61, 131072
    v_lshl_add_u32 v9, v1, 3, s61
    v_lshrrev_b32 v5, 1, v1
    v_lshl_add_u32 v253, v5, 2, s62
    v_and_b32 v5, 7, v5
    v_lshlrev_b32 v10, 4, v5
    v_lshrrev_b32 v5, 4, v1
    v_lshl_add_u32 v10, v5, 8, v10
    v_and_b32 v5, 1, v1
    v_lshl_add_u32 v10, v5, 2, v10
    s_lshr_b32 s61, s60, 1
    s_lshl_b32 s61, s61, 7
    s_and_b32 s60, s60, 1
    s_lshl_b32 s60, s60, 3
    s_add_u32 s60, s60, s61
    s_add_u32 s60, s60, 114944
    v_add_u32 v10, s60, v10
    v_and_b32 v5, 7, v1
    v_lshlrev_b32 v11, 4, v5
    v_lshrrev_b32 v5, 4, v1
    v_lshl_add_u32 v11, v5, 7, v11
    v_add_u32 v11, 114944, v11
    s_min_u32 s60, s5, 6
    s_lshl_b32 s54, s60, 10
    s_lshl_b32 s60, s60, 6
    v_add_u32 v4, s60, v1
    v_mul_u32_u24 v5, 9363, v4
    v_lshrrev_b32 v5, 16, v5
    v_mul_u32_u24 v14, 3472, v5
    v_lshl_add_u32 v14, v4, 4, v14
    s_mul_i32 s61, s4, 112
    v_add_u32 v14, s61, v14
    s_and_b32 s60, s4, 7
    s_mul_i32 s51, s60, 229376
    s_and_b32 s60, s4, 3
    s_lshl_b32 s60, s60, 12
    s_lshl_b32 s61, s5, 14
    s_add_u32 s61, s61, 65536
    s_add_u32 s40, s60, s61
    s_add_u32 s60, s60, 2048
    s_and_b32 s60, s60, 16383
    s_add_u32 s41, s60, s61
    s_add_u32 s60, s60, 2048
    s_and_b32 s60, s60, 16383
    s_add_u32 s42, s60, s61
    s_add_u32 s60, s60, 2048
    s_and_b32 s60, s60, 16383
    s_add_u32 s43, s60, s61
    s_add_u32 s60, s60, 2048
    s_and_b32 s60, s60, 16383
    s_add_u32 s44, s60, s61
    s_add_u32 s60, s60, 2048
    s_and_b32 s60, s60, 16383
    s_add_u32 s45, s60, s61
    s_add_u32 s60, s60, 2048
    s_and_b32 s60, s60, 16383
    s_add_u32 s46, s60, s61
    s_add_u32 s60, s60, 2048
    s_and_b32 s60, s60, 16383
    s_add_u32 s47, s60, s61
    s_lshl_b32 s55, s3, 5
    s_add_u32 s55, s55, s4
    s_lshl_b32 s55, s55, 13
    s_add_u32 s55, s55, 1048576
    s_and_b32 s56, s4, 3
    s_lshl_b32 s56, s56, 11
    s_lshl_b32 s57, s5, 12
    s_add_u32 s57, s57, 3145728
    v_mov_b32 v12, v14
    s_add_u32 s48, s55, s56
    v_lshrrev_b32 v2, 4, v1
    v_bfe_u32 v3, v1, 2, 2
    v_and_b32 v15, 3, v1
    s_cmp_lt_u32 s5, 4
    s_cbranch_scc1 L_LN
    v_xor_b32 v4, v3, v2
    v_lshlrev_b32 v244, 10, v2
    s_sub_u32 s33, s5, 4
    s_and_b32 s38, s33, 2
    v_lshl_add_u32 v244, v4, 6, v244
    v_xor_b32 v4, s38, v15
    v_lshl_add_u32 v244, v4, 4, v244
    s_lshl_b32 s38, s33, 12
    s_lshl_b32 s39, s37, 8
    s_add_u32 s38, s38, s39
    v_add_u32 v244, s38, v244
    s_lshl_b32 s38, s99, 16
    s_lshl_b32 s39, s33, 10
    s_add_u32 m0, s39, 17408
    s_mov_b32 s24, s66
    s_mov_b32 s25, s67
    s_mov_b32 s26, 524288
    s_mov_b32 s27, 0x00020000
    buffer_load_dwordx4 v244, s[24:27], s38 offen lds
    s_add_u32 m0, m0, 4096
    s_add_u32 s38, s38, 16384
    s_and_b32 s38, s38, 0x7ffff
    buffer_load_dwordx4 v244, s[24:27], s38 offen lds
    s_add_u32 m0, m0, 4096
    s_add_u32 s38, s38, 16384
    s_and_b32 s38, s38, 0x7ffff
    buffer_load_dwordx4 v244, s[24:27], s38 offen lds
    s_add_u32 m0, m0, 4096
    s_add_u32 s38, s38, 16384
    s_and_b32 s38, s38, 0x7ffff
    buffer_load_dwordx4 v244, s[24:27], s38 offen lds
    s_add_u32 m0, m0, 4096
    s_add_u32 s38, s38, 16384
    s_and_b32 s38, s38, 0x7ffff
    s_branch G_MAIN
L_LN:
    v_lshl_add_u32 v3, v2, 3, v3
    v_lshlrev_b32 v251, 6, v3
    v_lshl_add_u32 v251, v15, 4, v251
    v_add_u32 v251, 152576, v251
    v_lshlrev_b32 v244, 5, v1
    v_add_u32 v244, 148480, v244
    s_lshl_b32 s38, s99, 7
    v_subrev_u32 v245, s38, v6
    v_and_b32 v245, 1023, v245
    s_mul_i32 s38, s33, 4224
    v_add_u32 v245, s38, v245
    s_lshl_b32 s1, s3, 7
    s_add_u32 s1, s1, 40960
    s_lshl_b32 s94, s5, 10
    s_add_u32 s38, s94, 148480
    s_add_u32 s94, s94, 4096
    s_add_u32 s95, s94, 4096
    s_add_u32 s96, s94, 8192
    s_add_u32 s97, s94, 12288
    v_add_u32 v249, s38, v6
    v_lshrrev_b32 v4, 3, v1
    v_and_b32 v5, 7, v1
    v_mul_u32_u24 v250, 12288, v4
    v_lshl_add_u32 v250, v5, 4, v250
    v_lshlrev_b32 v247, 2, v4
    v_and_b32 v4, 16, v1
    v_lshl_add_u32 v248, v5, 5, v4
    v_and_b32 v2, 31, v1
    v_lshlrev_b32 v2, 2, v2
    s_lshr_b32 s39, s4, 3
    s_lshl_b32 s60, s3, 2
    s_add_u32 s33, s39, s60
    s_and_b32 s38, s4, 7
    s_lshl_b32 s38, s38, 2
    s_add_u32 s38, s38, s5
    s_lshl_b32 s75, s38, 5
    s_lshl_b32 s33, s33, 7
    s_mul_i32 s74, s38, 98304
    s_add_u32 s74, s74, s33
    s_lshl_b32 s38, s38, 12
    s_add_u32 s33, s33, s38
    s_lshl_b32 s33, s33, 1
    s_add_u32 s33, s33, 786432
    s_mov_b32 s12, s84
    s_mov_b32 s13, s85
    s_mov_b32 s14, 3145728
    s_mov_b32 s15, 0x00020000
    s_cmp_lg_u32 s5, 0
    s_cbranch_scc1 L_M1
    v_lshlrev_b32 v224, 5, v224
    v_and_b32 v225, 16, v1
    v_add_u32 v224, v224, v225
    s_setprio 3
    s_waitcnt vmcnt(12)
    v_lshlrev_b32 v192, 16, v222
    v_and_b32 v193, 0xffff0000, v222
    v_lshlrev_b32 v194, 16, v223
    v_and_b32 v195, 0xffff0000, v223
    v_mul_f32 v200, 0xbfb8aa3b, v192
    v_mul_f32 v201, 0xbfb8aa3b, v193
    v_mul_f32 v202, 0xbfb8aa3b, v194
    v_mul_f32 v203, 0xbfb8aa3b, v195
    v_exp_f32 v200, v200
    v_exp_f32 v201, v201
    v_exp_f32 v202, v202
    v_exp_f32 v203, v203
    v_add_f32 v200, 1.0, v200
    v_add_f32 v201, 1.0, v201
    v_add_f32 v202, 1.0, v202
    v_add_f32 v203, 1.0, v203
    v_rcp_f32 v200, v200
    v_rcp_f32 v201, v201
    v_rcp_f32 v202, v202
    v_rcp_f32 v203, v203
    v_mul_f32 v192, v192, v200
    v_mul_f32 v193, v193, v201
    v_mul_f32 v194, v194, v202
    v_mul_f32 v195, v195, v203
    v_cvt_pk_bf16_f32 v200, v192, v193
    v_cvt_pk_bf16_f32 v201, v194, v195
    v_lshlrev_b32 v192, 16, v200
    v_and_b32 v193, 0xffff0000, v200
    v_lshlrev_b32 v194, 16, v201
    v_and_b32 v195, 0xffff0000, v201
    s_waitcnt vmcnt(11)
    v_lshlrev_b32 v200, 16, v176
    v_and_b32 v201, 0xffff0000, v176
    v_lshlrev_b32 v202, 16, v177
    v_and_b32 v203, 0xffff0000, v177
    v_lshlrev_b32 v204, 16, v178
    v_and_b32 v205, 0xffff0000, v178
    v_lshlrev_b32 v206, 16, v179
    v_and_b32 v207, 0xffff0000, v179
    v_pk_mul_f32 v[208:209], v[200:201], v[192:193] op_sel:[0,0] op_sel_hi:[1,0]
    v_pk_mul_f32 v[210:211], v[202:203], v[192:193] op_sel:[0,0] op_sel_hi:[1,0]
    v_pk_mul_f32 v[212:213], v[204:205], v[192:193] op_sel:[0,0] op_sel_hi:[1,0]
    v_pk_mul_f32 v[214:215], v[206:207], v[192:193] op_sel:[0,0] op_sel_hi:[1,0]
    s_waitcnt vmcnt(10)
    v_lshlrev_b32 v200, 16, v180
    v_and_b32 v201, 0xffff0000, v180
    v_lshlrev_b32 v202, 16, v181
    v_and_b32 v203, 0xffff0000, v181
    v_lshlrev_b32 v204, 16, v182
    v_and_b32 v205, 0xffff0000, v182
    v_lshlrev_b32 v206, 16, v183
    v_and_b32 v207, 0xffff0000, v183
    v_pk_fma_f32 v[208:209], v[200:201], v[192:193], v[208:209] op_sel:[0,1,0] op_sel_hi:[1,1,1]
    v_pk_fma_f32 v[210:211], v[202:203], v[192:193], v[210:211] op_sel:[0,1,0] op_sel_hi:[1,1,1]
    v_pk_fma_f32 v[212:213], v[204:205], v[192:193], v[212:213] op_sel:[0,1,0] op_sel_hi:[1,1,1]
    v_pk_fma_f32 v[214:215], v[206:207], v[192:193], v[214:215] op_sel:[0,1,0] op_sel_hi:[1,1,1]
    s_waitcnt vmcnt(9)
    v_lshlrev_b32 v200, 16, v184
    v_and_b32 v201, 0xffff0000, v184
    v_lshlrev_b32 v202, 16, v185
    v_and_b32 v203, 0xffff0000, v185
    v_lshlrev_b32 v204, 16, v186
    v_and_b32 v205, 0xffff0000, v186
    v_lshlrev_b32 v206, 16, v187
    v_and_b32 v207, 0xffff0000, v187
    v_pk_fma_f32 v[208:209], v[200:201], v[194:195], v[208:209] op_sel:[0,0,0] op_sel_hi:[1,0,1]
    v_pk_fma_f32 v[210:211], v[202:203], v[194:195], v[210:211] op_sel:[0,0,0] op_sel_hi:[1,0,1]
    v_pk_fma_f32 v[212:213], v[204:205], v[194:195], v[212:213] op_sel:[0,0,0] op_sel_hi:[1,0,1]
    v_pk_fma_f32 v[214:215], v[206:207], v[194:195], v[214:215] op_sel:[0,0,0] op_sel_hi:[1,0,1]
    s_waitcnt vmcnt(8)
    v_lshlrev_b32 v200, 16, v188
    v_and_b32 v201, 0xffff0000, v188
    v_lshlrev_b32 v202, 16, v189
    v_and_b32 v203, 0xffff0000, v189
    v_lshlrev_b32 v204, 16, v190
    v_and_b32 v205, 0xffff0000, v190
    v_lshlrev_b32 v206, 16, v191
    v_and_b32 v207, 0xffff0000, v191
    v_pk_fma_f32 v[208:209], v[200:201], v[194:195], v[208:209] op_sel:[0,1,0] op_sel_hi:[1,1,1]
    v_pk_fma_f32 v[210:211], v[202:203], v[194:195], v[210:211] op_sel:[0,1,0] op_sel_hi:[1,1,1]
    v_pk_fma_f32 v[212:213], v[204:205], v[194:195], v[212:213] op_sel:[0,1,0] op_sel_hi:[1,1,1]
    v_pk_fma_f32 v[214:215], v[206:207], v[194:195], v[214:215] op_sel:[0,1,0] op_sel_hi:[1,1,1]
    v_permlane32_swap_b32 v208, v209
    v_permlane32_swap_b32 v210, v211
    v_permlane32_swap_b32 v212, v213
    v_permlane32_swap_b32 v214, v215
    v_add_f32 v208, v208, v209
    v_add_f32 v210, v210, v211
    v_add_f32 v212, v212, v213
    v_add_f32 v214, v214, v215
    v_permlane16_swap_b32 v208, v210
    s_nop 0
    v_permlane16_swap_b32 v212, v214
    v_add_f32 v208, v208, v210
    v_add_f32 v212, v212, v214
    s_nop 0
    v_add_f32_dpp v208, v208, v208 row_ror:8 row_mask:0xf bank_mask:0xf
    v_add_f32_dpp v212, v212, v212 row_ror:8 row_mask:0xf bank_mask:0xf
    s_nop 0
    v_add_f32_dpp v208, v208, v208 row_ror:4 row_mask:0xf bank_mask:0xf
    v_add_f32_dpp v212, v212, v212 row_ror:4 row_mask:0xf bank_mask:0xf
    s_nop 0
    v_add_f32_dpp v208, v208, v208 row_ror:2 row_mask:0xf bank_mask:0xf
    v_add_f32_dpp v212, v212, v212 row_ror:2 row_mask:0xf bank_mask:0xf
    s_waitcnt lgkmcnt(0)
    s_mul_i32 s6, s6, 0x9E3779B1
    s_add_u32 s6, s6, 0x7F4A7C15
    v_mov_b32 v225, s6
    v_permlane16_swap_b32 v208, v212
    v_mov_b32 v209, v208
    v_mov_b32 v213, v212
    s_nop 0
    v_permlane32_swap_b32 v208, v209
    v_permlane32_swap_b32 v212, v213
    s_mov_b32 s60, 0x7060500
    v_perm_b32 v216, v208, v225, s60
    s_mov_b32 s60, 0x7060501
    v_perm_b32 v217, v209, v225, s60
    s_mov_b32 s60, 0x7060502
    v_perm_b32 v218, v212, v225, s60
    s_mov_b32 s60, 0x7060503
    v_perm_b32 v219, v213, v225, s60
    s_mov_b64 exec, 0x30003
    s_waitcnt vmcnt(8)
    buffer_store_dwordx4 v[216:219], v224, s[8:11], s0 offen sc1
    s_mov_b64 exec, -1
    s_setprio 0
    s_branch L_X
L_M1:
    buffer_load_dwordx4 v[16:19], v6, s[20:23], s35 offen offset:0 nt
    buffer_load_dwordx4 v[20:23], v6, s[20:23], s35 offen offset:1024 nt
    buffer_load_dwordx4 v[24:27], v6, s[20:23], s35 offen offset:2048 nt
    buffer_load_dwordx4 v[28:31], v6, s[20:23], s35 offen offset:3072 nt
    buffer_load_dwordx4 v[32:35], v6, s[20:23], s32 offen offset:0 nt
    buffer_load_dwordx4 v[36:39], v6, s[20:23], s32 offen offset:1024 nt
    buffer_load_dwordx4 v[40:43], v6, s[20:23], s32 offen offset:2048 nt
    buffer_load_dwordx4 v[44:47], v6, s[20:23], s32 offen offset:3072 nt
L_M2:
    buffer_load_dword v254, off, s[8:11], s1
    s_waitcnt lgkmcnt(0)
    s_mul_i32 s6, s6, 0x9E3779B1
    s_add_u32 s6, s6, 0x7F4A7C15
L_X:
    s_barrier
    s_waitcnt vmcnt(8)
    v_lshlrev_b32 v112, 16, v16
    v_and_b32 v113, 0xffff0000, v16
    v_lshlrev_b32 v114, 16, v17
    v_and_b32 v115, 0xffff0000, v17
    v_lshlrev_b32 v116, 16, v18
    v_and_b32 v117, 0xffff0000, v18
    v_lshlrev_b32 v118, 16, v19
    v_and_b32 v119, 0xffff0000, v19
    v_pk_add_f32 v[192:193], v[112:113], v[114:115]
    v_pk_mul_f32 v[196:197], v[112:113], v[112:113]
    v_pk_add_f32 v[194:195], v[116:117], v[118:119]
    v_pk_fma_f32 v[196:197], v[114:115], v[114:115], v[196:197]
    v_pk_add_f32 v[192:193], v[192:193], v[194:195]
    v_pk_fma_f32 v[196:197], v[116:117], v[116:117], v[196:197]
    v_add_f32 v176, v192, v193
    v_pk_fma_f32 v[196:197], v[118:119], v[118:119], v[196:197]
    v_add_f32 v184, v196, v197
    s_waitcnt vmcnt(7)
    v_lshlrev_b32 v120, 16, v20
    v_and_b32 v121, 0xffff0000, v20
    v_lshlrev_b32 v122, 16, v21
    v_and_b32 v123, 0xffff0000, v21
    v_lshlrev_b32 v124, 16, v22
    v_and_b32 v125, 0xffff0000, v22
    v_lshlrev_b32 v126, 16, v23
    v_and_b32 v127, 0xffff0000, v23
    v_pk_add_f32 v[192:193], v[120:121], v[122:123]
    v_pk_mul_f32 v[196:197], v[120:121], v[120:121]
    v_pk_add_f32 v[194:195], v[124:125], v[126:127]
    v_pk_fma_f32 v[196:197], v[122:123], v[122:123], v[196:197]
    v_pk_add_f32 v[192:193], v[192:193], v[194:195]
    v_pk_fma_f32 v[196:197], v[124:125], v[124:125], v[196:197]
    v_add_f32 v177, v192, v193
    v_pk_fma_f32 v[196:197], v[126:127], v[126:127], v[196:197]
    v_add_f32 v185, v196, v197
    s_waitcnt vmcnt(6)
    v_lshlrev_b32 v128, 16, v24
    v_and_b32 v129, 0xffff0000, v24
    v_lshlrev_b32 v130, 16, v25
    v_and_b32 v131, 0xffff0000, v25
    v_lshlrev_b32 v132, 16, v26
    v_and_b32 v133, 0xffff0000, v26
    v_lshlrev_b32 v134, 16, v27
    v_and_b32 v135, 0xffff0000, v27
    v_pk_add_f32 v[192:193], v[128:129], v[130:131]
    v_pk_mul_f32 v[196:197], v[128:129], v[128:129]
    v_pk_add_f32 v[194:195], v[132:133], v[134:135]
    v_pk_fma_f32 v[196:197], v[130:131], v[130:131], v[196:197]
    v_pk_add_f32 v[192:193], v[192:193], v[194:195]
    v_pk_fma_f32 v[196:197], v[132:133], v[132:133], v[196:197]
    v_add_f32 v178, v192, v193
    v_pk_fma_f32 v[196:197], v[134:135], v[134:135], v[196:197]
    v_add_f32 v186, v196, v197
    s_waitcnt vmcnt(5)
    v_lshlrev_b32 v136, 16, v28
    v_and_b32 v137, 0xffff0000, v28
    v_lshlrev_b32 v138, 16, v29
    v_and_b32 v139, 0xffff0000, v29
    v_lshlrev_b32 v140, 16, v30
    v_and_b32 v141, 0xffff0000, v30
    v_lshlrev_b32 v142, 16, v31
    v_and_b32 v143, 0xffff0000, v31
    v_pk_add_f32 v[192:193], v[136:137], v[138:139]
    v_pk_mul_f32 v[196:197], v[136:137], v[136:137]
    v_pk_add_f32 v[194:195], v[140:141], v[142:143]
    v_pk_fma_f32 v[196:197], v[138:139], v[138:139], v[196:197]
    v_pk_add_f32 v[192:193], v[192:193], v[194:195]
    v_pk_fma_f32 v[196:197], v[140:141], v[140:141], v[196:197]
    v_add_f32 v179, v192, v193
    v_pk_fma_f32 v[196:197], v[142:143], v[142:143], v[196:197]
    v_add_f32 v187, v196, v197
    s_waitcnt vmcnt(4)
    v_lshlrev_b32 v144, 16, v32
    v_and_b32 v145, 0xffff0000, v32
    v_lshlrev_b32 v146, 16, v33
    v_and_b32 v147, 0xffff0000, v33
    v_lshlrev_b32 v148, 16, v34
    v_and_b32 v149, 0xffff0000, v34
    v_lshlrev_b32 v150, 16, v35
    v_and_b32 v151, 0xffff0000, v35
    v_pk_add_f32 v[192:193], v[144:145], v[146:147]
    v_pk_mul_f32 v[196:197], v[144:145], v[144:145]
    v_pk_add_f32 v[194:195], v[148:149], v[150:151]
    v_pk_fma_f32 v[196:197], v[146:147], v[146:147], v[196:197]
    v_pk_add_f32 v[192:193], v[192:193], v[194:195]
    v_pk_fma_f32 v[196:197], v[148:149], v[148:149], v[196:197]
    v_add_f32 v180, v192, v193
    v_pk_fma_f32 v[196:197], v[150:151], v[150:151], v[196:197]
    v_add_f32 v188, v196, v197
    s_waitcnt vmcnt(3)
    v_lshlrev_b32 v152, 16, v36
    v_and_b32 v153, 0xffff0000, v36
    v_lshlrev_b32 v154, 16, v37
    v_and_b32 v155, 0xffff0000, v37
    v_lshlrev_b32 v156, 16, v38
    v_and_b32 v157, 0xffff0000, v38
    v_lshlrev_b32 v158, 16, v39
    v_and_b32 v159, 0xffff0000, v39
    v_pk_add_f32 v[192:193], v[152:153], v[154:155]
    v_pk_mul_f32 v[196:197], v[152:153], v[152:153]
    v_pk_add_f32 v[194:195], v[156:157], v[158:159]
    v_pk_fma_f32 v[196:197], v[154:155], v[154:155], v[196:197]
    v_pk_add_f32 v[192:193], v[192:193], v[194:195]
    v_pk_fma_f32 v[196:197], v[156:157], v[156:157], v[196:197]
    v_add_f32 v181, v192, v193
    v_pk_fma_f32 v[196:197], v[158:159], v[158:159], v[196:197]
    v_add_f32 v189, v196, v197
    s_waitcnt vmcnt(2)
    v_lshlrev_b32 v160, 16, v40
    v_and_b32 v161, 0xffff0000, v40
    v_lshlrev_b32 v162, 16, v41
    v_and_b32 v163, 0xffff0000, v41
    v_lshlrev_b32 v164, 16, v42
    v_and_b32 v165, 0xffff0000, v42
    v_lshlrev_b32 v166, 16, v43
    v_and_b32 v167, 0xffff0000, v43
    v_pk_add_f32 v[192:193], v[160:161], v[162:163]
    v_pk_mul_f32 v[196:197], v[160:161], v[160:161]
    v_pk_add_f32 v[194:195], v[164:165], v[166:167]
    v_pk_fma_f32 v[196:197], v[162:163], v[162:163], v[196:197]
    v_pk_add_f32 v[192:193], v[192:193], v[194:195]
    v_pk_fma_f32 v[196:197], v[164:165], v[164:165], v[196:197]
    v_add_f32 v182, v192, v193
    v_pk_fma_f32 v[196:197], v[166:167], v[166:167], v[196:197]
    v_add_f32 v190, v196, v197
    s_waitcnt vmcnt(1)
    v_lshlrev_b32 v168, 16, v44
    v_and_b32 v169, 0xffff0000, v44
    v_lshlrev_b32 v170, 16, v45
    v_and_b32 v171, 0xffff0000, v45
    v_lshlrev_b32 v172, 16, v46
    v_and_b32 v173, 0xffff0000, v46
    v_lshlrev_b32 v174, 16, v47
    v_and_b32 v175, 0xffff0000, v47
    v_pk_add_f32 v[192:193], v[168:169], v[170:171]
    v_pk_mul_f32 v[196:197], v[168:169], v[168:169]
    v_pk_add_f32 v[194:195], v[172:173], v[174:175]
    v_pk_fma_f32 v[196:197], v[170:171], v[170:171], v[196:197]
    v_pk_add_f32 v[192:193], v[192:193], v[194:195]
    v_pk_fma_f32 v[196:197], v[172:173], v[172:173], v[196:197]
    v_add_f32 v183, v192, v193
    v_pk_fma_f32 v[196:197], v[174:175], v[174:175], v[196:197]
    v_add_f32 v191, v196, v197
    ds_read_b64_tr_b16 v[40:41], v251
    ds_read_b64_tr_b16 v[42:43], v251 offset:256
    ds_read_b64_tr_b16 v[44:45], v251 offset:8
    ds_read_b64_tr_b16 v[46:47], v251 offset:264
    v_permlane32_swap_b32 v176, v177
    v_permlane32_swap_b32 v178, v179
    v_permlane32_swap_b32 v180, v181
    v_permlane32_swap_b32 v182, v183
    v_permlane32_swap_b32 v184, v185
    v_permlane32_swap_b32 v186, v187
    v_permlane32_swap_b32 v188, v189
    v_permlane32_swap_b32 v190, v191
    v_add_f32 v176, v176, v177
    v_add_f32 v178, v178, v179
    v_add_f32 v180, v180, v181
    v_add_f32 v182, v182, v183
    v_add_f32 v184, v184, v185
    v_add_f32 v186, v186, v187
    v_add_f32 v188, v188, v189
    v_add_f32 v190, v190, v191
    v_permlane16_swap_b32 v176, v178
    v_permlane16_swap_b32 v180, v182
    v_permlane16_swap_b32 v184, v186
    v_permlane16_swap_b32 v188, v190
    v_add_f32 v176, v176, v178
    v_add_f32 v180, v180, v182
    v_add_f32 v184, v184, v186
    v_add_f32 v188, v188, v190
    v_add_f32_dpp v176, v176, v176 row_ror:8 row_mask:0xf bank_mask:0xf
    v_add_f32_dpp v180, v180, v180 row_ror:8 row_mask:0xf bank_mask:0xf
    v_add_f32_dpp v184, v184, v184 row_ror:8 row_mask:0xf bank_mask:0xf
    v_add_f32_dpp v188, v188, v188 row_ror:8 row_mask:0xf bank_mask:0xf
    v_add_f32_dpp v176, v176, v176 row_ror:4 row_mask:0xf bank_mask:0xf
    v_add_f32_dpp v180, v180, v180 row_ror:4 row_mask:0xf bank_mask:0xf
    v_add_f32_dpp v184, v184, v184 row_ror:4 row_mask:0xf bank_mask:0xf
    v_add_f32_dpp v188, v188, v188 row_ror:4 row_mask:0xf bank_mask:0xf
    v_add_f32_dpp v176, v176, v176 row_ror:2 row_mask:0xf bank_mask:0xf
    v_add_f32_dpp v180, v180, v180 row_ror:2 row_mask:0xf bank_mask:0xf
    v_add_f32_dpp v184, v184, v184 row_ror:2 row_mask:0xf bank_mask:0xf
    v_add_f32_dpp v188, v188, v188 row_ror:2 row_mask:0xf bank_mask:0xf
    v_add_f32_dpp v176, v176, v176 row_ror:1 row_mask:0xf bank_mask:0xf
    v_add_f32_dpp v180, v180, v180 row_ror:1 row_mask:0xf bank_mask:0xf
    v_add_f32_dpp v184, v184, v184 row_ror:1 row_mask:0xf bank_mask:0xf
    v_add_f32_dpp v188, v188, v188 row_ror:1 row_mask:0xf bank_mask:0xf
    v_mul_f32 v176, 0xbb000000, v176
    v_mul_f32 v184, 0x3b000000, v184
    v_fma_f32 v184, -v176, v176, v184
    v_max_f32 v184, 0, v184
    v_add_f32 v184, 0x3727c5ac, v184
    v_rsq_f32 v184, v184
    v_mul_f32 v180, 0xbb000000, v180
    v_mul_f32 v188, 0x3b000000, v188
    v_fma_f32 v188, -v180, v180, v188
    v_max_f32 v188, 0, v188
    v_add_f32 v188, 0x3727c5ac, v188
    v_rsq_f32 v188, v188
    v_mul_f32 v176, v176, v184
    v_mul_f32 v180, v180, v188
    v_readlane_b32 s16, v184, 0
    v_readlane_b32 s17, v176, 0
    v_readlane_b32 s18, v184, 32
    v_readlane_b32 s19, v176, 32
    v_readlane_b32 s20, v184, 16
    v_readlane_b32 s21, v176, 16
    v_readlane_b32 s22, v184, 48
    v_readlane_b32 s23, v176, 48
    v_readlane_b32 s24, v188, 0
    v_readlane_b32 s25, v180, 0
    v_readlane_b32 s26, v188, 32
    v_readlane_b32 s27, v180, 32
    v_readlane_b32 s28, v188, 16
    v_readlane_b32 s29, v180, 16
    v_readlane_b32 s30, v188, 48
    v_readlane_b32 s31, v180, 48
    s_waitcnt lgkmcnt(0)
    s_cmp_lg_u32 s5, 2
    s_cbranch_scc1 L_W5
    s_lshl_b32 s38, s2, 11
    s_add_u32 s38, s38, 3145728
    buffer_store_dwordx4 v[40:43], v6, s[8:11], s38 offen sc1
    buffer_store_dwordx4 v[44:47], v6, s[8:11], s38 offen offset:1024 sc1
L_W5:
    v_pk_fma_f32 v[112:113], v[112:113], s[16:17], s[16:17] op_sel:[0,0,1] op_sel_hi:[1,0,1]
    v_pk_fma_f32 v[114:115], v[114:115], s[16:17], s[16:17] op_sel:[0,0,1] op_sel_hi:[1,0,1]
    v_pk_fma_f32 v[116:117], v[116:117], s[16:17], s[16:17] op_sel:[0,0,1] op_sel_hi:[1,0,1]
    v_pk_fma_f32 v[118:119], v[118:119], s[16:17], s[16:17] op_sel:[0,0,1] op_sel_hi:[1,0,1]
    v_pk_fma_f32 v[120:121], v[120:121], s[18:19], s[18:19] op_sel:[0,0,1] op_sel_hi:[1,0,1]
    v_pk_fma_f32 v[122:123], v[122:123], s[18:19], s[18:19] op_sel:[0,0,1] op_sel_hi:[1,0,1]
    v_pk_fma_f32 v[124:125], v[124:125], s[18:19], s[18:19] op_sel:[0,0,1] op_sel_hi:[1,0,1]
    v_pk_fma_f32 v[126:127], v[126:127], s[18:19], s[18:19] op_sel:[0,0,1] op_sel_hi:[1,0,1]
    v_pk_fma_f32 v[128:129], v[128:129], s[20:21], s[20:21] op_sel:[0,0,1] op_sel_hi:[1,0,1]
    v_pk_fma_f32 v[130:131], v[130:131], s[20:21], s[20:21] op_sel:[0,0,1] op_sel_hi:[1,0,1]
    v_pk_fma_f32 v[132:133], v[132:133], s[20:21], s[20:21] op_sel:[0,0,1] op_sel_hi:[1,0,1]
    v_pk_fma_f32 v[134:135], v[134:135], s[20:21], s[20:21] op_sel:[0,0,1] op_sel_hi:[1,0,1]
    v_pk_fma_f32 v[136:137], v[136:137], s[22:23], s[22:23] op_sel:[0,0,1] op_sel_hi:[1,0,1]
    v_pk_fma_f32 v[138:139], v[138:139], s[22:23], s[22:23] op_sel:[0,0,1] op_sel_hi:[1,0,1]
    v_pk_fma_f32 v[140:141], v[140:141], s[22:23], s[22:23] op_sel:[0,0,1] op_sel_hi:[1,0,1]
    v_pk_fma_f32 v[142:143], v[142:143], s[22:23], s[22:23] op_sel:[0,0,1] op_sel_hi:[1,0,1]
    v_pk_fma_f32 v[144:145], v[144:145], s[24:25], s[24:25] op_sel:[0,0,1] op_sel_hi:[1,0,1]
    v_pk_fma_f32 v[146:147], v[146:147], s[24:25], s[24:25] op_sel:[0,0,1] op_sel_hi:[1,0,1]
    v_pk_fma_f32 v[148:149], v[148:149], s[24:25], s[24:25] op_sel:[0,0,1] op_sel_hi:[1,0,1]
    v_pk_fma_f32 v[150:151], v[150:151], s[24:25], s[24:25] op_sel:[0,0,1] op_sel_hi:[1,0,1]
    v_pk_fma_f32 v[152:153], v[152:153], s[26:27], s[26:27] op_sel:[0,0,1] op_sel_hi:[1,0,1]
    v_pk_fma_f32 v[154:155], v[154:155], s[26:27], s[26:27] op_sel:[0,0,1] op_sel_hi:[1,0,1]
    v_pk_fma_f32 v[156:157], v[156:157], s[26:27], s[26:27] op_sel:[0,0,1] op_sel_hi:[1,0,1]
    v_pk_fma_f32 v[158:159], v[158:159], s[26:27], s[26:27] op_sel:[0,0,1] op_sel_hi:[1,0,1]
    v_pk_fma_f32 v[160:161], v[160:161], s[28:29], s[28:29] op_sel:[0,0,1] op_sel_hi:[1,0,1]
    v_pk_fma_f32 v[162:163], v[162:163], s[28:29], s[28:29] op_sel:[0,0,1] op_sel_hi:[1,0,1]
    v_pk_fma_f32 v[164:165], v[164:165], s[28:29], s[28:29] op_sel:[0,0,1] op_sel_hi:[1,0,1]
    v_pk_fma_f32 v[166:167], v[166:167], s[28:29], s[28:29] op_sel:[0,0,1] op_sel_hi:[1,0,1]
    v_pk_fma_f32 v[168:169], v[168:169], s[30:31], s[30:31] op_sel:[0,0,1] op_sel_hi:[1,0,1]
    v_pk_fma_f32 v[170:171], v[170:171], s[30:31], s[30:31] op_sel:[0,0,1] op_sel_hi:[1,0,1]
    v_pk_fma_f32 v[172:173], v[172:173], s[30:31], s[30:31] op_sel:[0,0,1] op_sel_hi:[1,0,1]
    v_pk_fma_f32 v[174:175], v[174:175], s[30:31], s[30:31] op_sel:[0,0,1] op_sel_hi:[1,0,1]
    v_pk_mov_b32 v[68:69], v[52:53], v[52:53]
    v_pk_mov_b32 v[70:71], v[52:53], v[52:53]
    v_pk_mov_b32 v[76:77], v[52:53], v[52:53]
    v_pk_mov_b32 v[78:79], v[52:53], v[52:53]
    v_pk_mov_b32 v[84:85], v[52:53], v[52:53]
    v_pk_mov_b32 v[86:87], v[52:53], v[52:53]
    v_pk_mov_b32 v[92:93], v[52:53], v[52:53]
    v_pk_mov_b32 v[94:95], v[52:53], v[52:53]
    v_pk_mov_b32 v[100:101], v[52:53], v[52:53]
    v_pk_mov_b32 v[102:103], v[52:53], v[52:53]
    v_pk_mov_b32 v[108:109], v[52:53], v[52:53]
    v_pk_mov_b32 v[110:111], v[52:53], v[52:53]
    s_mov_b32 s16, s82
    s_mov_b32 s17, s83
    s_mov_b32 s18, 1024
    s_mov_b32 s19, 0x00020000
    buffer_load_dwordx4 v[16:19], v6, s[8:11], s94 offen sc1
    buffer_load_dwordx4 v[20:23], v6, s[8:11], s95 offen sc1
    buffer_load_dwordx4 v[24:27], v6, s[8:11], s96 offen sc1
    buffer_load_dwordx4 v[28:31], v6, s[8:11], s97 offen sc1
    s_setprio 2
    s_waitcnt vmcnt(0)
G_POLL:
    v_perm_b32 v32, v17, v16, s58
    v_perm_b32 v33, v19, v18, s59
    v_or_b32 v32, v32, v33
    v_cmp_ne_u32 vcc, s6, v32
    v_perm_b32 v32, v21, v20, s58
    v_perm_b32 v33, v23, v22, s59
    v_or_b32 v32, v32, v33
    v_cmp_ne_u32 s[62:63], s6, v32
    s_nop 0
    s_or_b64 vcc, vcc, s[62:63]
    v_perm_b32 v32, v25, v24, s58
    v_perm_b32 v33, v27, v26, s59
    v_or_b32 v32, v32, v33
    v_cmp_ne_u32 s[62:63], s6, v32
    s_nop 0
    s_or_b64 vcc, vcc, s[62:63]
    v_perm_b32 v32, v29, v28, s58
    v_perm_b32 v33, v31, v30, s59
    v_or_b32 v32, v32, v33
    v_cmp_ne_u32 s[62:63], s6, v32
    s_nop 0
    s_or_b64 vcc, vcc, s[62:63]
    s_cbranch_scc1 G_POLLR
G_POLLX:
    v_and_b32 v16, 0xffffff00, v16
    v_and_b32 v17, 0xffffff00, v17
    v_and_b32 v18, 0xffffff00, v18
    v_and_b32 v19, 0xffffff00, v19
    v_and_b32 v20, 0xffffff00, v20
    v_and_b32 v21, 0xffffff00, v21
    v_and_b32 v22, 0xffffff00, v22
    v_and_b32 v23, 0xffffff00, v23
    v_and_b32 v24, 0xffffff00, v24
    v_and_b32 v25, 0xffffff00, v25
    v_and_b32 v26, 0xffffff00, v26
    v_and_b32 v27, 0xffffff00, v27
    v_and_b32 v28, 0xffffff00, v28
    v_and_b32 v29, 0xffffff00, v29
    v_and_b32 v30, 0xffffff00, v30
    v_and_b32 v31, 0xffffff00, v31
    v_pk_add_f32 v[16:17], v[16:17], v[20:21]
    v_pk_add_f32 v[18:19], v[18:19], v[22:23]
    v_pk_add_f32 v[24:25], v[24:25], v[28:29]
    v_pk_add_f32 v[26:27], v[26:27], v[30:31]
    v_pk_add_f32 v[16:17], v[16:17], v[24:25]
    v_pk_add_f32 v[18:19], v[18:19], v[26:27]
    s_cmp_ge_u32 s5, 2
    s_cselect_b32 s38, 1.0, 0
    v_cvt_pk_bf16_f32 v17, v16, v17
    v_cvt_pk_bf16_f32 v19, v18, v19
    v_lshlrev_b32 v16, 16, v17
    v_and_b32 v17, 0xffff0000, v17
    v_lshlrev_b32 v18, 16, v19
    v_and_b32 v19, 0xffff0000, v19
    v_add_f32 v16, s38, v16
    v_add_f32 v17, s38, v17
    v_add_f32 v18, s38, v18
    v_add_f32 v19, s38, v19
    v_cvt_pk_bf16_f32 v17, v16, v17
    v_cvt_pk_bf16_f32 v19, v18, v19
    v_lshlrev_b32 v16, 16, v17
    v_and_b32 v17, 0xffff0000, v17
    v_lshlrev_b32 v18, 16, v19
    v_and_b32 v19, 0xffff0000, v19
    ds_write_b128 v249, v[16:19]
    s_waitcnt lgkmcnt(0)
    s_barrier
    ds_read_b128 v[16:19], v244
    ds_read_b128 v[24:27], v244 offset:2048
    ds_read_b128 v[20:23], v244 offset:16
    ds_read_b128 v[28:31], v244 offset:2064
    buffer_load_dword v232, v247, s[16:19], s75 offen
    buffer_load_dwordx4 v[200:203], v250, s[12:15], s74 offen offset:2048 nt
    s_add_u32 s74, s74, 6144
    buffer_load_dwordx4 v[204:207], v250, s[12:15], s74 offen offset:2048 nt
    s_waitcnt lgkmcnt(0)
    v_pk_fma_f32 v[112:113], v[112:113], v[24:25], v[16:17]
    v_pk_fma_f32 v[114:115], v[114:115], v[26:27], v[18:19]
    v_pk_fma_f32 v[116:117], v[116:117], v[28:29], v[20:21]
    v_pk_fma_f32 v[118:119], v[118:119], v[30:31], v[22:23]
    v_cvt_pk_bf16_f32 v112, v112, v113
    v_cvt_pk_bf16_f32 v113, v114, v115
    v_cvt_pk_bf16_f32 v114, v116, v117
    v_cvt_pk_bf16_f32 v115, v118, v119
    ds_write_b128 v245, v[112:115] offset:0
    v_pk_fma_f32 v[120:121], v[120:121], v[24:25], v[16:17]
    v_pk_fma_f32 v[122:123], v[122:123], v[26:27], v[18:19]
    v_pk_fma_f32 v[124:125], v[124:125], v[28:29], v[20:21]
    v_pk_fma_f32 v[126:127], v[126:127], v[30:31], v[22:23]
    v_cvt_pk_bf16_f32 v120, v120, v121
    v_cvt_pk_bf16_f32 v121, v122, v123
    v_cvt_pk_bf16_f32 v122, v124, v125
    v_cvt_pk_bf16_f32 v123, v126, v127
    ds_write_b128 v245, v[120:123] offset:1056
    v_pk_fma_f32 v[128:129], v[128:129], v[24:25], v[16:17]
    v_pk_fma_f32 v[130:131], v[130:131], v[26:27], v[18:19]
    v_pk_fma_f32 v[132:133], v[132:133], v[28:29], v[20:21]
    v_pk_fma_f32 v[134:135], v[134:135], v[30:31], v[22:23]
    v_cvt_pk_bf16_f32 v128, v128, v129
    v_cvt_pk_bf16_f32 v129, v130, v131
    v_cvt_pk_bf16_f32 v130, v132, v133
    v_cvt_pk_bf16_f32 v131, v134, v135
    ds_write_b128 v245, v[128:131] offset:2112
    v_pk_fma_f32 v[136:137], v[136:137], v[24:25], v[16:17]
    v_pk_fma_f32 v[138:139], v[138:139], v[26:27], v[18:19]
    v_pk_fma_f32 v[140:141], v[140:141], v[28:29], v[20:21]
    v_pk_fma_f32 v[142:143], v[142:143], v[30:31], v[22:23]
    v_cvt_pk_bf16_f32 v136, v136, v137
    v_cvt_pk_bf16_f32 v137, v138, v139
    v_cvt_pk_bf16_f32 v138, v140, v141
    v_cvt_pk_bf16_f32 v139, v142, v143
    ds_write_b128 v245, v[136:139] offset:3168
    s_waitcnt lgkmcnt(0)
    s_barrier
    s_setprio 0
    v_pk_fma_f32 v[144:145], v[144:145], v[24:25], v[16:17]
    v_pk_fma_f32 v[146:147], v[146:147], v[26:27], v[18:19]
    v_pk_fma_f32 v[148:149], v[148:149], v[28:29], v[20:21]
    v_pk_fma_f32 v[150:151], v[150:151], v[30:31], v[22:23]
    v_cvt_pk_bf16_f32 v144, v144, v145
    v_cvt_pk_bf16_f32 v145, v146, v147
    v_cvt_pk_bf16_f32 v146, v148, v149
    v_cvt_pk_bf16_f32 v147, v150, v151
    ds_write_b128 v245, v[144:147] offset:16896
    v_pk_fma_f32 v[152:153], v[152:153], v[24:25], v[16:17]
    v_pk_fma_f32 v[154:155], v[154:155], v[26:27], v[18:19]
    v_pk_fma_f32 v[156:157], v[156:157], v[28:29], v[20:21]
    v_pk_fma_f32 v[158:159], v[158:159], v[30:31], v[22:23]
    v_cvt_pk_bf16_f32 v152, v152, v153
    v_cvt_pk_bf16_f32 v153, v154, v155
    v_cvt_pk_bf16_f32 v154, v156, v157
    v_cvt_pk_bf16_f32 v155, v158, v159
    ds_write_b128 v245, v[152:155] offset:17952
    v_pk_fma_f32 v[160:161], v[160:161], v[24:25], v[16:17]
    v_pk_fma_f32 v[162:163], v[162:163], v[26:27], v[18:19]
    v_pk_fma_f32 v[164:165], v[164:165], v[28:29], v[20:21]
    v_pk_fma_f32 v[166:167], v[166:167], v[30:31], v[22:23]
    v_cvt_pk_bf16_f32 v160, v160, v161
    v_cvt_pk_bf16_f32 v161, v162, v163
    v_cvt_pk_bf16_f32 v162, v164, v165
    v_cvt_pk_bf16_f32 v163, v166, v167
    ds_write_b128 v245, v[160:163] offset:19008
    v_pk_fma_f32 v[168:169], v[168:169], v[24:25], v[16:17]
    v_pk_fma_f32 v[170:171], v[170:171], v[26:27], v[18:19]
    v_pk_fma_f32 v[172:173], v[172:173], v[28:29], v[20:21]
    v_pk_fma_f32 v[174:175], v[174:175], v[30:31], v[22:23]
    v_cvt_pk_bf16_f32 v168, v168, v169
    v_cvt_pk_bf16_f32 v169, v170, v171
    v_cvt_pk_bf16_f32 v170, v172, v173
    v_cvt_pk_bf16_f32 v171, v174, v175
    ds_write_b128 v245, v[168:171] offset:20064
    s_waitcnt lgkmcnt(0)
    s_setprio 2
    s_barrier
    buffer_load_dwordx4 v[16:19], v6, s[8:11], s40 offen sc1
    buffer_load_dwordx4 v[48:51], v6, s[8:11], s40 offen offset:1024 sc1
    buffer_load_dwordx4 v[20:23], v6, s[8:11], s41 offen sc1
    buffer_load_dwordx4 v[56:59], v6, s[8:11], s41 offen offset:1024 sc1
    buffer_load_dwordx4 v[24:27], v6, s[8:11], s42 offen sc1
    buffer_load_dwordx4 v[64:67], v6, s[8:11], s42 offen offset:1024 sc1
    buffer_load_dwordx4 v[28:31], v6, s[8:11], s43 offen sc1
    v_mov_b32 v112, 0xff800000
    s_lshl_b32 s60, s5, 11
    s_add_u32 s60, s60, 122880
    v_mov_b32 v113, v112
    v_add_u32 v116, s60, v6
    v_pk_mov_b32 v[114:115], v[112:113], v[112:113]
    v_mov_b32 v117, 117504
    ds_write_b128 v116, v[112:115]
    ds_write_b128 v116, v[112:115] offset:1024
    ds_write_b64 v117, v[240:241]
    s_waitcnt vmcnt(9)
    v_lshlrev_b32 v176, 16, v232
    v_and_b32 v177, 0xffff0000, v232
    v_mul_f32 v184, 0xbfb8aa3b, v176
    v_mul_f32 v185, 0xbfb8aa3b, v177
    v_exp_f32 v184, v184
    v_exp_f32 v185, v185
    v_add_f32 v184, 1.0, v184
    v_add_f32 v185, 1.0, v185
    v_rcp_f32 v184, v184
    v_rcp_f32 v185, v185
    v_mul_f32 v176, v176, v184
    v_mul_f32 v177, v177, v185
    v_cvt_pk_bf16_f32 v184, v176, v177
    v_lshlrev_b32 v176, 16, v184
    v_and_b32 v177, 0xffff0000, v184
    s_waitcnt vmcnt(8)
    v_lshlrev_b32 v184, 16, v200
    v_and_b32 v185, 0xffff0000, v200
    v_lshlrev_b32 v186, 16, v201
    v_and_b32 v187, 0xffff0000, v201
    v_lshlrev_b32 v188, 16, v202
    v_and_b32 v189, 0xffff0000, v202
    v_lshlrev_b32 v190, 16, v203
    v_and_b32 v191, 0xffff0000, v203
    v_pk_mul_f32 v[192:193], v[184:185], v[176:177] op_sel:[0,0] op_sel_hi:[1,0]
    v_pk_mul_f32 v[194:195], v[186:187], v[176:177] op_sel:[0,0] op_sel_hi:[1,0]
    v_pk_mul_f32 v[196:197], v[188:189], v[176:177] op_sel:[0,0] op_sel_hi:[1,0]
    v_pk_mul_f32 v[198:199], v[190:191], v[176:177] op_sel:[0,0] op_sel_hi:[1,0]
    s_waitcnt vmcnt(7)
    v_lshlrev_b32 v184, 16, v204
    v_and_b32 v185, 0xffff0000, v204
    v_lshlrev_b32 v186, 16, v205
    v_and_b32 v187, 0xffff0000, v205
    v_lshlrev_b32 v188, 16, v206
    v_and_b32 v189, 0xffff0000, v206
    v_lshlrev_b32 v190, 16, v207
    v_and_b32 v191, 0xffff0000, v207
    v_pk_fma_f32 v[192:193], v[184:185], v[176:177], v[192:193] op_sel:[0,1,0] op_sel_hi:[1,1,1]
    v_pk_fma_f32 v[194:195], v[186:187], v[176:177], v[194:195] op_sel:[0,1,0] op_sel_hi:[1,1,1]
    v_pk_fma_f32 v[196:197], v[188:189], v[176:177], v[196:197] op_sel:[0,1,0] op_sel_hi:[1,1,1]
    v_pk_fma_f32 v[198:199], v[190:191], v[176:177], v[198:199] op_sel:[0,1,0] op_sel_hi:[1,1,1]
    v_permlane32_swap_b32 v192, v193
    v_permlane32_swap_b32 v194, v195
    v_permlane32_swap_b32 v196, v197
    v_permlane32_swap_b32 v198, v199
    v_add_f32 v192, v192, v193
    v_add_f32 v194, v194, v195
    v_add_f32 v196, v196, v197
    v_add_f32 v198, v198, v199
    v_permlane16_swap_b32 v192, v194
    s_nop 0
    v_permlane16_swap_b32 v196, v198
    v_add_f32 v192, v192, v194
    v_add_f32 v196, v196, v198
    s_nop 0
    v_add_f32_dpp v192, v192, v192 row_ror:8 row_mask:0xf bank_mask:0xf
    v_add_f32_dpp v196, v196, v196 row_ror:8 row_mask:0xf bank_mask:0xf
    v_mov_b32 v251, s6
    s_nop 0
    v_permlane16_swap_b32 v192, v196
    v_mov_b32 v193, v192
    v_mov_b32 v197, v196
    s_nop 0
    v_permlane32_swap_b32 v192, v193
    v_permlane32_swap_b32 v196, v197
    s_mov_b32 s60, 0x7060500
    v_perm_b32 v236, v192, v251, s60
    s_mov_b32 s60, 0x7060501
    v_perm_b32 v237, v193, v251, s60
    s_mov_b32 s60, 0x7060502
    v_perm_b32 v238, v196, v251, s60
    s_mov_b32 s60, 0x7060503
    v_perm_b32 v239, v197, v251, s60
    s_mov_b64 exec, 0x00ff00ff
    buffer_store_dwordx4 v[236:239], v248, s[8:11], s33 offen sc1
    s_mov_b64 exec, -1
    s_waitcnt lgkmcnt(0)
    s_barrier
    s_branch P2_J
G_POLLR:
    s_sub_u32 s7, s7, 1
    s_cbranch_scc1 G_POLLE
    buffer_load_dwordx4 v[16:19], v6, s[8:11], s94 offen sc1
    buffer_load_dwordx4 v[20:23], v6, s[8:11], s95 offen sc1
    buffer_load_dwordx4 v[24:27], v6, s[8:11], s96 offen sc1
    buffer_load_dwordx4 v[28:31], v6, s[8:11], s97 offen sc1
    s_waitcnt vmcnt(0)
    s_branch G_POLL
G_POLLE:
    s_mov_b32 s7, 0
    s_branch G_POLLX
G_MAIN:
    v_lshl_add_u32 v5, v2, 3, v3
    v_lshlrev_b32 v245, 8, v5
    v_xor_b32 v4, s33, v3
    v_lshl_add_u32 v245, v4, 6, v245
    v_lshl_add_u32 v245, v15, 3, v245
    v_and_b32 v4, 1, v2
    v_lshl_add_u32 v245, v4, 5, v245
    v_add_u32 v245, 17408, v245
    v_add_u32 v246, 0x10000, v245
    v_xor_b32 v250, 32, v245
    v_xor_b32 v251, 32, v246
    v_lshlrev_b32 v20, 5, v5
    v_lshl_add_u32 v20, v15, 3, v20
    v_and_b32 v3, 15, v1
    v_mul_u32_u24 v247, 1056, v3
    v_lshl_add_u32 v247, v2, 4, v247
    s_lshr_b32 s60, s37, 1
    s_lshl_b32 s61, s60, 14
    s_lshl_b32 s74, s34, 11
    s_and_b32 s39, s37, 1
    s_lshl_b32 s94, s39, 3
    s_lshl_b32 s94, 0x00ff00ff, s94
    s_mov_b32 s95, s94
    s_lshl_b32 s39, s39, 2
    s_add_u32 s60, s60, s39
    s_add_u32 s60, s60, 256
    s_lshl_b32 s60, s60, 8
    s_add_u32 s74, s74, s60
    v_lshrrev_b32 v5, 1, v2
    v_lshlrev_b32 v5, 9, v5
    v_lshl_add_u32 v22, v3, 4, v5
    v_lshl_add_u32 v22, v4, 3, v22
    v_lshl_add_u32 v5, v4, 7, v5
    v_and_b32 v4, 7, v1
    v_lshl_add_u32 v5, v4, 4, v5
    v_lshrrev_b32 v3, 3, v3
    v_lshl_add_u32 v248, v3, 13, v5
    s_lshl_b32 s1, s3, 7
    s_add_u32 s1, s1, 40960
    s_lshl_b32 s75, s4, 2
    s_add_u32 s75, s75, s1
    v_and_b32 v2, 31, v1
    v_lshlrev_b32 v2, 2, v2
    s_lshr_b32 s39, s33, 1
    s_lshl_b32 s39, s39, 10
    s_and_b32 s35, s33, 1
    s_lshl_b32 s35, s35, 8
    s_add_u32 s39, s39, s35
    s_lshl_b32 s35, s37, 11
    s_add_u32 s35, s35, s39
    s_add_u32 s35, s35, s36
    s_add_u32 s35, s35, s61
    s_add_u32 s35, s35, 1048576
    s_xor_b32 s0, s35, 16384
    s_add_u32 s39, s39, 152576
    v_add_u32 v249, s39, v5
    s_lshl_b32 s32, s34, 7
    s_lshl_b32 s39, s37, 4
    s_add_u32 s32, s32, s39
    s_lshl_b32 s39, s33, 2
    s_add_u32 s32, s32, s39
    s_add_u32 s32, s32, 32768
    s_mov_b32 s96, 0x3eb8aa3b
    s_lshl_b32 s39, s2, 2
    s_add_u32 s39, s39, s33
    s_lshl_b32 s39, s39, 11
    s_add_u32 s39, s39, 6291456
    v_mov_b32 v44, 0xffbfffbf
    v_mov_b32 v45, v44
    v_mov_b32 v46, v44
    v_mov_b32 v47, v44
    s_waitcnt lgkmcnt(0)
    s_mul_i32 s6, s6, 0x9E3779B1
    s_add_u32 s6, s6, 0x7F4A7C15
    s_barrier
    s_mov_b32 s62, m0
    s_lshl_b32 s60, s99, 11
    s_cmp_lg_u32 s5, 5
    s_cbranch_scc1 G_NK
    s_mov_b32 m0, 0
    s_nop 0
    buffer_load_dwordx4 v6, s[28:31], s60 offen lds
    buffer_load_dwordx4 v6, s[28:31], s60 offen offset:1024 lds
    s_add_u32 m0, m0, 2048
    s_add_u32 s60, s60, 2048
    s_and_b32 s60, s60, 16383
    buffer_load_dwordx4 v6, s[28:31], s60 offen lds
    buffer_load_dwordx4 v6, s[28:31], s60 offen offset:1024 lds
    s_add_u32 m0, m0, 2048
    s_add_u32 s60, s60, 2048
    s_and_b32 s60, s60, 16383
    buffer_load_dwordx4 v6, s[28:31], s60 offen lds
    buffer_load_dwordx4 v6, s[28:31], s60 offen offset:1024 lds
    s_add_u32 m0, m0, 2048
    s_add_u32 s60, s60, 2048
    s_and_b32 s60, s60, 16383
    buffer_load_dwordx4 v6, s[28:31], s60 offen lds
    buffer_load_dwordx4 v6, s[28:31], s60 offen offset:1024 lds
    s_add_u32 m0, m0, 2048
    s_add_u32 s60, s60, 2048
    s_and_b32 s60, s60, 16383
    buffer_load_dwordx4 v6, s[28:31], s60 offen lds
    buffer_load_dwordx4 v6, s[28:31], s60 offen offset:1024 lds
    s_add_u32 m0, m0, 2048
    s_add_u32 s60, s60, 2048
    s_and_b32 s60, s60, 16383
    buffer_load_dwordx4 v6, s[28:31], s60 offen lds
    buffer_load_dwordx4 v6, s[28:31], s60 offen offset:1024 lds
    s_add_u32 m0, m0, 2048
    s_add_u32 s60, s60, 2048
    s_and_b32 s60, s60, 16383
    buffer_load_dwordx4 v6, s[28:31], s60 offen lds
    buffer_load_dwordx4 v6, s[28:31], s60 offen offset:1024 lds
    s_add_u32 m0, m0, 2048
    s_add_u32 s60, s60, 2048
    s_and_b32 s60, s60, 16383
    buffer_load_dwordx4 v6, s[28:31], s60 offen lds
    buffer_load_dwordx4 v6, s[28:31], s60 offen offset:1024 lds
    s_mov_b32 m0, s62
G_NK:
    s_nop 0
    buffer_load_dwordx4 v244, s[24:27], s38 offen lds
    s_add_u32 m0, m0, 4096
    s_add_u32 s38, s38, 16384
    s_and_b32 s38, s38, 0x7ffff
    buffer_load_dwordx4 v244, s[24:27], s38 offen lds
    s_add_u32 m0, m0, 4096
    s_add_u32 s38, s38, 16384
    s_and_b32 s38, s38, 0x7ffff
    buffer_load_dwordx4 v244, s[24:27], s38 offen lds
    s_add_u32 m0, m0, 4096
    s_add_u32 s38, s38, 16384
    s_and_b32 s38, s38, 0x7ffff
    buffer_load_dwordx4 v244, s[24:27], s38 offen lds
    s_add_u32 m0, m0, 4096
    s_add_u32 s38, s38, 16384
    s_and_b32 s38, s38, 0x7ffff
    buffer_load_dwordx4 v244, s[24:27], s38 offen lds
    s_add_u32 m0, m0, 4096
    s_add_u32 s38, s38, 16384
    s_and_b32 s38, s38, 0x7ffff
    buffer_load_dwordx4 v244, s[24:27], s38 offen lds
    s_add_u32 m0, m0, 4096
    s_add_u32 s38, s38, 16384
    s_and_b32 s38, s38, 0x7ffff
    buffer_load_dwordx4 v244, s[24:27], s38 offen lds
    s_add_u32 m0, m0, 4096
    s_add_u32 s38, s38, 16384
    s_and_b32 s38, s38, 0x7ffff
    buffer_load_dwordx4 v244, s[24:27], s38 offen lds
    s_add_u32 m0, m0, 4096
    s_add_u32 s38, s38, 16384
    s_and_b32 s38, s38, 0x7ffff
    s_waitcnt vmcnt(7)
    s_waitcnt vmcnt(7)
    v_mov_b32 v23, s6
    s_cmp_lg_u32 s5, 5
    s_cbranch_scc1 G_NW
    ds_read_b64_tr_b16 v[128:129], v20 offset:0
    ds_read_b64_tr_b16 v[130:131], v20 offset:128
    ds_read_b64_tr_b16 v[132:133], v20 offset:1024
    ds_read_b64_tr_b16 v[134:135], v20 offset:1152
    ds_read_b64_tr_b16 v[136:137], v20 offset:2048
    ds_read_b64_tr_b16 v[138:139], v20 offset:2176
    ds_read_b64_tr_b16 v[140:141], v20 offset:3072
    ds_read_b64_tr_b16 v[142:143], v20 offset:3200
    ds_read_b64_tr_b16 v[144:145], v20 offset:4096
    ds_read_b64_tr_b16 v[146:147], v20 offset:4224
    ds_read_b64_tr_b16 v[148:149], v20 offset:5120
    ds_read_b64_tr_b16 v[150:151], v20 offset:5248
    ds_read_b64_tr_b16 v[152:153], v20 offset:6144
    ds_read_b64_tr_b16 v[154:155], v20 offset:6272
    ds_read_b64_tr_b16 v[156:157], v20 offset:7168
    ds_read_b64_tr_b16 v[158:159], v20 offset:7296
    ds_read_b64_tr_b16 v[160:161], v20 offset:8192
    ds_read_b64_tr_b16 v[162:163], v20 offset:8320
    ds_read_b64_tr_b16 v[164:165], v20 offset:9216
    ds_read_b64_tr_b16 v[166:167], v20 offset:9344
    ds_read_b64_tr_b16 v[168:169], v20 offset:10240
    ds_read_b64_tr_b16 v[170:171], v20 offset:10368
    ds_read_b64_tr_b16 v[172:173], v20 offset:11264
    ds_read_b64_tr_b16 v[174:175], v20 offset:11392
    ds_read_b64_tr_b16 v[176:177], v20 offset:12288
    ds_read_b64_tr_b16 v[178:179], v20 offset:12416
    ds_read_b64_tr_b16 v[180:181], v20 offset:13312
    ds_read_b64_tr_b16 v[182:183], v20 offset:13440
    ds_read_b64_tr_b16 v[184:185], v20 offset:14336
    ds_read_b64_tr_b16 v[186:187], v20 offset:14464
    ds_read_b64_tr_b16 v[188:189], v20 offset:15360
    ds_read_b64_tr_b16 v[190:191], v20 offset:15488
G_NW:
    buffer_load_dwordx4 v244, s[24:27], s38 offen lds
    s_add_u32 m0, m0, 4096
    s_add_u32 s38, s38, 16384
    s_and_b32 s38, s38, 0x7ffff
    s_waitcnt vmcnt(7)
    buffer_load_dwordx4 v244, s[24:27], s38 offen lds
    s_add_u32 m0, m0, 4096
    s_add_u32 s38, s38, 16384
    s_and_b32 s38, s38, 0x7ffff
    s_waitcnt vmcnt(7)
    buffer_load_dwordx4 v244, s[24:27], s38 offen lds
    s_add_u32 m0, m0, 4096
    s_add_u32 s38, s38, 16384
    s_and_b32 s38, s38, 0x7ffff
    s_waitcnt vmcnt(7)
    buffer_load_dwordx4 v244, s[24:27], s38 offen lds
    s_add_u32 m0, m0, 4096
    s_add_u32 s38, s38, 16384
    s_and_b32 s38, s38, 0x7ffff
    s_waitcnt vmcnt(7)
    buffer_load_dwordx4 v244, s[24:27], s38 offen lds
    s_add_u32 m0, m0, 4096
    s_add_u32 s38, s38, 16384
    s_and_b32 s38, s38, 0x7ffff
    s_waitcnt vmcnt(7)
    buffer_load_dwordx4 v244, s[24:27], s38 offen lds
    s_add_u32 m0, m0, 4096
    s_add_u32 s38, s38, 16384
    s_and_b32 s38, s38, 0x7ffff
    s_waitcnt vmcnt(7)
    buffer_load_dwordx4 v244, s[24:27], s38 offen lds
    s_add_u32 m0, m0, 4096
    s_add_u32 s38, s38, 16384
    s_and_b32 s38, s38, 0x7ffff
    s_waitcnt vmcnt(7)
    buffer_load_dwordx4 v244, s[24:27], s38 offen lds
    s_add_u32 m0, m0, 4096
    s_add_u32 s38, s38, 16384
    s_and_b32 s38, s38, 0x7ffff
    s_waitcnt vmcnt(7)
    buffer_load_dwordx4 v244, s[24:27], s38 offen lds
    s_add_u32 m0, m0, 4096
    s_add_u32 s38, s38, 16384
    s_and_b32 s38, s38, 0x7ffff
    s_waitcnt vmcnt(7)
    buffer_load_dwordx4 v244, s[24:27], s38 offen lds
    s_add_u32 m0, m0, 4096
    s_add_u32 s38, s38, 16384
    s_and_b32 s38, s38, 0x7ffff
    s_waitcnt vmcnt(7)
    buffer_load_dwordx4 v244, s[24:27], s38 offen lds
    s_add_u32 m0, m0, 4096
    s_add_u32 s38, s38, 16384
    s_and_b32 s38, s38, 0x7ffff
    s_waitcnt vmcnt(7)
    buffer_load_dwordx4 v244, s[24:27], s38 offen lds
    s_add_u32 m0, m0, 4096
    s_add_u32 s38, s38, 16384
    s_and_b32 s38, s38, 0x7ffff
    s_waitcnt vmcnt(7)
    buffer_load_dwordx4 v244, s[24:27], s38 offen lds
    s_add_u32 m0, m0, 4096
    s_add_u32 s38, s38, 16384
    s_and_b32 s38, s38, 0x7ffff
    s_waitcnt vmcnt(7)
    buffer_load_dwordx4 v244, s[24:27], s38 offen lds
    s_add_u32 m0, m0, 4096
    s_add_u32 s38, s38, 16384
    s_and_b32 s38, s38, 0x7ffff
    s_waitcnt vmcnt(7)
    buffer_load_dwordx4 v244, s[24:27], s38 offen lds
    s_add_u32 m0, m0, 4096
    s_add_u32 s38, s38, 16384
    s_and_b32 s38, s38, 0x7ffff
    s_waitcnt vmcnt(7)
    buffer_load_dwordx4 v244, s[24:27], s38 offen lds
    s_add_u32 m0, m0, 4096
    s_add_u32 s38, s38, 16384
    s_and_b32 s38, s38, 0x7ffff
    s_waitcnt vmcnt(7)
    buffer_load_dwordx4 v244, s[24:27], s38 offen lds
    s_add_u32 m0, m0, 4096
    s_add_u32 s38, s38, 16384
    s_and_b32 s38, s38, 0x7ffff
    s_waitcnt vmcnt(7)
    buffer_load_dwordx4 v244, s[24:27], s38 offen lds
    s_add_u32 m0, m0, 4096
    s_add_u32 s38, s38, 16384
    s_and_b32 s38, s38, 0x7ffff
    s_waitcnt vmcnt(7)
    buffer_load_dwordx4 v244, s[24:27], s38 offen lds
    s_add_u32 m0, m0, 4096
    s_add_u32 s38, s38, 16384
    s_and_b32 s38, s38, 0x7ffff
    s_waitcnt vmcnt(7)
    buffer_load_dwordx4 v244, s[24:27], s38 offen lds
    buffer_store_dwordx4 v[44:47], v6, s[8:11], s39 offen offset:0 sc1
    buffer_store_dwordx4 v[44:47], v6, s[8:11], s39 offen offset:1024 sc1
    s_waitcnt vmcnt(18)
    s_waitcnt lgkmcnt(0)
    s_barrier
G_N6:
    ds_read_b64_tr_b16 v[64:65], v245 offset:0
    ds_read_b64_tr_b16 v[66:67], v245 offset:1024
    ds_read_b64_tr_b16 v[68:69], v250 offset:0
    ds_read_b64_tr_b16 v[70:71], v250 offset:1024
    ds_read_b64_tr_b16 v[72:73], v245 offset:8192
    ds_read_b64_tr_b16 v[74:75], v245 offset:9216
    ds_read_b64_tr_b16 v[76:77], v250 offset:8192
    ds_read_b64_tr_b16 v[78:79], v250 offset:9216
    ds_read_b64_tr_b16 v[80:81], v245 offset:16384
    ds_read_b64_tr_b16 v[82:83], v245 offset:17408
    ds_read_b64_tr_b16 v[84:85], v250 offset:16384
    ds_read_b64_tr_b16 v[86:87], v250 offset:17408
    ds_read_b64_tr_b16 v[88:89], v245 offset:24576
    ds_read_b64_tr_b16 v[90:91], v245 offset:25600
    ds_read_b64_tr_b16 v[92:93], v250 offset:24576
    ds_read_b64_tr_b16 v[94:95], v250 offset:25600
    ds_read_b64_tr_b16 v[96:97], v245 offset:32768
    ds_read_b64_tr_b16 v[98:99], v245 offset:33792
    ds_read_b64_tr_b16 v[100:101], v250 offset:32768
    ds_read_b64_tr_b16 v[102:103], v250 offset:33792
    ds_read_b64_tr_b16 v[104:105], v245 offset:40960
    ds_read_b64_tr_b16 v[106:107], v245 offset:41984
    ds_read_b64_tr_b16 v[108:109], v250 offset:40960
    ds_read_b64_tr_b16 v[110:111], v250 offset:41984
    ds_read_b64_tr_b16 v[112:113], v245 offset:49152
    ds_read_b64_tr_b16 v[114:115], v245 offset:50176
    ds_read_b64_tr_b16 v[116:117], v250 offset:49152
    ds_read_b64_tr_b16 v[118:119], v250 offset:50176
    ds_read_b64_tr_b16 v[120:121], v245 offset:57344
    ds_read_b64_tr_b16 v[122:123], v245 offset:58368
    ds_read_b64_tr_b16 v[124:125], v250 offset:57344
    ds_read_b64_tr_b16 v[126:127], v250 offset:58368
    s_waitcnt vmcnt(2)
    s_cmp_lg_u32 s5, 5
    s_waitcnt lgkmcnt(0)
    s_barrier
    s_cbranch_scc1 G_N1
    s_setprio 3
    ds_read_b128 v[208:211], v247 offset:512
    ds_read_b128 v[212:215], v247 offset:576
    ds_read_b128 v[216:219], v247 offset:640
    ds_read_b128 v[220:223], v247 offset:704
    ds_read_b128 v[224:227], v247 offset:768
    ds_read_b128 v[228:231], v247 offset:832
    s_mov_b64 exec, 1
    buffer_store_dword v23, off, s[8:11], s75
    s_mov_b64 exec, -1
    s_bitcmp1_b32 s37, 0
    s_cbranch_scc1 L_V
    s_waitcnt lgkmcnt(5)
    v_mfma_f32_16x16x32_bf16 v[32:35], v[160:163], v[208:211], 0
    ds_read_b128 v[232:235], v247 offset:896
    s_waitcnt lgkmcnt(5)
    v_mfma_f32_16x16x32_bf16 v[32:35], v[164:167], v[212:215], v[32:35]
    ds_read_b128 v[236:239], v247 offset:960
    s_waitcnt lgkmcnt(5)
    v_mfma_f32_16x16x32_bf16 v[32:35], v[168:171], v[216:219], v[32:35]
    ds_read_b128 v[208:211], v247 offset:0
    s_waitcnt lgkmcnt(5)
    v_mfma_f32_16x16x32_bf16 v[32:35], v[172:175], v[220:223], v[32:35]
    ds_read_b128 v[212:215], v247 offset:64
    s_waitcnt lgkmcnt(5)
    v_mfma_f32_16x16x32_bf16 v[32:35], v[176:179], v[224:227], v[32:35]
    ds_read_b128 v[216:219], v247 offset:128
    s_waitcnt lgkmcnt(5)
    v_mfma_f32_16x16x32_bf16 v[32:35], v[180:183], v[228:231], v[32:35]
    ds_read_b128 v[220:223], v247 offset:192
    s_waitcnt lgkmcnt(5)
    v_mfma_f32_16x16x32_bf16 v[32:35], v[184:187], v[232:235], v[32:35]
    ds_read_b128 v[224:227], v247 offset:256
    s_waitcnt lgkmcnt(5)
    v_mfma_f32_16x16x32_bf16 v[32:35], v[188:191], v[236:239], v[32:35]
    ds_read_b128 v[228:231], v247 offset:320
    s_waitcnt lgkmcnt(5)
    v_mfma_f32_16x16x32_bf16 v[32:35], v[128:131], v[208:211], v[32:35]
    ds_read_b128 v[232:235], v247 offset:384
    s_waitcnt lgkmcnt(5)
    v_mfma_f32_16x16x32_bf16 v[32:35], v[132:135], v[212:215], v[32:35]
    ds_read_b128 v[236:239], v247 offset:448
    s_waitcnt lgkmcnt(5)
    v_mfma_f32_16x16x32_bf16 v[32:35], v[136:139], v[216:219], v[32:35]
    s_waitcnt lgkmcnt(4)
    v_mfma_f32_16x16x32_bf16 v[32:35], v[140:143], v[220:223], v[32:35]
    s_waitcnt lgkmcnt(3)
    v_mfma_f32_16x16x32_bf16 v[32:35], v[144:147], v[224:227], v[32:35]
    s_waitcnt lgkmcnt(2)
    v_mfma_f32_16x16x32_bf16 v[32:35], v[148:151], v[228:231], v[32:35]
    s_waitcnt lgkmcnt(1)
    v_mfma_f32_16x16x32_bf16 v[32:35], v[152:155], v[232:235], v[32:35]
    s_waitcnt lgkmcnt(0)
    v_mfma_f32_16x16x32_bf16 v[32:35], v[156:159], v[236:239], v[32:35]
    s_branch L_KVS
L_V:
    s_waitcnt lgkmcnt(5)
    v_mfma_f32_16x16x32_bf16 v[32:35], v[208:211], v[160:163], 0
    ds_read_b128 v[232:235], v247 offset:896
    s_waitcnt lgkmcnt(5)
    v_mfma_f32_16x16x32_bf16 v[32:35], v[212:215], v[164:167], v[32:35]
    ds_read_b128 v[236:239], v247 offset:960
    s_waitcnt lgkmcnt(5)
    v_mfma_f32_16x16x32_bf16 v[32:35], v[216:219], v[168:171], v[32:35]
    ds_read_b128 v[208:211], v247 offset:0
    s_waitcnt lgkmcnt(5)
    v_mfma_f32_16x16x32_bf16 v[32:35], v[220:223], v[172:175], v[32:35]
    ds_read_b128 v[212:215], v247 offset:64
    s_waitcnt lgkmcnt(5)
    v_mfma_f32_16x16x32_bf16 v[32:35], v[224:227], v[176:179], v[32:35]
    ds_read_b128 v[216:219], v247 offset:128
    s_waitcnt lgkmcnt(5)
    v_mfma_f32_16x16x32_bf16 v[32:35], v[228:231], v[180:183], v[32:35]
    ds_read_b128 v[220:223], v247 offset:192
    s_waitcnt lgkmcnt(5)
    v_mfma_f32_16x16x32_bf16 v[32:35], v[232:235], v[184:187], v[32:35]
    ds_read_b128 v[224:227], v247 offset:256
    s_waitcnt lgkmcnt(5)
    v_mfma_f32_16x16x32_bf16 v[32:35], v[236:239], v[188:191], v[32:35]
    ds_read_b128 v[228:231], v247 offset:320
    s_waitcnt lgkmcnt(5)
    v_mfma_f32_16x16x32_bf16 v[32:35], v[208:211], v[128:131], v[32:35]
    ds_read_b128 v[232:235], v247 offset:384
    s_waitcnt lgkmcnt(5)
    v_mfma_f32_16x16x32_bf16 v[32:35], v[212:215], v[132:135], v[32:35]
    ds_read_b128 v[236:239], v247 offset:448
    s_waitcnt lgkmcnt(5)
    v_mfma_f32_16x16x32_bf16 v[32:35], v[216:219], v[136:139], v[32:35]
    s_waitcnt lgkmcnt(4)
    v_mfma_f32_16x16x32_bf16 v[32:35], v[220:223], v[140:143], v[32:35]
    s_waitcnt lgkmcnt(3)
    v_mfma_f32_16x16x32_bf16 v[32:35], v[224:227], v[144:147], v[32:35]
    s_waitcnt lgkmcnt(2)
    v_mfma_f32_16x16x32_bf16 v[32:35], v[228:231], v[148:151], v[32:35]
    s_waitcnt lgkmcnt(1)
    v_mfma_f32_16x16x32_bf16 v[32:35], v[232:235], v[152:155], v[32:35]
    s_waitcnt lgkmcnt(0)
    v_mfma_f32_16x16x32_bf16 v[32:35], v[236:239], v[156:159], v[32:35]
L_KVS:
    buffer_load_dword v3, v2, s[8:11], s1 offen sc1
    s_nop 5
    s_nop 0
    v_cvt_pk_bf16_f32 v36, v32, v33
    v_cvt_pk_bf16_f32 v37, v34, v35
    buffer_store_dwordx2 v[36:37], v22, s[8:11], s74 offen sc1
    s_setprio 0
    s_branch G_N2
G_HW:
    s_mov_b32 s61, 24
HW_1:
    buffer_load_dword v3, v2, s[8:11], s1 offen sc1
    s_sub_u32 s61, s61, 1
    s_waitcnt vmcnt(0)
    v_cmp_ne_u32 vcc, s6, v3
    s_cbranch_scc1 HW_1_X
    s_cbranch_vccnz HW_1
HW_1_X:
    s_cmp_eq_u32 s5, 5
    s_branch G_HR
G_N1:
    ds_read_b128 v[208:211], v247 offset:0
    ds_read_b128 v[212:215], v247 offset:64
    ds_read_b128 v[216:219], v247 offset:128
    ds_read_b128 v[220:223], v247 offset:192
    ds_read_b128 v[224:227], v247 offset:256
    ds_read_b128 v[228:231], v247 offset:320
G_N2:
    s_cmp_eq_u32 s5, 5
    s_waitcnt lgkmcnt(5)
    v_mfma_f32_16x16x32_bf16 v[192:195], v[64:67], v[208:211], 0
    ds_read_b64_tr_b16 v[160:161], v246 offset:32768
    ds_read_b64_tr_b16 v[162:163], v246 offset:33792
    v_mfma_f32_16x16x32_bf16 v[196:199], v[68:71], v[208:211], 0
    ds_read_b64_tr_b16 v[164:165], v251 offset:32768
    ds_read_b64_tr_b16 v[166:167], v251 offset:33792
    ds_read_b128 v[232:235], v247 offset:384
    s_waitcnt lgkmcnt(9)
    v_mfma_f32_16x16x32_bf16 v[192:195], v[72:75], v[212:215], v[192:195]
    ds_read_b64_tr_b16 v[168:169], v246 offset:40960
    ds_read_b64_tr_b16 v[170:171], v246 offset:41984
    v_mfma_f32_16x16x32_bf16 v[196:199], v[76:79], v[212:215], v[196:199]
    ds_read_b64_tr_b16 v[172:173], v251 offset:40960
    ds_read_b64_tr_b16 v[174:175], v251 offset:41984
    ds_read_b128 v[236:239], v247 offset:448
    s_waitcnt lgkmcnt(13)
    v_mfma_f32_16x16x32_bf16 v[192:195], v[80:83], v[216:219], v[192:195]
    ds_read_b64_tr_b16 v[128:129], v246 offset:0
    ds_read_b64_tr_b16 v[130:131], v246 offset:1024
    v_mfma_f32_16x16x32_bf16 v[196:199], v[84:87], v[216:219], v[196:199]
    ds_read_b64_tr_b16 v[132:133], v251 offset:0
    ds_read_b64_tr_b16 v[134:135], v251 offset:1024
    ds_read_b128 v[208:211], v247 offset:512
    s_waitcnt lgkmcnt(15)
    v_mfma_f32_16x16x32_bf16 v[192:195], v[88:91], v[220:223], v[192:195]
    ds_read_b64_tr_b16 v[136:137], v246 offset:8192
    ds_read_b64_tr_b16 v[138:139], v246 offset:9216
    v_mfma_f32_16x16x32_bf16 v[196:199], v[92:95], v[220:223], v[196:199]
    ds_read_b64_tr_b16 v[140:141], v251 offset:8192
    ds_read_b64_tr_b16 v[142:143], v251 offset:9216
    ds_read_b128 v[212:215], v247 offset:576
    s_waitcnt lgkmcnt(15)
    v_mfma_f32_16x16x32_bf16 v[192:195], v[96:99], v[224:227], v[192:195]
    ds_read_b64_tr_b16 v[144:145], v246 offset:16384
    ds_read_b64_tr_b16 v[146:147], v246 offset:17408
    v_mfma_f32_16x16x32_bf16 v[196:199], v[100:103], v[224:227], v[196:199]
    ds_read_b64_tr_b16 v[148:149], v251 offset:16384
    ds_read_b64_tr_b16 v[150:151], v251 offset:17408
    ds_read_b128 v[216:219], v247 offset:640
    s_waitcnt lgkmcnt(15)
    v_mfma_f32_16x16x32_bf16 v[192:195], v[104:107], v[228:231], v[192:195]
    ds_read_b64_tr_b16 v[152:153], v246 offset:24576
    ds_read_b64_tr_b16 v[154:155], v246 offset:25600
    v_mfma_f32_16x16x32_bf16 v[196:199], v[108:111], v[228:231], v[196:199]
    ds_read_b64_tr_b16 v[156:157], v251 offset:24576
    ds_read_b64_tr_b16 v[158:159], v251 offset:25600
    ds_read_b128 v[220:223], v247 offset:704
    s_waitcnt lgkmcnt(15)
    s_cbranch_scc0 CF_2
    s_waitcnt vmcnt(1)
    v_cmp_ne_u32 vcc, s6, v3
    s_cbranch_vccnz G_HW
G_HR:
    s_setprio 0
    s_barrier
CF_2:
    s_waitcnt lgkmcnt(15)
    v_mfma_f32_16x16x32_bf16 v[192:195], v[112:115], v[232:235], v[192:195]
    ds_read_b64_tr_b16 v[176:177], v246 offset:49152
    ds_read_b64_tr_b16 v[178:179], v246 offset:50176
    v_mfma_f32_16x16x32_bf16 v[196:199], v[116:119], v[232:235], v[196:199]
    ds_read_b64_tr_b16 v[180:181], v251 offset:49152
    ds_read_b64_tr_b16 v[182:183], v251 offset:50176
    ds_read_b128 v[224:227], v247 offset:768
    s_waitcnt lgkmcnt(15)
    v_mfma_f32_16x16x32_bf16 v[192:195], v[120:123], v[236:239], v[192:195]
    ds_read_b64_tr_b16 v[184:185], v246 offset:57344
    ds_read_b64_tr_b16 v[186:187], v246 offset:58368
    v_mfma_f32_16x16x32_bf16 v[196:199], v[124:127], v[236:239], v[196:199]
    ds_read_b64_tr_b16 v[188:189], v251 offset:57344
    ds_read_b64_tr_b16 v[190:191], v251 offset:58368
    ds_read_b128 v[228:231], v247 offset:832
    s_waitcnt lgkmcnt(15)
    v_mfma_f32_16x16x32_bf16 v[192:195], v[128:131], v[208:211], v[192:195]
    v_mfma_f32_16x16x32_bf16 v[196:199], v[132:135], v[208:211], v[196:199]
    s_cbranch_scc0 CF_3
    buffer_load_dwordx4 v[16:19], v6, s[8:11], s40 offen sc1
CF_3:
    ds_read_b128 v[232:235], v247 offset:896
    s_waitcnt lgkmcnt(15)
    v_mfma_f32_16x16x32_bf16 v[192:195], v[136:139], v[212:215], v[192:195]
    v_mfma_f32_16x16x32_bf16 v[196:199], v[140:143], v[212:215], v[196:199]
    s_cbranch_scc0 CF_4
    buffer_load_dwordx4 v[48:51], v6, s[8:11], s40 offen offset:1024 sc1
CF_4:
    ds_read_b128 v[236:239], v247 offset:960
    s_cbranch_scc1 CF_5
    s_setprio 0
    s_barrier
CF_5:
    s_waitcnt lgkmcnt(15)
    v_mfma_f32_16x16x32_bf16 v[192:195], v[144:147], v[216:219], v[192:195]
    v_mfma_f32_16x16x32_bf16 v[196:199], v[148:151], v[216:219], v[196:199]
    s_cbranch_scc0 CF_6
    buffer_load_dwordx4 v[20:23], v6, s[8:11], s41 offen sc1
CF_6:
    ds_read_b128 v[208:211], v247 offset:16896
    s_waitcnt lgkmcnt(13)
    v_mfma_f32_16x16x32_bf16 v[192:195], v[152:155], v[220:223], v[192:195]
    s_waitcnt lgkmcnt(13)
    v_mfma_f32_16x16x32_bf16 v[196:199], v[156:159], v[220:223], v[196:199]
    s_cbranch_scc0 CF_7
    buffer_load_dwordx4 v[56:59], v6, s[8:11], s41 offen offset:1024 sc1
CF_7:
    ds_read_b128 v[212:215], v247 offset:16960
    s_waitcnt lgkmcnt(9)
    v_mfma_f32_16x16x32_bf16 v[192:195], v[160:163], v[224:227], v[192:195]
    v_mfma_f32_16x16x32_bf16 v[196:199], v[164:167], v[224:227], v[196:199]
    s_cbranch_scc1 CF_8
    buffer_load_dwordx4 v[16:19], v6, s[8:11], s40 offen sc1
CF_8:
    s_cbranch_scc0 CF_9
    buffer_load_dwordx4 v[24:27], v6, s[8:11], s42 offen sc1
CF_9:
    ds_read_b128 v[216:219], v247 offset:17024
    s_waitcnt lgkmcnt(5)
    v_mfma_f32_16x16x32_bf16 v[192:195], v[168:171], v[228:231], v[192:195]
    v_mfma_f32_16x16x32_bf16 v[196:199], v[172:175], v[228:231], v[196:199]
    s_cbranch_scc1 CF_10
    buffer_load_dwordx4 v[48:51], v6, s[8:11], s40 offen offset:1024 sc1
CF_10:
    ds_read_b128 v[220:223], v247 offset:17088
    s_waitcnt lgkmcnt(5)
    v_mfma_f32_16x16x32_bf16 v[192:195], v[176:179], v[232:235], v[192:195]
    s_waitcnt lgkmcnt(5)
    v_mfma_f32_16x16x32_bf16 v[196:199], v[180:183], v[232:235], v[196:199]
    s_cbranch_scc1 CF_11
    buffer_load_dwordx4 v[20:23], v6, s[8:11], s41 offen sc1
CF_11:
    ds_read_b128 v[224:227], v247 offset:17152
    s_waitcnt lgkmcnt(5)
    v_mfma_f32_16x16x32_bf16 v[192:195], v[184:187], v[236:239], v[192:195]
    s_waitcnt lgkmcnt(5)
    v_mfma_f32_16x16x32_bf16 v[196:199], v[188:191], v[236:239], v[196:199]
    s_cbranch_scc1 CF_12
    buffer_load_dwordx4 v[56:59], v6, s[8:11], s41 offen offset:1024 sc1
CF_12:
    ds_read_b128 v[228:231], v247 offset:17216
    s_waitcnt lgkmcnt(5)
    v_mfma_f32_16x16x32_bf16 v[200:203], v[64:67], v[208:211], 0
    v_mfma_f32_16x16x32_bf16 v[204:207], v[68:71], v[208:211], 0
    s_cbranch_scc1 CF_13
    buffer_load_dwordx4 v[24:27], v6, s[8:11], s42 offen sc1
CF_13:
    ds_read_b128 v[232:235], v247 offset:17280
    s_waitcnt lgkmcnt(5)
    v_mfma_f32_16x16x32_bf16 v[200:203], v[72:75], v[212:215], v[200:203]
    v_mul_f32 v192, s96, v192
    v_mul_f32 v193, s96, v193
    v_mfma_f32_16x16x32_bf16 v[204:207], v[76:79], v[212:215], v[204:207]
    v_mul_f32 v194, s96, v194
    v_mul_f32 v195, s96, v195
    buffer_load_dwordx4 v[64:67], v6, s[8:11], s42 offen offset:1024 sc1
    ds_read_b128 v[236:239], v247 offset:17344
    s_waitcnt lgkmcnt(5)
    v_mfma_f32_16x16x32_bf16 v[200:203], v[80:83], v[216:219], v[200:203]
    v_mul_f32 v196, s96, v196
    v_mul_f32 v197, s96, v197
    v_mfma_f32_16x16x32_bf16 v[204:207], v[84:87], v[216:219], v[204:207]
    v_mul_f32 v198, s96, v198
    v_mul_f32 v199, s96, v199
    buffer_load_dwordx4 v[28:31], v6, s[8:11], s43 offen sc1
    ds_read_b128 v[208:211], v247 offset:17408
    s_waitcnt lgkmcnt(5)
    v_mfma_f32_16x16x32_bf16 v[200:203], v[88:91], v[220:223], v[200:203]
    v_cvt_pk_bf16_f32 v192, v192, v193
    v_cvt_pk_bf16_f32 v193, v194, v195
    v_mfma_f32_16x16x32_bf16 v[204:207], v[92:95], v[220:223], v[204:207]
    v_cvt_pk_bf16_f32 v194, v196, v197
    v_cvt_pk_bf16_f32 v195, v198, v199
    ds_read_b128 v[212:215], v247 offset:17472
    s_waitcnt lgkmcnt(5)
    v_mfma_f32_16x16x32_bf16 v[200:203], v[96:99], v[224:227], v[200:203]
    v_permlane16_swap_b32 v192, v194
    v_permlane16_swap_b32 v193, v195
    v_mfma_f32_16x16x32_bf16 v[204:207], v[100:103], v[224:227], v[204:207]
    s_mov_b64 exec, s[94:95]
    ds_write_b128 v249, v[192:195]
    s_mov_b64 exec, -1
    ds_read_b128 v[216:219], v247 offset:17536
    s_cbranch_scc0 CF_14
    s_waitcnt lgkmcnt(0)
    s_setprio 3
    s_barrier
CF_14:
    s_waitcnt lgkmcnt(6)
    v_mfma_f32_16x16x32_bf16 v[200:203], v[104:107], v[228:231], v[200:203]
    v_mfma_f32_16x16x32_bf16 v[204:207], v[108:111], v[228:231], v[204:207]
    ds_read_b128 v[220:223], v247 offset:17600
    s_waitcnt lgkmcnt(6)
    v_mfma_f32_16x16x32_bf16 v[200:203], v[112:115], v[232:235], v[200:203]
    v_mfma_f32_16x16x32_bf16 v[204:207], v[116:119], v[232:235], v[204:207]
    ds_read_b128 v[224:227], v247 offset:17664
    s_waitcnt lgkmcnt(6)
    v_mfma_f32_16x16x32_bf16 v[200:203], v[120:123], v[236:239], v[200:203]
    v_pk_mov_b32 v[68:69], v[52:53], v[52:53]
    v_mfma_f32_16x16x32_bf16 v[204:207], v[124:127], v[236:239], v[204:207]
    v_pk_mov_b32 v[70:71], v[52:53], v[52:53]
    ds_read_b128 v[228:231], v247 offset:17728
    s_cbranch_scc1 CF_15
    s_waitcnt lgkmcnt(0)
    s_setprio 3
    s_barrier
CF_15:
    s_waitcnt lgkmcnt(6)
    v_mfma_f32_16x16x32_bf16 v[200:203], v[128:131], v[208:211], v[200:203]
    v_pk_mov_b32 v[76:77], v[52:53], v[52:53]
    v_mfma_f32_16x16x32_bf16 v[204:207], v[132:135], v[208:211], v[204:207]
    v_pk_mov_b32 v[78:79], v[52:53], v[52:53]
    ds_read_b128 v[232:235], v247 offset:17792
    s_waitcnt lgkmcnt(6)
    v_mfma_f32_16x16x32_bf16 v[200:203], v[136:139], v[212:215], v[200:203]
    v_pk_mov_b32 v[84:85], v[52:53], v[52:53]
    v_mfma_f32_16x16x32_bf16 v[204:207], v[140:143], v[212:215], v[204:207]
    v_pk_mov_b32 v[86:87], v[52:53], v[52:53]
    ds_read_b128 v[236:239], v247 offset:17856
    s_waitcnt lgkmcnt(5)
    v_mfma_f32_16x16x32_bf16 v[200:203], v[144:147], v[216:219], v[200:203]
    v_pk_mov_b32 v[92:93], v[52:53], v[52:53]
    v_mfma_f32_16x16x32_bf16 v[204:207], v[148:151], v[216:219], v[204:207]
    v_pk_mov_b32 v[94:95], v[52:53], v[52:53]
    s_waitcnt lgkmcnt(4)
    v_mfma_f32_16x16x32_bf16 v[200:203], v[152:155], v[220:223], v[200:203]
    v_pk_mov_b32 v[100:101], v[52:53], v[52:53]
    v_mfma_f32_16x16x32_bf16 v[204:207], v[156:159], v[220:223], v[204:207]
    v_pk_mov_b32 v[102:103], v[52:53], v[52:53]
    s_waitcnt lgkmcnt(3)
    v_mfma_f32_16x16x32_bf16 v[200:203], v[160:163], v[224:227], v[200:203]
    v_pk_mov_b32 v[108:109], v[52:53], v[52:53]
    v_mfma_f32_16x16x32_bf16 v[204:207], v[164:167], v[224:227], v[204:207]
    v_pk_mov_b32 v[110:111], v[52:53], v[52:53]
    s_waitcnt lgkmcnt(2)
    v_mfma_f32_16x16x32_bf16 v[200:203], v[168:171], v[228:231], v[200:203]
    v_mfma_f32_16x16x32_bf16 v[204:207], v[172:175], v[228:231], v[204:207]
    s_waitcnt lgkmcnt(1)
    v_mfma_f32_16x16x32_bf16 v[200:203], v[176:179], v[232:235], v[200:203]
    v_mfma_f32_16x16x32_bf16 v[204:207], v[180:183], v[232:235], v[204:207]
    s_waitcnt lgkmcnt(0)
    v_mfma_f32_16x16x32_bf16 v[200:203], v[184:187], v[236:239], v[200:203]
    v_mfma_f32_16x16x32_bf16 v[204:207], v[188:191], v[236:239], v[204:207]
    s_nop 6
    v_mul_f32 v200, s96, v200
    v_mul_f32 v201, s96, v201
    v_mul_f32 v202, s96, v202
    v_mul_f32 v203, s96, v203
    v_mul_f32 v204, s96, v204
    v_mul_f32 v205, s96, v205
    v_mul_f32 v206, s96, v206
    v_mul_f32 v207, s96, v207
    v_cvt_pk_bf16_f32 v200, v200, v201
    v_cvt_pk_bf16_f32 v201, v202, v203
    v_cvt_pk_bf16_f32 v202, v204, v205
    v_cvt_pk_bf16_f32 v203, v206, v207
    s_nop 0
    v_permlane16_swap_b32 v200, v202
    v_permlane16_swap_b32 v201, v203
    buffer_store_dwordx4 v[192:195], v248, s[8:11], s35 offen sc1
    buffer_store_dwordx4 v[200:203], v248, s[8:11], s0 offen sc1
P2_J:
    v_add_u32 v2, 152576, v6
    ds_read_b128 v[160:163], v2
    ds_read_b128 v[164:167], v2 offset:1024
    v_mfma_f32_32x32x16_bf16 v[144:159], v[240:243], v[240:243], 0
    s_mov_b32 s12, s76
    s_mov_b32 s13, s77
    s_mov_b32 s14, 1835008
    s_mov_b32 s15, 0x00020000
    s_mov_b32 s16, s78
    s_mov_b32 s17, s79
    s_mov_b32 s18, 1835008
    s_mov_b32 s19, 0x00020000
    s_waitcnt vmcnt(7)
    v_max_u32 v0, v16, v18
    v_cmp_eq_u32 vcc, 0xffbfffbf, v0
    s_cbranch_vccnz SC_16
SC_16_R:
    s_waitcnt lgkmcnt(0)
    v_mfma_f32_32x32x16_bf16 v[112:127], v[16:19], v[160:163], 0
    s_setprio 3
    s_nop 10
    v_exp_f32 v112, v112
    s_waitcnt vmcnt(5)
    v_max3_u32 v0, v20, v22, v48
    v_exp_f32 v113, v113
    v_max_u32 v0, v50, v0
    v_exp_f32 v114, v114
    v_cmp_eq_u32 vcc, 0xffbfffbf, v0
    v_exp_f32 v115, v115
    s_cbranch_vccnz SC_17
SC_17_R:
    v_exp_f32 v116, v116
    v_mfma_f32_32x32x16_bf16 v[128:143], v[20:23], v[160:163], 0
    v_exp_f32 v117, v117
    v_permlane16_swap_b32 v48, v52
    v_exp_f32 v118, v118
    v_permlane16_swap_b32 v49, v53
    buffer_load_dwordx4 v[72:75], v6, s[8:11], s43 offen offset:1024 sc1
    v_exp_f32 v119, v119
    v_permlane16_swap_b32 v50, v54
    buffer_load_dwordx4 v[32:35], v6, s[8:11], s44 offen sc1
    v_exp_f32 v120, v120
    v_permlane16_swap_b32 v51, v55
    v_exp_f32 v121, v121
    v_exp_f32 v122, v122
    v_smfmac_f32_32x32x32_bf16 v[144:159], v[48:51], v[112:119], v13
    v_exp_f32 v123, v123
    v_exp_f32 v124, v124
    v_exp_f32 v125, v125
    v_exp_f32 v126, v126
    v_exp_f32 v127, v127
    s_setprio 2
    v_exp_f32 v128, v128
    s_waitcnt vmcnt(5)
    v_max3_u32 v0, v24, v26, v56
    v_exp_f32 v129, v129
    v_smfmac_f32_32x32x32_bf16 v[144:159], v[52:55], v[120:127], v13
    v_max_u32 v0, v58, v0
    v_exp_f32 v130, v130
    v_cmp_eq_u32 vcc, 0xffbfffbf, v0
    v_exp_f32 v131, v131
    s_cbranch_vccnz SC_18
SC_18_R:
    v_exp_f32 v132, v132
    v_mfma_f32_32x32x16_bf16 v[112:127], v[24:27], v[160:163], 0
    v_exp_f32 v133, v133
    v_permlane16_swap_b32 v56, v60
    v_exp_f32 v134, v134
    v_permlane16_swap_b32 v57, v61
    buffer_load_dwordx4 v[80:83], v6, s[8:11], s44 offen offset:1024 sc1
    v_exp_f32 v135, v135
    v_permlane16_swap_b32 v58, v62
    buffer_load_dwordx4 v[36:39], v6, s[8:11], s45 offen sc1
    v_exp_f32 v136, v136
    v_permlane16_swap_b32 v59, v63
    v_exp_f32 v137, v137
    v_exp_f32 v138, v138
    v_smfmac_f32_32x32x32_bf16 v[144:159], v[56:59], v[128:135], v13
    v_exp_f32 v139, v139
    v_exp_f32 v140, v140
    v_exp_f32 v141, v141
    v_exp_f32 v142, v142
    v_exp_f32 v143, v143
    v_exp_f32 v112, v112
    s_waitcnt vmcnt(5)
    v_max3_u32 v0, v28, v30, v64
    v_exp_f32 v113, v113
    v_smfmac_f32_32x32x32_bf16 v[144:159], v[60:63], v[136:143], v13
    v_max_u32 v0, v66, v0
    v_exp_f32 v114, v114
    v_cmp_eq_u32 vcc, 0xffbfffbf, v0
    v_exp_f32 v115, v115
    s_cbranch_vccnz SC_19
SC_19_R:
    v_exp_f32 v116, v116
    v_mfma_f32_32x32x16_bf16 v[128:143], v[28:31], v[160:163], 0
    v_exp_f32 v117, v117
    v_permlane16_swap_b32 v64, v68
    v_exp_f32 v118, v118
    v_permlane16_swap_b32 v65, v69
    buffer_load_dwordx4 v[88:91], v6, s[8:11], s45 offen offset:1024 sc1
    v_exp_f32 v119, v119
    v_permlane16_swap_b32 v66, v70
    buffer_load_dwordx4 v[40:43], v6, s[8:11], s46 offen sc1
    v_exp_f32 v120, v120
    v_permlane16_swap_b32 v67, v71
    v_exp_f32 v121, v121
    v_exp_f32 v122, v122
    v_smfmac_f32_32x32x32_bf16 v[144:159], v[64:67], v[112:119], v13
    v_exp_f32 v123, v123
    v_and_b32 v14, 7, v1
    v_exp_f32 v124, v124
    v_mul_u32_u24 v14, 0x404, v14
    v_exp_f32 v125, v125
    v_add_u32 v14, 122880, v14
    v_exp_f32 v126, v126
    v_exp_f32 v127, v127
    v_exp_f32 v128, v128
    s_waitcnt vmcnt(4)
    v_max3_u32 v0, v32, v34, v72
    v_exp_f32 v129, v129
    v_smfmac_f32_32x32x32_bf16 v[144:159], v[68:71], v[120:127], v13
    v_max_u32 v0, v74, v0
    v_exp_f32 v130, v130
    v_cmp_eq_u32 vcc, 0xffbfffbf, v0
    v_exp_f32 v131, v131
    s_cbranch_vccnz SC_20
SC_20_R:
    v_exp_f32 v132, v132
    v_mfma_f32_32x32x16_bf16 v[112:127], v[32:35], v[160:163], 0
    v_exp_f32 v133, v133
    v_permlane16_swap_b32 v72, v76
    s_cmp_ge_u32 s5, 4
    s_cbranch_scc1 QF_P
QF_PR:
    v_exp_f32 v134, v134
    v_permlane16_swap_b32 v73, v77
    buffer_load_dwordx4 v[96:99], v6, s[8:11], s46 offen offset:1024 sc1
    v_exp_f32 v135, v135
    v_permlane16_swap_b32 v74, v78
    buffer_load_dwordx4 v[44:47], v6, s[8:11], s47 offen sc1
    v_exp_f32 v136, v136
    v_permlane16_swap_b32 v75, v79
    v_exp_f32 v137, v137
    v_exp_f32 v138, v138
    v_smfmac_f32_32x32x32_bf16 v[144:159], v[72:75], v[128:135], v13
    v_exp_f32 v139, v139
    v_exp_f32 v140, v140
    v_exp_f32 v141, v141
    v_exp_f32 v142, v142
    v_exp_f32 v143, v143
    s_setprio 1
    v_exp_f32 v112, v112
    s_waitcnt vmcnt(4)
    v_max3_u32 v0, v36, v38, v80
    v_exp_f32 v113, v113
    v_smfmac_f32_32x32x32_bf16 v[144:159], v[76:79], v[136:143], v13
    v_max_u32 v0, v82, v0
    v_exp_f32 v114, v114
    v_cmp_eq_u32 vcc, 0xffbfffbf, v0
    v_exp_f32 v115, v115
    s_cbranch_vccnz SC_21
SC_21_R:
    v_exp_f32 v116, v116
    v_mfma_f32_32x32x16_bf16 v[128:143], v[36:39], v[160:163], 0
    v_exp_f32 v117, v117
    v_permlane16_swap_b32 v80, v84
    v_exp_f32 v118, v118
    v_permlane16_swap_b32 v81, v85
    buffer_load_dwordx4 v[104:107], v6, s[8:11], s47 offen offset:1024 sc1
    v_exp_f32 v119, v119
    v_permlane16_swap_b32 v82, v86
    v_exp_f32 v120, v120
    v_permlane16_swap_b32 v83, v87
    v_exp_f32 v121, v121
    v_exp_f32 v122, v122
    v_smfmac_f32_32x32x32_bf16 v[144:159], v[80:83], v[112:119], v13
    v_exp_f32 v123, v123
    v_exp_f32 v124, v124
    v_exp_f32 v125, v125
    v_exp_f32 v126, v126
    v_exp_f32 v127, v127
    v_exp_f32 v128, v128
    s_waitcnt vmcnt(3)
    v_max3_u32 v0, v40, v42, v88
    v_exp_f32 v129, v129
    v_smfmac_f32_32x32x32_bf16 v[144:159], v[84:87], v[120:127], v13
    v_max_u32 v0, v90, v0
    v_exp_f32 v130, v130
    v_cmp_eq_u32 vcc, 0xffbfffbf, v0
    v_exp_f32 v131, v131
    s_cbranch_vccnz SC_22
SC_22_R:
    v_exp_f32 v132, v132
    v_mfma_f32_32x32x16_bf16 v[112:127], v[40:43], v[160:163], 0
    v_exp_f32 v133, v133
    v_permlane16_swap_b32 v88, v92
    v_exp_f32 v134, v134
    v_permlane16_swap_b32 v89, v93
    v_exp_f32 v135, v135
    v_permlane16_swap_b32 v90, v94
    v_exp_f32 v136, v136
    v_permlane16_swap_b32 v91, v95
    v_exp_f32 v137, v137
    v_exp_f32 v138, v138
    v_smfmac_f32_32x32x32_bf16 v[144:159], v[88:91], v[128:135], v13
    v_exp_f32 v139, v139
    v_exp_f32 v140, v140
    v_exp_f32 v141, v141
    v_exp_f32 v142, v142
    v_exp_f32 v143, v143
    v_exp_f32 v112, v112
    s_waitcnt vmcnt(1)
    v_max3_u32 v0, v44, v46, v96
    v_exp_f32 v113, v113
    v_smfmac_f32_32x32x32_bf16 v[144:159], v[92:95], v[136:143], v13
    v_max_u32 v0, v98, v0
    v_exp_f32 v114, v114
    v_cmp_eq_u32 vcc, 0xffbfffbf, v0
    v_exp_f32 v115, v115
    s_cbranch_vccnz SC_23
SC_23_R:
    v_exp_f32 v116, v116
    v_mfma_f32_32x32x16_bf16 v[128:143], v[44:47], v[160:163], 0
    v_exp_f32 v117, v117
    v_permlane16_swap_b32 v96, v100
    v_exp_f32 v118, v118
    v_permlane16_swap_b32 v97, v101
    v_exp_f32 v119, v119
    v_permlane16_swap_b32 v98, v102
    v_exp_f32 v120, v120
    v_permlane16_swap_b32 v99, v103
    v_exp_f32 v121, v121
    v_exp_f32 v122, v122
    v_smfmac_f32_32x32x32_bf16 v[144:159], v[96:99], v[112:119], v13
    v_exp_f32 v123, v123
    v_exp_f32 v124, v124
    v_exp_f32 v125, v125
    v_exp_f32 v126, v126
    v_exp_f32 v127, v127
    v_exp_f32 v128, v128
    s_waitcnt vmcnt(0)
    v_exp_f32 v129, v129
    v_smfmac_f32_32x32x32_bf16 v[144:159], v[100:103], v[120:127], v13
    v_max_u32 v0, v104, v106
    v_exp_f32 v130, v130
    v_cmp_eq_u32 vcc, 0xffbfffbf, v0
    v_exp_f32 v131, v131
    s_cbranch_vccnz SC_24
SC_24_R:
    v_exp_f32 v132, v132
    v_mfma_f32_32x32x16_bf16 v[112:127], v[16:19], v[164:167], 0
    v_exp_f32 v133, v133
    v_permlane16_swap_b32 v104, v108
    s_lshl_b32 s39, s3, 5
    s_add_u32 s39, s39, s4
    s_lshl_b32 s39, s39, 3
    s_add_u32 s39, s39, s5
    s_mul_i32 s39, s39, 3584
    s_add_u32 s39, s39, 8388608
    v_mov_b32 v2, 0xffbfffbf
    v_mov_b32 v3, 0xffbfffbf
    v_mov_b32 v4, 0xffbfffbf
    v_mov_b32 v5, 0xffbfffbf
    v_exp_f32 v134, v134
    v_permlane16_swap_b32 v105, v109
    v_exp_f32 v135, v135
    v_permlane16_swap_b32 v106, v110
    v_exp_f32 v136, v136
    v_permlane16_swap_b32 v107, v111
    s_lshl_b32 s60, s34, 7
    v_and_b32 v15, 15, v1
    s_add_u32 s60, s60, 32768
    v_lshlrev_b32 v15, 2, v15
    buffer_load_dword v15, v15, s[8:11], s60 offen sc1
    v_exp_f32 v137, v137
    v_exp_f32 v138, v138
    v_smfmac_f32_32x32x32_bf16 v[144:159], v[104:107], v[128:135], v13
    v_exp_f32 v139, v139
    v_exp_f32 v140, v140
    v_exp_f32 v141, v141
    v_exp_f32 v142, v142
    v_exp_f32 v143, v143
    v_exp_f32 v112, v112
    v_exp_f32 v113, v113
    v_smfmac_f32_32x32x32_bf16 v[144:159], v[108:111], v[136:143], v13
    v_exp_f32 v114, v114
    v_exp_f32 v115, v115
    v_exp_f32 v116, v116
    v_mfma_f32_32x32x16_bf16 v[128:143], v[20:23], v[164:167], 0
    v_exp_f32 v117, v117
    v_exp_f32 v118, v118
    v_exp_f32 v119, v119
    v_exp_f32 v120, v120
    v_exp_f32 v121, v121
    v_exp_f32 v122, v122
    v_exp_f32 v123, v123
    v_exp_f32 v124, v124
    ds_write_b128 v8, v[144:147] offset:0
    v_exp_f32 v125, v125
    ds_write_b128 v8, v[148:151] offset:1024
    v_exp_f32 v126, v126
    s_mov_b32 exec_hi, 0
    ds_write_b32 v252, v152 offset:0
    s_mov_b32 exec_hi, -1
    v_exp_f32 v127, v127
    v_mfma_f32_32x32x16_bf16 v[144:159], v[240:243], v[240:243], 0
    v_smfmac_f32_32x32x32_bf16 v[144:159], v[48:51], v[112:119], v13
    s_setprio 0
    v_exp_f32 v128, v128
    v_exp_f32 v129, v129
    v_smfmac_f32_32x32x32_bf16 v[144:159], v[52:55], v[120:127], v13
    v_exp_f32 v130, v130
    v_exp_f32 v131, v131
    v_exp_f32 v132, v132
    v_mfma_f32_32x32x16_bf16 v[112:127], v[24:27], v[164:167], 0
    v_exp_f32 v133, v133
    buffer_store_dwordx4 v[2:5], v6, s[8:11], s39 offen offset:0 sc1
    v_exp_f32 v134, v134
    v_exp_f32 v135, v135
    v_exp_f32 v136, v136
    v_exp_f32 v137, v137
    s_cmp_lt_u32 s5, 4
    s_cselect_b32 s24, s78, s80
    s_cselect_b32 s25, s79, s81
    s_cmp_lt_u32 s5, 2
    s_cselect_b32 s24, s76, s24
    s_cselect_b32 s25, s77, s25
    s_cmp_lt_u32 s5, 6
    s_cselect_b32 s26, 1835008, 0
    s_mov_b32 s27, 0x00020000
    s_and_b32 s60, s5, 1
    s_lshl_b32 s61, s2, 1
    s_add_u32 s60, s60, s61
    s_mul_i32 s60, s60, 3584
    v_lshlrev_b32 v0, 6, v1
    buffer_load_dword v0, v0, s[24:27], s60 offen
    v_exp_f32 v138, v138
    v_smfmac_f32_32x32x32_bf16 v[144:159], v[56:59], v[128:135], v13
    v_exp_f32 v139, v139
    v_exp_f32 v140, v140
    v_exp_f32 v141, v141
    v_exp_f32 v142, v142
    v_exp_f32 v143, v143
    s_setprio 3
    v_exp_f32 v112, v112
    v_exp_f32 v113, v113
    v_smfmac_f32_32x32x32_bf16 v[144:159], v[60:63], v[136:143], v13
    s_waitcnt vmcnt(2)
    v_cmp_ne_u32 vcc, s6, v15
    s_cbranch_vccnz QF_C
QF_CR:
    v_exp_f32 v114, v114
    s_add_u32 s48, s56, 2048
    s_and_b32 s48, s48, 8191
    s_add_u32 s48, s48, s55
    v_exp_f32 v115, v115
    buffer_load_dwordx4 v[160:163], v6, s[8:11], s48 offen sc1
    v_exp_f32 v116, v116
    v_mfma_f32_32x32x16_bf16 v[128:143], v[28:31], v[164:167], 0
    v_exp_f32 v117, v117
    v_exp_f32 v118, v118
    v_exp_f32 v119, v119
    v_exp_f32 v120, v120
    v_exp_f32 v121, v121
    v_exp_f32 v122, v122
    v_smfmac_f32_32x32x32_bf16 v[144:159], v[64:67], v[112:119], v13
    v_exp_f32 v123, v123
    ds_read_b32 v251, v14 offset:0
    v_exp_f32 v124, v124
    v_exp_f32 v125, v125
    v_exp_f32 v126, v126
    v_exp_f32 v127, v127
    s_waitcnt lgkmcnt(0)
    v_cmp_eq_u32 vcc, 0xff800000, v251
    s_cbranch_vccnz FW_1
FW_R1:
    v_exp_f32 v128, v128
    s_bitcmp0_b32 s5, 2
    s_cbranch_scc1 CB_25
    ds_read2st64_b32 v[244:245], v253 offset0:0 offset1:4
    ds_read2st64_b32 v[246:247], v253 offset0:8 offset1:12
    ds_read2st64_b32 v[248:249], v253 offset0:16 offset1:20
    ds_read2st64_b32 v[250:251], v253 offset0:24 offset1:28
    ds_read2st64_b64 v[224:227], v9 offset0:0 offset1:4
    ds_read2st64_b64 v[228:231], v9 offset0:8 offset1:12
    ds_read2st64_b64 v[232:235], v9 offset0:16 offset1:20
    ds_read2st64_b64 v[236:239], v9 offset0:24 offset1:28
CB_25:
    v_exp_f32 v129, v129
    v_smfmac_f32_32x32x32_bf16 v[144:159], v[68:71], v[120:127], v13
    v_exp_f32 v130, v130
    v_exp_f32 v131, v131
    v_exp_f32 v132, v132
    v_mfma_f32_32x32x16_bf16 v[112:127], v[32:35], v[164:167], 0
    v_exp_f32 v133, v133
    v_exp_f32 v134, v134
    v_exp_f32 v135, v135
    v_exp_f32 v136, v136
    v_exp_f32 v137, v137
    s_bitcmp0_b32 s5, 2
    s_cbranch_scc1 CB_26
    s_waitcnt lgkmcnt(4)
    v_pk_add_f32 v[244:245], v[244:245], v[246:247]
    v_pk_add_f32 v[248:249], v[248:249], v[250:251]
    v_pk_add_f32 v[244:245], v[244:245], v[248:249]
    v_add_f32 v245, v244, v245
    v_rcp_f32 v244, v245
    s_waitcnt lgkmcnt(0)
    v_pk_add_f32 v[224:225], v[224:225], v[226:227]
    v_pk_add_f32 v[228:229], v[228:229], v[230:231]
    v_pk_add_f32 v[232:233], v[232:233], v[234:235]
    v_pk_add_f32 v[236:237], v[236:237], v[238:239]
    v_pk_add_f32 v[224:225], v[224:225], v[228:229]
    v_pk_add_f32 v[232:233], v[232:233], v[236:237]
    v_pk_add_f32 v[224:225], v[224:225], v[232:233]
    v_mul_f32 v224, v224, v244
    v_mul_f32 v225, v225, v244
    v_cvt_pk_bf16_f32 v226, v224, v225
    ds_write_b32 v10, v226 offset:0
    v_fma_f32 v245, v224, 0, v245
    v_fma_f32 v245, v225, 0, v245
    v_subrev_u32 v245, 0x1f800000, v245
    v_cmp_le_u32 vcc, 2.0, v245
    s_cbranch_vccnz CB_26_B
CB_26:
    v_exp_f32 v138, v138
    v_smfmac_f32_32x32x32_bf16 v[144:159], v[72:75], v[128:135], v13
    v_exp_f32 v139, v139
    s_add_u32 s49, s56, 0
    s_and_b32 s49, s49, 8191
    s_lshl_b32 s49, s49, 6
    s_add_u32 s49, s49, s57
    s_add_u32 s50, s49, 32768
    v_exp_f32 v140, v140
    v_exp_f32 v141, v141
    buffer_load_dwordx4 v[184:187], v6, s[8:11], s49 offen offset:0 sc1
    v_exp_f32 v142, v142
    v_exp_f32 v143, v143
    v_exp_f32 v112, v112
    v_exp_f32 v113, v113
    v_smfmac_f32_32x32x32_bf16 v[144:159], v[76:79], v[136:143], v13
    v_exp_f32 v114, v114
    v_exp_f32 v115, v115
    v_exp_f32 v116, v116
    v_mfma_f32_32x32x16_bf16 v[128:143], v[36:39], v[164:167], 0
    v_exp_f32 v117, v117
    v_exp_f32 v118, v118
    v_exp_f32 v119, v119
    v_exp_f32 v120, v120
    v_exp_f32 v121, v121
    v_exp_f32 v122, v122
    v_smfmac_f32_32x32x32_bf16 v[144:159], v[80:83], v[112:119], v13
    v_exp_f32 v123, v123
    v_exp_f32 v124, v124
    v_exp_f32 v125, v125
    buffer_load_dwordx4 v[188:191], v6, s[8:11], s49 offen offset:1024 sc1
    v_exp_f32 v126, v126
    v_exp_f32 v127, v127
    s_setprio 2
    v_exp_f32 v128, v128
    v_exp_f32 v129, v129
    v_smfmac_f32_32x32x32_bf16 v[144:159], v[84:87], v[120:127], v13
    v_exp_f32 v130, v130
    s_mov_b32 s38, 786432
    s_cmp_eq_u32 s5, 4
    s_cbranch_scc1 LP_A
LP_AR:
    v_exp_f32 v131, v131
    v_exp_f32 v132, v132
    v_mfma_f32_32x32x16_bf16 v[112:127], v[40:43], v[164:167], 0
    v_exp_f32 v133, v133
    v_exp_f32 v134, v134
    v_exp_f32 v135, v135
    v_pk_mov_b32 v[216:217], v[240:241], v[240:241]
    v_exp_f32 v136, v136
    v_pk_mov_b32 v[218:219], v[240:241], v[240:241]
    v_exp_f32 v137, v137
    v_exp_f32 v138, v138
    v_smfmac_f32_32x32x32_bf16 v[144:159], v[88:91], v[128:135], v13
    v_exp_f32 v139, v139
    v_exp_f32 v140, v140
    v_exp_f32 v141, v141
    buffer_load_dwordx4 v[192:195], v6, s[8:11], s49 offen offset:2048 sc1
    v_exp_f32 v142, v142
    v_exp_f32 v143, v143
    v_exp_f32 v112, v112
    v_exp_f32 v113, v113
    v_smfmac_f32_32x32x32_bf16 v[144:159], v[92:95], v[136:143], v13
    v_exp_f32 v114, v114
    v_exp_f32 v115, v115
    v_exp_f32 v116, v116
    v_mfma_f32_32x32x16_bf16 v[128:143], v[44:47], v[164:167], 0
    v_exp_f32 v117, v117
    v_exp_f32 v118, v118
    s_mov_b32 s94, 0x00ff00ff
    s_mov_b32 s95, s94
    v_exp_f32 v119, v119
    v_pk_mov_b32 v[220:221], v[240:241], v[240:241]
    v_exp_f32 v120, v120
    v_pk_mov_b32 v[222:223], v[240:241], v[240:241]
    v_exp_f32 v121, v121
    v_exp_f32 v122, v122
    v_smfmac_f32_32x32x32_bf16 v[144:159], v[96:99], v[112:119], v13
    v_exp_f32 v123, v123
    v_exp_f32 v124, v124
    v_exp_f32 v125, v125
    buffer_load_dwordx4 v[196:199], v6, s[8:11], s49 offen offset:3072 sc1
    v_exp_f32 v126, v126
    v_exp_f32 v127, v127
    s_setprio 1
    v_exp_f32 v128, v128
    v_exp_f32 v129, v129
    v_smfmac_f32_32x32x32_bf16 v[144:159], v[100:103], v[120:127], v13
    v_exp_f32 v130, v130
    v_exp_f32 v131, v131
    s_waitcnt vmcnt(4)
    v_exp_f32 v132, v132
    v_mfma_f32_32x32x16_bf16 v[112:127], v[16:19], v[160:163], 0
    v_exp_f32 v133, v133
    v_exp_f32 v134, v134
    v_exp_f32 v135, v135
    v_exp_f32 v136, v136
    v_exp_f32 v137, v137
    v_exp_f32 v138, v138
    v_smfmac_f32_32x32x32_bf16 v[144:159], v[104:107], v[128:135], v13
    v_exp_f32 v139, v139
    v_exp_f32 v140, v140
    v_exp_f32 v141, v141
    buffer_load_dwordx4 v[200:203], v6, s[8:11], s50 offen offset:0 sc1
    v_exp_f32 v142, v142
    v_exp_f32 v143, v143
    v_exp_f32 v112, v112
    v_exp_f32 v113, v113
    v_smfmac_f32_32x32x32_bf16 v[144:159], v[108:111], v[136:143], v13
    v_exp_f32 v114, v114
    v_exp_f32 v115, v115
    v_exp_f32 v116, v116
    v_mfma_f32_32x32x16_bf16 v[128:143], v[20:23], v[160:163], 0
    v_exp_f32 v117, v117
    v_exp_f32 v118, v118
    v_exp_f32 v119, v119
    v_exp_f32 v120, v120
    v_exp_f32 v121, v121
    v_exp_f32 v122, v122
    v_exp_f32 v123, v123
    v_exp_f32 v124, v124
    ds_write_b128 v8, v[144:147] offset:16384
    v_exp_f32 v125, v125
    ds_write_b128 v8, v[148:151] offset:17408
    buffer_load_dwordx4 v[204:207], v6, s[8:11], s50 offen offset:1024 sc1
    v_exp_f32 v126, v126
    s_mov_b32 exec_hi, 0
    ds_write_b32 v252, v152 offset:128
    s_mov_b32 exec_hi, -1
    v_exp_f32 v127, v127
    v_mfma_f32_32x32x16_bf16 v[144:159], v[240:243], v[240:243], 0
    v_smfmac_f32_32x32x32_bf16 v[144:159], v[48:51], v[112:119], v13
    s_setprio 0
    v_exp_f32 v128, v128
    v_exp_f32 v129, v129
    v_smfmac_f32_32x32x32_bf16 v[144:159], v[52:55], v[120:127], v13
    v_exp_f32 v130, v130
    v_exp_f32 v131, v131
    v_exp_f32 v132, v132
    v_mfma_f32_32x32x16_bf16 v[112:127], v[24:27], v[160:163], 0
    v_exp_f32 v133, v133
    buffer_store_dwordx4 v[2:5], v6, s[8:11], s39 offen offset:1024 sc1
    v_exp_f32 v134, v134
    v_exp_f32 v135, v135
    v_exp_f32 v136, v136
    v_exp_f32 v137, v137
    v_exp_f32 v138, v138
    v_smfmac_f32_32x32x32_bf16 v[144:159], v[56:59], v[128:135], v13
    v_exp_f32 v139, v139
    v_exp_f32 v140, v140
    v_exp_f32 v141, v141
    buffer_load_dwordx4 v[208:211], v6, s[8:11], s50 offen offset:2048 sc1
    v_exp_f32 v142, v142
    v_exp_f32 v143, v143
    s_setprio 3
    v_exp_f32 v112, v112
    s_cmp_eq_u32 s5, 4
    s_cbranch_scc1 LP_B
LP_BR:
    v_exp_f32 v113, v113
    v_smfmac_f32_32x32x32_bf16 v[144:159], v[60:63], v[136:143], v13
    v_exp_f32 v114, v114
    s_add_u32 s48, s56, 3072
    s_and_b32 s48, s48, 8191
    s_add_u32 s48, s48, s55
    v_exp_f32 v115, v115
    buffer_load_dwordx4 v[164:167], v6, s[8:11], s48 offen sc1
    v_exp_f32 v116, v116
    v_mfma_f32_32x32x16_bf16 v[128:143], v[28:31], v[160:163], 0
    v_exp_f32 v117, v117
    v_exp_f32 v118, v118
    v_exp_f32 v119, v119
    v_exp_f32 v120, v120
    v_exp_f32 v121, v121
    v_exp_f32 v122, v122
    v_smfmac_f32_32x32x32_bf16 v[144:159], v[64:67], v[112:119], v13
    v_exp_f32 v123, v123
    ds_read_b32 v251, v14 offset:128
    v_exp_f32 v124, v124
    v_exp_f32 v125, v125
    buffer_load_dwordx4 v[212:215], v6, s[8:11], s50 offen offset:3072 sc1
    v_exp_f32 v126, v126
    v_exp_f32 v127, v127
    s_waitcnt lgkmcnt(0)
    v_cmp_eq_u32 vcc, 0xff800000, v251
    s_cbranch_vccnz FW_2
FW_R2:
    s_mov_b64 exec, s[94:95]
    ds_read_b128 v[216:219], v11 offset:0
    ds_read_b128 v[220:223], v11 offset:512
    s_mov_b64 exec, -1
    v_exp_f32 v128, v128
    s_bitcmp1_b32 s5, 2
    s_cbranch_scc1 CB_27
    ds_read2st64_b32 v[244:245], v253 offset0:0 offset1:4
    ds_read2st64_b32 v[246:247], v253 offset0:8 offset1:12
    ds_read2st64_b32 v[248:249], v253 offset0:16 offset1:20
    ds_read2st64_b32 v[250:251], v253 offset0:24 offset1:28
    ds_read2st64_b64 v[224:227], v9 offset0:32 offset1:36
    ds_read2st64_b64 v[228:231], v9 offset0:40 offset1:44
    ds_read2st64_b64 v[232:235], v9 offset0:48 offset1:52
    ds_read2st64_b64 v[236:239], v9 offset0:56 offset1:60
CB_27:
    v_exp_f32 v129, v129
    v_smfmac_f32_32x32x32_bf16 v[144:159], v[68:71], v[120:127], v13
    v_exp_f32 v130, v130
    v_exp_f32 v131, v131
    v_exp_f32 v132, v132
    v_mfma_f32_32x32x16_bf16 v[112:127], v[32:35], v[160:163], 0
    v_exp_f32 v133, v133
    v_exp_f32 v134, v134
    v_exp_f32 v135, v135
    v_exp_f32 v136, v136
    v_exp_f32 v137, v137
    s_bitcmp1_b32 s5, 2
    s_cbranch_scc1 CB_28
    s_waitcnt lgkmcnt(4)
    v_pk_add_f32 v[244:245], v[244:245], v[246:247]
    v_pk_add_f32 v[248:249], v[248:249], v[250:251]
    v_pk_add_f32 v[244:245], v[244:245], v[248:249]
    v_add_f32 v245, v244, v245
    v_rcp_f32 v244, v245
    s_waitcnt lgkmcnt(0)
    v_pk_add_f32 v[224:225], v[224:225], v[226:227]
    v_pk_add_f32 v[228:229], v[228:229], v[230:231]
    v_pk_add_f32 v[232:233], v[232:233], v[234:235]
    v_pk_add_f32 v[236:237], v[236:237], v[238:239]
    v_pk_add_f32 v[224:225], v[224:225], v[228:229]
    v_pk_add_f32 v[232:233], v[232:233], v[236:237]
    v_pk_add_f32 v[224:225], v[224:225], v[232:233]
    v_mul_f32 v224, v224, v244
    v_mul_f32 v225, v225, v244
    v_cvt_pk_bf16_f32 v226, v224, v225
    ds_write_b32 v10, v226 offset:1024
    v_fma_f32 v245, v224, 0, v245
    v_fma_f32 v245, v225, 0, v245
    v_subrev_u32 v245, 0x1f800000, v245
    v_cmp_le_u32 vcc, 2.0, v245
    s_cbranch_vccnz CB_28_B
CB_28:
    v_exp_f32 v138, v138
    v_smfmac_f32_32x32x32_bf16 v[144:159], v[72:75], v[128:135], v13
    v_exp_f32 v139, v139
    s_add_u32 s49, s56, 1024
    s_and_b32 s49, s49, 8191
    s_lshl_b32 s49, s49, 6
    s_add_u32 s49, s49, s57
    s_add_u32 s50, s49, 32768
    v_exp_f32 v140, v140
    v_exp_f32 v141, v141
    s_waitcnt lgkmcnt(0)
    s_waitcnt vmcnt(8)
    v_mfma_f32_16x16x32_bf16 v[168:171], v[184:187], v[216:219], 0
    buffer_load_dwordx4 v[184:187], v6, s[8:11], s49 offen offset:0 sc1
    v_exp_f32 v142, v142
    v_exp_f32 v143, v143
    v_exp_f32 v112, v112
    v_exp_f32 v113, v113
    v_smfmac_f32_32x32x32_bf16 v[144:159], v[76:79], v[136:143], v13
    v_exp_f32 v114, v114
    v_exp_f32 v115, v115
    v_exp_f32 v116, v116
    v_mfma_f32_32x32x16_bf16 v[128:143], v[36:39], v[160:163], 0
    v_exp_f32 v117, v117
    v_exp_f32 v118, v118
    v_exp_f32 v119, v119
    v_exp_f32 v120, v120
    s_add_u32 m0, s54, 86208
    s_nop 0
    buffer_load_dwordx4 v12, s[12:15], s51 offen lds
    v_exp_f32 v121, v121
    v_exp_f32 v122, v122
    v_smfmac_f32_32x32x32_bf16 v[144:159], v[80:83], v[112:119], v13
    v_exp_f32 v123, v123
    v_exp_f32 v124, v124
    v_exp_f32 v125, v125
    v_mfma_f32_16x16x32_bf16 v[172:175], v[188:191], v[216:219], 0
    buffer_load_dwordx4 v[188:191], v6, s[8:11], s49 offen offset:1024 sc1
    v_exp_f32 v126, v126
    v_exp_f32 v127, v127
    s_setprio 2
    v_exp_f32 v128, v128
    v_exp_f32 v129, v129
    v_smfmac_f32_32x32x32_bf16 v[144:159], v[84:87], v[120:127], v13
    v_exp_f32 v130, v130
    v_exp_f32 v131, v131
    v_exp_f32 v132, v132
    v_mfma_f32_32x32x16_bf16 v[112:127], v[40:43], v[160:163], 0
    v_exp_f32 v133, v133
    v_exp_f32 v134, v134
    v_exp_f32 v135, v135
    v_exp_f32 v136, v136
    v_exp_f32 v137, v137
    v_exp_f32 v138, v138
    v_smfmac_f32_32x32x32_bf16 v[144:159], v[88:91], v[128:135], v13
    v_exp_f32 v139, v139
    v_exp_f32 v140, v140
    v_exp_f32 v141, v141
    s_waitcnt vmcnt(9)
    v_mfma_f32_16x16x32_bf16 v[176:179], v[192:195], v[216:219], 0
    buffer_load_dwordx4 v[192:195], v6, s[8:11], s49 offen offset:2048 sc1
    v_exp_f32 v142, v142
    v_exp_f32 v143, v143
    v_exp_f32 v112, v112
    v_exp_f32 v113, v113
    v_smfmac_f32_32x32x32_bf16 v[144:159], v[92:95], v[136:143], v13
    v_exp_f32 v114, v114
    v_exp_f32 v115, v115
    v_exp_f32 v116, v116
    v_mfma_f32_32x32x16_bf16 v[128:143], v[44:47], v[160:163], 0
    v_exp_f32 v117, v117
    v_exp_f32 v118, v118
    v_exp_f32 v119, v119
    v_exp_f32 v120, v120
    s_add_u32 m0, s54, 93392
    s_add_u32 s60, s51, 229376
    buffer_load_dwordx4 v12, s[16:19], s51 offen lds
    s_cmp_eq_u32 s60, 1835008
    s_cselect_b32 s51, 0, s60
    v_exp_f32 v121, v121
    v_exp_f32 v122, v122
    v_smfmac_f32_32x32x32_bf16 v[144:159], v[96:99], v[112:119], v13
    v_exp_f32 v123, v123
    s_and_b32 s42, s5, 3
    s_lshl_b32 s40, s42, 11
    s_lshr_b32 s31, s5, 2
    s_lshl_b32 s44, s31, 10
    v_exp_f32 v124, v124
    v_exp_f32 v125, v125
    v_mfma_f32_16x16x32_bf16 v[180:183], v[196:199], v[216:219], 0
    buffer_load_dwordx4 v[196:199], v6, s[8:11], s49 offen offset:3072 sc1
    v_exp_f32 v126, v126
    v_exp_f32 v127, v127
    s_setprio 1
    v_exp_f32 v128, v128
    v_exp_f32 v129, v129
    v_smfmac_f32_32x32x32_bf16 v[144:159], v[100:103], v[120:127], v13
    v_exp_f32 v130, v130
    v_exp_f32 v131, v131
    s_waitcnt vmcnt(7)
    v_exp_f32 v132, v132
    v_mfma_f32_32x32x16_bf16 v[112:127], v[16:19], v[164:167], 0
    v_exp_f32 v133, v133
    v_exp_f32 v134, v134
    v_exp_f32 v135, v135
    v_exp_f32 v136, v136
    v_exp_f32 v137, v137
    v_exp_f32 v138, v138
    v_smfmac_f32_32x32x32_bf16 v[144:159], v[104:107], v[128:135], v13
    v_exp_f32 v139, v139
    s_add_u32 s44, s44, s40
    s_mul_i32 s35, s42, 458752
    s_lshl_b32 s46, s31, 15
    s_add_u32 s46, s46, 98304
    v_exp_f32 v140, v140
    v_exp_f32 v141, v141
    s_waitcnt vmcnt(10)
    v_mfma_f32_16x16x32_bf16 v[168:171], v[200:203], v[220:223], v[168:171]
    buffer_load_dwordx4 v[200:203], v6, s[8:11], s50 offen offset:0 sc1
    v_exp_f32 v142, v142
    v_exp_f32 v143, v143
    v_exp_f32 v112, v112
    v_exp_f32 v113, v113
    v_smfmac_f32_32x32x32_bf16 v[144:159], v[108:111], v[136:143], v13
    v_exp_f32 v114, v114
    v_exp_f32 v115, v115
    v_exp_f32 v116, v116
    v_mfma_f32_32x32x16_bf16 v[128:143], v[20:23], v[164:167], 0
    v_exp_f32 v117, v117
    v_exp_f32 v118, v118
    v_exp_f32 v119, v119
    v_exp_f32 v120, v120
    s_add_u32 m0, s54, 100576
    s_nop 0
    buffer_load_dwordx4 v12, s[12:15], s51 offen lds
    v_exp_f32 v121, v121
    v_exp_f32 v122, v122
    v_exp_f32 v123, v123
    s_add_u32 s45, s46, s40
    s_add_u32 s40, s40, 98304
    s_mul_i32 s60, s42, 640
    s_and_b32 s60, s60, 1152
    s_add_u32 s46, s46, s60
    v_exp_f32 v124, v124
    ds_write_b128 v8, v[144:147] offset:0
    v_exp_f32 v125, v125
    ds_write_b128 v8, v[148:151] offset:1024
    v_mfma_f32_16x16x32_bf16 v[172:175], v[204:207], v[220:223], v[172:175]
    buffer_load_dwordx4 v[204:207], v6, s[8:11], s50 offen offset:1024 sc1
    v_exp_f32 v126, v126
    s_mov_b32 exec_hi, 0
    ds_write_b32 v252, v152 offset:256
    s_mov_b32 exec_hi, -1
    v_exp_f32 v127, v127
    v_mfma_f32_32x32x16_bf16 v[144:159], v[240:243], v[240:243], 0
    v_smfmac_f32_32x32x32_bf16 v[144:159], v[48:51], v[112:119], v13
    s_setprio 0
    v_exp_f32 v128, v128
    v_exp_f32 v129, v129
    v_smfmac_f32_32x32x32_bf16 v[144:159], v[52:55], v[120:127], v13
    v_exp_f32 v130, v130
    v_exp_f32 v131, v131
    v_exp_f32 v132, v132
    v_mfma_f32_32x32x16_bf16 v[112:127], v[24:27], v[164:167], 0
    v_exp_f32 v133, v133
    buffer_store_dwordx4 v[2:5], v6, s[8:11], s39 offen offset:2048 sc1
    v_exp_f32 v134, v134
    v_exp_f32 v135, v135
    v_exp_f32 v136, v136
    v_exp_f32 v137, v137
    v_exp_f32 v138, v138
    v_smfmac_f32_32x32x32_bf16 v[144:159], v[56:59], v[128:135], v13
    v_exp_f32 v139, v139
    s_xor_b32 s60, s4, 0
    s_and_b32 s60, s60, 3
    s_mul_i32 s60, s60, 114688
    s_add_u32 s32, s60, s35
    v_exp_f32 v140, v140
    v_exp_f32 v141, v141
    s_waitcnt vmcnt(10)
    v_mfma_f32_16x16x32_bf16 v[176:179], v[208:211], v[220:223], v[176:179]
    buffer_load_dwordx4 v[208:211], v6, s[8:11], s50 offen offset:2048 sc1
    v_exp_f32 v142, v142
    v_exp_f32 v143, v143
    s_setprio 3
    v_exp_f32 v112, v112
    v_exp_f32 v113, v113
    v_smfmac_f32_32x32x32_bf16 v[144:159], v[60:63], v[136:143], v13
    v_exp_f32 v114, v114
    s_add_u32 s48, s56, 4096
    s_and_b32 s48, s48, 8191
    s_add_u32 s48, s48, s55
    v_exp_f32 v115, v115
    buffer_load_dwordx4 v[160:163], v6, s[8:11], s48 offen sc1
    v_exp_f32 v116, v116
    v_mfma_f32_32x32x16_bf16 v[128:143], v[28:31], v[164:167], 0
    v_exp_f32 v117, v117
    v_exp_f32 v118, v118
    v_exp_f32 v119, v119
    v_exp_f32 v120, v120
    s_add_u32 m0, s54, 107760
    s_add_u32 s60, s51, 229376
    buffer_load_dwordx4 v12, s[16:19], s51 offen lds
    s_cmp_eq_u32 s60, 1835008
    s_cselect_b32 s51, 0, s60
    v_exp_f32 v121, v121
    v_exp_f32 v122, v122
    v_smfmac_f32_32x32x32_bf16 v[144:159], v[64:67], v[112:119], v13
    v_exp_f32 v123, v123
    ds_read_b32 v251, v14 offset:256
    s_xor_b32 s60, s4, 1
    s_and_b32 s60, s60, 3
    s_mul_i32 s60, s60, 114688
    s_add_u32 s33, s60, s35
    v_exp_f32 v124, v124
    v_exp_f32 v125, v125
    v_mfma_f32_16x16x32_bf16 v[180:183], v[212:215], v[220:223], v[180:183]
    buffer_load_dwordx4 v[212:215], v6, s[8:11], s50 offen offset:3072 sc1
    v_exp_f32 v126, v126
    v_exp_f32 v127, v127
    s_waitcnt lgkmcnt(0)
    v_cmp_eq_u32 vcc, 0xff800000, v251
    s_cbranch_vccnz FW_3
FW_R3:
    s_mov_b64 exec, s[94:95]
    ds_read_b128 v[216:219], v11 offset:1024
    ds_read_b128 v[220:223], v11 offset:1536
    s_mov_b64 exec, -1
    v_exp_f32 v128, v128
    s_bitcmp0_b32 s5, 2
    s_cbranch_scc1 CB_29
    ds_read2st64_b32 v[244:245], v253 offset0:1 offset1:5
    ds_read2st64_b32 v[246:247], v253 offset0:9 offset1:13
    ds_read2st64_b32 v[248:249], v253 offset0:17 offset1:21
    ds_read2st64_b32 v[250:251], v253 offset0:25 offset1:29
    ds_read2st64_b64 v[224:227], v9 offset0:0 offset1:4
    ds_read2st64_b64 v[228:231], v9 offset0:8 offset1:12
    ds_read2st64_b64 v[232:235], v9 offset0:16 offset1:20
    ds_read2st64_b64 v[236:239], v9 offset0:24 offset1:28
CB_29:
    v_exp_f32 v129, v129
    v_smfmac_f32_32x32x32_bf16 v[144:159], v[68:71], v[120:127], v13
    v_exp_f32 v130, v130
    v_exp_f32 v131, v131
    v_exp_f32 v132, v132
    v_mfma_f32_32x32x16_bf16 v[112:127], v[32:35], v[164:167], 0
    v_exp_f32 v133, v133
    v_exp_f32 v134, v134
    v_exp_f32 v135, v135
    v_exp_f32 v136, v136
    v_exp_f32 v137, v137
    s_bitcmp0_b32 s5, 2
    s_cbranch_scc1 CB_30
    s_waitcnt lgkmcnt(4)
    v_pk_add_f32 v[244:245], v[244:245], v[246:247]
    v_pk_add_f32 v[248:249], v[248:249], v[250:251]
    v_pk_add_f32 v[244:245], v[244:245], v[248:249]
    v_add_f32 v245, v244, v245
    v_rcp_f32 v244, v245
    s_waitcnt lgkmcnt(0)
    v_pk_add_f32 v[224:225], v[224:225], v[226:227]
    v_pk_add_f32 v[228:229], v[228:229], v[230:231]
    v_pk_add_f32 v[232:233], v[232:233], v[234:235]
    v_pk_add_f32 v[236:237], v[236:237], v[238:239]
    v_pk_add_f32 v[224:225], v[224:225], v[228:229]
    v_pk_add_f32 v[232:233], v[232:233], v[236:237]
    v_pk_add_f32 v[224:225], v[224:225], v[232:233]
    v_mul_f32 v224, v224, v244
    v_mul_f32 v225, v225, v244
    v_cvt_pk_bf16_f32 v226, v224, v225
    ds_write_b32 v10, v226 offset:0
    v_fma_f32 v245, v224, 0, v245
    v_fma_f32 v245, v225, 0, v245
    v_subrev_u32 v245, 0x1f800000, v245
    v_cmp_le_u32 vcc, 2.0, v245
    s_cbranch_vccnz CB_30_B
CB_30:
    v_exp_f32 v138, v138
    v_smfmac_f32_32x32x32_bf16 v[144:159], v[72:75], v[128:135], v13
    v_exp_f32 v139, v139
    s_add_u32 s49, s56, 2048
    s_and_b32 s49, s49, 8191
    s_lshl_b32 s49, s49, 6
    s_add_u32 s49, s49, s57
    s_add_u32 s50, s49, 32768
    s_xor_b32 s60, s4, 2
    s_and_b32 s60, s60, 3
    s_mul_i32 s60, s60, 114688
    s_add_u32 s34, s60, s35
    v_exp_f32 v140, v140
    v_exp_f32 v141, v141
    s_waitcnt lgkmcnt(0)
    s_waitcnt vmcnt(11)
    v_mfma_f32_16x16x32_bf16 v[168:171], v[184:187], v[216:219], v[168:171]
    buffer_load_dwordx4 v[184:187], v6, s[8:11], s49 offen offset:0 sc1
    v_exp_f32 v142, v142
    v_exp_f32 v143, v143
    v_exp_f32 v112, v112
    v_exp_f32 v113, v113
    v_smfmac_f32_32x32x32_bf16 v[144:159], v[76:79], v[136:143], v13
    v_exp_f32 v114, v114
    v_exp_f32 v115, v115
    v_exp_f32 v116, v116
    v_mfma_f32_32x32x16_bf16 v[128:143], v[36:39], v[164:167], 0
    v_exp_f32 v117, v117
    v_exp_f32 v118, v118
    v_exp_f32 v119, v119
    v_exp_f32 v120, v120
    s_add_u32 m0, s54, 57472
    s_nop 0
    buffer_load_dwordx4 v12, s[12:15], s51 offen lds
    v_exp_f32 v121, v121
    v_exp_f32 v122, v122
    v_smfmac_f32_32x32x32_bf16 v[144:159], v[80:83], v[112:119], v13
    v_exp_f32 v123, v123
    s_xor_b32 s60, s4, 3
    s_and_b32 s60, s60, 3
    s_mul_i32 s60, s60, 114688
    s_add_u32 s35, s60, s35
    v_exp_f32 v124, v124
    v_exp_f32 v125, v125
    v_mfma_f32_16x16x32_bf16 v[172:175], v[188:191], v[216:219], v[172:175]
    buffer_load_dwordx4 v[188:191], v6, s[8:11], s49 offen offset:1024 sc1
    v_exp_f32 v126, v126
    v_exp_f32 v127, v127
    s_setprio 2
    v_exp_f32 v128, v128
    v_exp_f32 v129, v129
    v_smfmac_f32_32x32x32_bf16 v[144:159], v[84:87], v[120:127], v13
    v_exp_f32 v130, v130
    v_exp_f32 v131, v131
    v_exp_f32 v132, v132
    v_mfma_f32_32x32x16_bf16 v[112:127], v[40:43], v[164:167], 0
    v_exp_f32 v133, v133
    v_exp_f32 v134, v134
    v_exp_f32 v135, v135
    v_exp_f32 v136, v136
    v_exp_f32 v137, v137
    v_exp_f32 v138, v138
    v_smfmac_f32_32x32x32_bf16 v[144:159], v[88:91], v[128:135], v13
    v_exp_f32 v139, v139
    s_lshr_b32 s60, s4, 3
    s_lshl_b32 s60, s60, 1
    s_add_u32 s31, s31, s60
    s_lshl_b32 s30, s3, 3
    v_exp_f32 v140, v140
    v_exp_f32 v141, v141
    s_waitcnt vmcnt(11)
    v_mfma_f32_16x16x32_bf16 v[176:179], v[192:195], v[216:219], v[176:179]
    buffer_load_dwordx4 v[192:195], v6, s[8:11], s49 offen offset:2048 sc1
    v_exp_f32 v142, v142
    v_exp_f32 v143, v143
    v_exp_f32 v112, v112
    v_exp_f32 v113, v113
    v_smfmac_f32_32x32x32_bf16 v[144:159], v[92:95], v[136:143], v13
    v_exp_f32 v114, v114
    v_exp_f32 v115, v115
    v_exp_f32 v116, v116
    v_mfma_f32_32x32x16_bf16 v[128:143], v[44:47], v[164:167], 0
    v_exp_f32 v117, v117
    v_exp_f32 v118, v118
    v_exp_f32 v119, v119
    v_exp_f32 v120, v120
    s_add_u32 m0, s54, 64656
    s_add_u32 s60, s51, 229376
    buffer_load_dwordx4 v12, s[16:19], s51 offen lds
    s_cmp_eq_u32 s60, 1835008
    s_cselect_b32 s51, 0, s60
    v_exp_f32 v121, v121
    v_exp_f32 v122, v122
    v_smfmac_f32_32x32x32_bf16 v[144:159], v[96:99], v[112:119], v13
    v_exp_f32 v123, v123
    s_add_u32 s31, s31, s30
    s_mul_i32 s29, s31, 114688
    s_add_u32 s29, s29, 8388608
    v_exp_f32 v124, v124
    v_exp_f32 v125, v125
    v_mfma_f32_16x16x32_bf16 v[180:183], v[196:199], v[216:219], v[180:183]
    buffer_load_dwordx4 v[196:199], v6, s[8:11], s49 offen offset:3072 sc1
    v_exp_f32 v126, v126
    v_exp_f32 v127, v127
    s_setprio 1
    v_exp_f32 v128, v128
    v_exp_f32 v129, v129
    v_smfmac_f32_32x32x32_bf16 v[144:159], v[100:103], v[120:127], v13
    v_exp_f32 v130, v130
    v_exp_f32 v131, v131
    s_waitcnt vmcnt(8)
    v_exp_f32 v132, v132
    v_mfma_f32_32x32x16_bf16 v[112:127], v[16:19], v[160:163], 0
    v_exp_f32 v133, v133
    v_exp_f32 v134, v134
    v_exp_f32 v135, v135
    v_exp_f32 v136, v136
    v_exp_f32 v137, v137
    v_exp_f32 v138, v138
    v_smfmac_f32_32x32x32_bf16 v[144:159], v[104:107], v[128:135], v13
    v_exp_f32 v139, v139
    s_lshr_b32 s60, s32, 4
    s_add_u32 s76, s29, s60
    s_lshr_b32 s60, s33, 4
    s_add_u32 s77, s29, s60
    s_min_u32 s82, s76, s77
    v_exp_f32 v140, v140
    v_exp_f32 v141, v141
    s_waitcnt vmcnt(11)
    v_mfma_f32_16x16x32_bf16 v[168:171], v[200:203], v[220:223], v[168:171]
    buffer_load_dwordx4 v[200:203], v6, s[8:11], s50 offen offset:0 sc1
    v_exp_f32 v142, v142
    v_exp_f32 v143, v143
    v_exp_f32 v112, v112
    v_exp_f32 v113, v113
    v_smfmac_f32_32x32x32_bf16 v[144:159], v[108:111], v[136:143], v13
    v_exp_f32 v114, v114
    v_exp_f32 v115, v115
    v_exp_f32 v116, v116
    v_mfma_f32_32x32x16_bf16 v[128:143], v[20:23], v[160:163], 0
    v_exp_f32 v117, v117
    v_exp_f32 v118, v118
    v_exp_f32 v119, v119
    v_exp_f32 v120, v120
    s_add_u32 m0, s54, 71840
    s_nop 0
    buffer_load_dwordx4 v12, s[12:15], s51 offen lds
    v_exp_f32 v121, v121
    v_exp_f32 v122, v122
    v_exp_f32 v123, v123
    s_lshr_b32 s60, s34, 4
    s_add_u32 s78, s29, s60
    s_lshr_b32 s60, s35, 4
    s_add_u32 s79, s29, s60
    s_min_u32 s83, s78, s79
    v_exp_f32 v124, v124
    ds_write_b128 v8, v[144:147] offset:16384
    v_exp_f32 v125, v125
    ds_write_b128 v8, v[148:151] offset:17408
    v_mfma_f32_16x16x32_bf16 v[172:175], v[204:207], v[220:223], v[172:175]
    buffer_load_dwordx4 v[204:207], v6, s[8:11], s50 offen offset:1024 sc1
    v_exp_f32 v126, v126
    s_mov_b32 exec_hi, 0
    ds_write_b32 v252, v152 offset:384
    s_mov_b32 exec_hi, -1
    v_exp_f32 v127, v127
    v_mfma_f32_32x32x16_bf16 v[144:159], v[240:243], v[240:243], 0
    v_smfmac_f32_32x32x32_bf16 v[144:159], v[48:51], v[112:119], v13
    s_setprio 0
    v_exp_f32 v128, v128
    v_exp_f32 v129, v129
    v_smfmac_f32_32x32x32_bf16 v[144:159], v[52:55], v[120:127], v13
    v_exp_f32 v130, v130
    v_exp_f32 v131, v131
    v_exp_f32 v132, v132
    v_mfma_f32_32x32x16_bf16 v[112:127], v[24:27], v[160:163], 0
    v_exp_f32 v133, v133
    s_mov_b32 exec_hi, 0
    buffer_store_dwordx4 v[2:5], v6, s[8:11], s39 offen offset:3072 sc1
    s_mov_b64 exec, -1
    v_exp_f32 v134, v134
    v_exp_f32 v135, v135
    v_exp_f32 v136, v136
    v_exp_f32 v137, v137
    v_exp_f32 v138, v138
    v_smfmac_f32_32x32x32_bf16 v[144:159], v[56:59], v[128:135], v13
    v_exp_f32 v139, v139
    s_and_b32 s29, s4, 7
    s_lshl_b32 s41, s29, 8
    s_add_u32 s41, s41, 117568
    s_lshl_b32 s74, s31, 2
    v_exp_f32 v140, v140
    v_exp_f32 v141, v141
    s_waitcnt vmcnt(10)
    v_mfma_f32_16x16x32_bf16 v[176:179], v[208:211], v[220:223], v[176:179]
    buffer_load_dwordx4 v[208:211], v6, s[8:11], s50 offen offset:2048 sc1
    v_exp_f32 v142, v142
    v_exp_f32 v143, v143
    s_setprio 3
    v_exp_f32 v112, v112
    v_exp_f32 v113, v113
    v_smfmac_f32_32x32x32_bf16 v[144:159], v[60:63], v[136:143], v13
    v_exp_f32 v114, v114
    s_add_u32 s48, s56, 5120
    s_and_b32 s48, s48, 8191
    s_add_u32 s48, s48, s55
    v_exp_f32 v115, v115
    buffer_load_dwordx4 v[164:167], v6, s[8:11], s48 offen sc1
    v_exp_f32 v116, v116
    v_mfma_f32_32x32x16_bf16 v[128:143], v[28:31], v[160:163], 0
    v_exp_f32 v117, v117
    v_exp_f32 v118, v118
    v_exp_f32 v119, v119
    v_exp_f32 v120, v120
    s_add_u32 m0, s54, 79024
    s_add_u32 s60, s51, 229376
    buffer_load_dwordx4 v12, s[16:19], s51 offen lds
    s_cmp_eq_u32 s60, 1835008
    s_cselect_b32 s51, 0, s60
    v_exp_f32 v121, v121
    v_exp_f32 v122, v122
    v_smfmac_f32_32x32x32_bf16 v[144:159], v[64:67], v[112:119], v13
    v_exp_f32 v123, v123
    ds_read_b32 v251, v14 offset:384
    s_add_u32 s74, s74, s42
    s_lshl_b32 s74, s74, 6
    s_add_u32 s74, s74, s29
    s_lshl_b32 s74, s74, 7
    s_add_u32 s75, s74, 4194304
    v_exp_f32 v124, v124
    v_exp_f32 v125, v125
    v_mfma_f32_16x16x32_bf16 v[180:183], v[212:215], v[220:223], v[180:183]
    buffer_load_dwordx4 v[212:215], v6, s[8:11], s50 offen offset:3072 sc1
    v_exp_f32 v126, v126
    v_exp_f32 v127, v127
    s_waitcnt lgkmcnt(0)
    v_cmp_eq_u32 vcc, 0xff800000, v251
    s_cbranch_vccnz FW_4
FW_R4:
    s_mov_b64 exec, s[94:95]
    ds_read_b128 v[216:219], v11 offset:0
    ds_read_b128 v[220:223], v11 offset:512
    s_mov_b64 exec, -1
    v_exp_f32 v128, v128
    s_bitcmp1_b32 s5, 2
    s_cbranch_scc1 CB_31
    ds_read2st64_b32 v[244:245], v253 offset0:1 offset1:5
    ds_read2st64_b32 v[246:247], v253 offset0:9 offset1:13
    ds_read2st64_b32 v[248:249], v253 offset0:17 offset1:21
    ds_read2st64_b32 v[250:251], v253 offset0:25 offset1:29
    ds_read2st64_b64 v[224:227], v9 offset0:32 offset1:36
    ds_read2st64_b64 v[228:231], v9 offset0:40 offset1:44
    ds_read2st64_b64 v[232:235], v9 offset0:48 offset1:52
    ds_read2st64_b64 v[236:239], v9 offset0:56 offset1:60
CB_31:
    v_exp_f32 v129, v129
    v_smfmac_f32_32x32x32_bf16 v[144:159], v[68:71], v[120:127], v13
    v_exp_f32 v130, v130
    v_exp_f32 v131, v131
    v_exp_f32 v132, v132
    v_mfma_f32_32x32x16_bf16 v[112:127], v[32:35], v[160:163], 0
    v_exp_f32 v133, v133
    v_exp_f32 v134, v134
    v_exp_f32 v135, v135
    v_exp_f32 v136, v136
    v_exp_f32 v137, v137
    s_bitcmp1_b32 s5, 2
    s_cbranch_scc1 CB_32
    s_waitcnt lgkmcnt(4)
    v_pk_add_f32 v[244:245], v[244:245], v[246:247]
    v_pk_add_f32 v[248:249], v[248:249], v[250:251]
    v_pk_add_f32 v[244:245], v[244:245], v[248:249]
    v_add_f32 v245, v244, v245
    v_rcp_f32 v244, v245
    s_waitcnt lgkmcnt(0)
    v_pk_add_f32 v[224:225], v[224:225], v[226:227]
    v_pk_add_f32 v[228:229], v[228:229], v[230:231]
    v_pk_add_f32 v[232:233], v[232:233], v[234:235]
    v_pk_add_f32 v[236:237], v[236:237], v[238:239]
    v_pk_add_f32 v[224:225], v[224:225], v[228:229]
    v_pk_add_f32 v[232:233], v[232:233], v[236:237]
    v_pk_add_f32 v[224:225], v[224:225], v[232:233]
    v_mul_f32 v224, v224, v244
    v_mul_f32 v225, v225, v244
    v_cvt_pk_bf16_f32 v226, v224, v225
    ds_write_b32 v10, v226 offset:1024
    v_fma_f32 v245, v224, 0, v245
    v_fma_f32 v245, v225, 0, v245
    v_subrev_u32 v245, 0x1f800000, v245
    v_cmp_le_u32 vcc, 2.0, v245
    s_cbranch_vccnz CB_32_B
CB_32:
    v_exp_f32 v138, v138
    v_smfmac_f32_32x32x32_bf16 v[144:159], v[72:75], v[128:135], v13
    v_exp_f32 v139, v139
    s_add_u32 s49, s56, 3072
    s_and_b32 s49, s49, 8191
    s_lshl_b32 s49, s49, 6
    s_add_u32 s49, s49, s57
    s_add_u32 s50, s49, 32768
    s_add_u32 s31, s30, s5
    s_mul_i32 s43, s31, 112
    s_lshl_b32 s31, s31, 15
    s_add_u32 s31, s31, 6291456
    s_lshl_b32 s29, s29, 12
    v_exp_f32 v140, v140
    v_exp_f32 v141, v141
    s_waitcnt lgkmcnt(0)
    s_waitcnt vmcnt(11)
    v_mfma_f32_16x16x32_bf16 v[168:171], v[184:187], v[216:219], v[168:171]
    buffer_load_dwordx4 v[184:187], v6, s[8:11], s49 offen offset:0 sc1
    v_exp_f32 v142, v142
    v_exp_f32 v143, v143
    v_exp_f32 v112, v112
    v_exp_f32 v113, v113
    v_smfmac_f32_32x32x32_bf16 v[144:159], v[76:79], v[136:143], v13
    v_exp_f32 v114, v114
    v_exp_f32 v115, v115
    v_exp_f32 v116, v116
    v_mfma_f32_32x32x16_bf16 v[128:143], v[36:39], v[160:163], 0
    v_exp_f32 v117, v117
    v_exp_f32 v118, v118
    v_exp_f32 v119, v119
    v_exp_f32 v120, v120
    s_add_u32 m0, s54, 28736
    s_nop 0
    buffer_load_dwordx4 v12, s[12:15], s51 offen lds
    v_exp_f32 v121, v121
    v_exp_f32 v122, v122
    v_smfmac_f32_32x32x32_bf16 v[144:159], v[80:83], v[112:119], v13
    v_exp_f32 v123, v123
    s_add_u32 s66, s31, s29
    s_add_u32 s29, s29, 4096
    s_and_b32 s29, s29, 0x7fff
    v_exp_f32 v124, v124
    v_exp_f32 v125, v125
    v_mfma_f32_16x16x32_bf16 v[172:175], v[188:191], v[216:219], v[172:175]
    buffer_load_dwordx4 v[188:191], v6, s[8:11], s49 offen offset:1024 sc1
    v_exp_f32 v126, v126
    v_exp_f32 v127, v127
    s_setprio 2
    v_exp_f32 v128, v128
    v_exp_f32 v129, v129
    v_smfmac_f32_32x32x32_bf16 v[144:159], v[84:87], v[120:127], v13
    v_exp_f32 v130, v130
    v_exp_f32 v131, v131
    v_exp_f32 v132, v132
    v_mfma_f32_32x32x16_bf16 v[112:127], v[40:43], v[160:163], 0
    v_exp_f32 v133, v133
    v_exp_f32 v134, v134
    v_exp_f32 v135, v135
    v_exp_f32 v136, v136
    v_exp_f32 v137, v137
    v_exp_f32 v138, v138
    v_smfmac_f32_32x32x32_bf16 v[144:159], v[88:91], v[128:135], v13
    v_exp_f32 v139, v139
    s_add_u32 s67, s31, s29
    s_add_u32 s29, s29, 4096
    s_and_b32 s29, s29, 0x7fff
    v_exp_f32 v140, v140
    v_exp_f32 v141, v141
    s_waitcnt vmcnt(11)
    v_mfma_f32_16x16x32_bf16 v[176:179], v[192:195], v[216:219], v[176:179]
    buffer_load_dwordx4 v[192:195], v6, s[8:11], s49 offen offset:2048 sc1
    v_exp_f32 v142, v142
    v_exp_f32 v143, v143
    v_exp_f32 v112, v112
    v_exp_f32 v113, v113
    v_smfmac_f32_32x32x32_bf16 v[144:159], v[92:95], v[136:143], v13
    v_exp_f32 v114, v114
    v_exp_f32 v115, v115
    v_exp_f32 v116, v116
    v_mfma_f32_32x32x16_bf16 v[128:143], v[44:47], v[160:163], 0
    v_exp_f32 v117, v117
    v_exp_f32 v118, v118
    v_exp_f32 v119, v119
    v_exp_f32 v120, v120
    s_add_u32 m0, s54, 35920
    s_add_u32 s60, s51, 229376
    buffer_load_dwordx4 v12, s[16:19], s51 offen lds
    s_cmp_eq_u32 s60, 1835008
    s_cselect_b32 s51, 0, s60
    v_exp_f32 v121, v121
    v_exp_f32 v122, v122
    v_smfmac_f32_32x32x32_bf16 v[144:159], v[96:99], v[112:119], v13
    v_exp_f32 v123, v123
    s_add_u32 s68, s31, s29
    s_add_u32 s29, s29, 4096
    s_and_b32 s29, s29, 0x7fff
    v_exp_f32 v124, v124
    v_exp_f32 v125, v125
    v_mfma_f32_16x16x32_bf16 v[180:183], v[196:199], v[216:219], v[180:183]
    buffer_load_dwordx4 v[196:199], v6, s[8:11], s49 offen offset:3072 sc1
    v_exp_f32 v126, v126
    v_exp_f32 v127, v127
    s_setprio 1
    v_exp_f32 v128, v128
    v_exp_f32 v129, v129
    v_smfmac_f32_32x32x32_bf16 v[144:159], v[100:103], v[120:127], v13
    v_exp_f32 v130, v130
    v_exp_f32 v131, v131
    s_waitcnt vmcnt(8)
    v_exp_f32 v132, v132
    v_mfma_f32_32x32x16_bf16 v[112:127], v[16:19], v[164:167], 0
    v_exp_f32 v133, v133
    v_exp_f32 v134, v134
    v_exp_f32 v135, v135
    v_exp_f32 v136, v136
    v_exp_f32 v137, v137
    v_exp_f32 v138, v138
    v_smfmac_f32_32x32x32_bf16 v[144:159], v[104:107], v[128:135], v13
    v_exp_f32 v139, v139
    s_add_u32 s69, s31, s29
    s_add_u32 s29, s29, 4096
    s_and_b32 s29, s29, 0x7fff
    v_exp_f32 v140, v140
    v_exp_f32 v141, v141
    s_waitcnt vmcnt(11)
    v_mfma_f32_16x16x32_bf16 v[168:171], v[200:203], v[220:223], v[168:171]
    buffer_load_dwordx4 v[200:203], v6, s[8:11], s50 offen offset:0 sc1
    v_exp_f32 v142, v142
    v_exp_f32 v143, v143
    v_exp_f32 v112, v112
    v_exp_f32 v113, v113
    v_smfmac_f32_32x32x32_bf16 v[144:159], v[108:111], v[136:143], v13
    v_exp_f32 v114, v114
    v_exp_f32 v115, v115
    v_exp_f32 v116, v116
    v_mfma_f32_32x32x16_bf16 v[128:143], v[20:23], v[164:167], 0
    v_exp_f32 v117, v117
    v_exp_f32 v118, v118
    v_exp_f32 v119, v119
    v_exp_f32 v120, v120
    s_add_u32 m0, s54, 43104
    s_nop 0
    buffer_load_dwordx4 v12, s[12:15], s51 offen lds
    v_exp_f32 v121, v121
    v_exp_f32 v122, v122
    v_exp_f32 v123, v123
    s_add_u32 s70, s31, s29
    s_add_u32 s29, s29, 4096
    s_and_b32 s29, s29, 0x7fff
    v_exp_f32 v124, v124
    ds_write_b128 v8, v[144:147] offset:0
    v_exp_f32 v125, v125
    ds_write_b128 v8, v[148:151] offset:1024
    v_mfma_f32_16x16x32_bf16 v[172:175], v[204:207], v[220:223], v[172:175]
    buffer_load_dwordx4 v[204:207], v6, s[8:11], s50 offen offset:1024 sc1
    v_exp_f32 v126, v126
    s_mov_b32 exec_hi, 0
    ds_write_b32 v252, v152 offset:512
    s_mov_b32 exec_hi, -1
    v_exp_f32 v127, v127
    v_mfma_f32_32x32x16_bf16 v[144:159], v[240:243], v[240:243], 0
    v_smfmac_f32_32x32x32_bf16 v[144:159], v[48:51], v[112:119], v13
    s_setprio 0
    v_exp_f32 v128, v128
    v_exp_f32 v129, v129
    v_smfmac_f32_32x32x32_bf16 v[144:159], v[52:55], v[120:127], v13
    v_exp_f32 v130, v130
    v_exp_f32 v131, v131
    v_exp_f32 v132, v132
    v_mfma_f32_32x32x16_bf16 v[112:127], v[24:27], v[164:167], 0
    v_exp_f32 v133, v133
    v_exp_f32 v134, v134
    v_exp_f32 v135, v135
    v_exp_f32 v136, v136
    v_exp_f32 v137, v137
    v_exp_f32 v138, v138
    v_smfmac_f32_32x32x32_bf16 v[144:159], v[56:59], v[128:135], v13
    v_exp_f32 v139, v139
    s_add_u32 s71, s31, s29
    s_add_u32 s29, s29, 4096
    s_and_b32 s29, s29, 0x7fff
    v_exp_f32 v140, v140
    v_exp_f32 v141, v141
    s_waitcnt vmcnt(9)
    v_mfma_f32_16x16x32_bf16 v[176:179], v[208:211], v[220:223], v[176:179]
    buffer_load_dwordx4 v[208:211], v6, s[8:11], s50 offen offset:2048 sc1
    v_exp_f32 v142, v142
    v_exp_f32 v143, v143
    s_setprio 3
    v_exp_f32 v112, v112
    v_exp_f32 v113, v113
    v_smfmac_f32_32x32x32_bf16 v[144:159], v[60:63], v[136:143], v13
    v_exp_f32 v114, v114
    s_add_u32 s48, s56, 6144
    s_and_b32 s48, s48, 8191
    s_add_u32 s48, s48, s55
    v_exp_f32 v115, v115
    buffer_load_dwordx4 v[160:163], v6, s[8:11], s48 offen sc1
    v_exp_f32 v116, v116
    v_mfma_f32_32x32x16_bf16 v[128:143], v[28:31], v[164:167], 0
    v_exp_f32 v117, v117
    v_exp_f32 v118, v118
    v_exp_f32 v119, v119
    v_exp_f32 v120, v120
    s_add_u32 m0, s54, 50288
    s_add_u32 s60, s51, 229376
    buffer_load_dwordx4 v12, s[16:19], s51 offen lds
    s_cmp_eq_u32 s60, 1835008
    s_cselect_b32 s51, 0, s60
    v_exp_f32 v121, v121
    v_exp_f32 v122, v122
    v_smfmac_f32_32x32x32_bf16 v[144:159], v[64:67], v[112:119], v13
    v_exp_f32 v123, v123
    ds_read_b32 v251, v14 offset:512
    s_add_u32 s72, s31, s29
    s_add_u32 s29, s29, 4096
    s_and_b32 s29, s29, 0x7fff
    v_exp_f32 v124, v124
    v_exp_f32 v125, v125
    v_mfma_f32_16x16x32_bf16 v[180:183], v[212:215], v[220:223], v[180:183]
    buffer_load_dwordx4 v[212:215], v6, s[8:11], s50 offen offset:3072 sc1
    v_exp_f32 v126, v126
    v_exp_f32 v127, v127
    s_waitcnt lgkmcnt(0)
    v_cmp_eq_u32 vcc, 0xff800000, v251
    s_cbranch_vccnz FW_5
FW_R5:
    s_mov_b64 exec, s[94:95]
    ds_read_b128 v[216:219], v11 offset:1024
    ds_read_b128 v[220:223], v11 offset:1536
    s_mov_b64 exec, -1
    v_exp_f32 v128, v128
    s_bitcmp0_b32 s5, 2
    s_cbranch_scc1 CB_33
    ds_read2st64_b32 v[244:245], v253 offset0:2 offset1:6
    ds_read2st64_b32 v[246:247], v253 offset0:10 offset1:14
    ds_read2st64_b32 v[248:249], v253 offset0:18 offset1:22
    ds_read2st64_b32 v[250:251], v253 offset0:26 offset1:30
    ds_read2st64_b64 v[224:227], v9 offset0:0 offset1:4
    ds_read2st64_b64 v[228:231], v9 offset0:8 offset1:12
    ds_read2st64_b64 v[232:235], v9 offset0:16 offset1:20
    ds_read2st64_b64 v[236:239], v9 offset0:24 offset1:28
CB_33:
    v_exp_f32 v129, v129
    v_smfmac_f32_32x32x32_bf16 v[144:159], v[68:71], v[120:127], v13
    v_exp_f32 v130, v130
    v_exp_f32 v131, v131
    v_exp_f32 v132, v132
    v_mfma_f32_32x32x16_bf16 v[112:127], v[32:35], v[164:167], 0
    v_exp_f32 v133, v133
    v_exp_f32 v134, v134
    v_exp_f32 v135, v135
    v_exp_f32 v136, v136
    v_exp_f32 v137, v137
    s_bitcmp0_b32 s5, 2
    s_cbranch_scc1 CB_34
    s_waitcnt lgkmcnt(4)
    v_pk_add_f32 v[244:245], v[244:245], v[246:247]
    v_pk_add_f32 v[248:249], v[248:249], v[250:251]
    v_pk_add_f32 v[244:245], v[244:245], v[248:249]
    v_add_f32 v245, v244, v245
    v_rcp_f32 v244, v245
    s_waitcnt lgkmcnt(0)
    v_pk_add_f32 v[224:225], v[224:225], v[226:227]
    v_pk_add_f32 v[228:229], v[228:229], v[230:231]
    v_pk_add_f32 v[232:233], v[232:233], v[234:235]
    v_pk_add_f32 v[236:237], v[236:237], v[238:239]
    v_pk_add_f32 v[224:225], v[224:225], v[228:229]
    v_pk_add_f32 v[232:233], v[232:233], v[236:237]
    v_pk_add_f32 v[224:225], v[224:225], v[232:233]
    v_mul_f32 v224, v224, v244
    v_mul_f32 v225, v225, v244
    v_cvt_pk_bf16_f32 v226, v224, v225
    ds_write_b32 v10, v226 offset:0
    v_fma_f32 v245, v224, 0, v245
    v_fma_f32 v245, v225, 0, v245
    v_subrev_u32 v245, 0x1f800000, v245
    v_cmp_le_u32 vcc, 2.0, v245
    s_cbranch_vccnz CB_34_B
CB_34:
    v_exp_f32 v138, v138
    v_smfmac_f32_32x32x32_bf16 v[144:159], v[72:75], v[128:135], v13
    v_exp_f32 v139, v139
    s_add_u32 s49, s56, 4096
    s_and_b32 s49, s49, 8191
    s_lshl_b32 s49, s49, 6
    s_add_u32 s49, s49, s57
    s_add_u32 s50, s49, 32768
    s_add_u32 s73, s31, s29
    v_exp_f32 v140, v140
    v_exp_f32 v141, v141
    s_waitcnt lgkmcnt(0)
    s_waitcnt vmcnt(10)
    v_mfma_f32_16x16x32_bf16 v[168:171], v[184:187], v[216:219], v[168:171]
    buffer_load_dwordx4 v[184:187], v6, s[8:11], s49 offen offset:0 sc1
    v_exp_f32 v142, v142
    v_exp_f32 v143, v143
    v_exp_f32 v112, v112
    v_exp_f32 v113, v113
    v_smfmac_f32_32x32x32_bf16 v[144:159], v[76:79], v[136:143], v13
    v_exp_f32 v114, v114
    v_lshrrev_b32 v15, 4, v1
    v_lshlrev_b32 v15, 11, v15
    v_and_b32 v2, 15, v1
    v_lshl_add_u32 v15, v2, 4, v15
    s_lshl_b32 s39, s5, 8
    s_add_u32 s39, s39, 20480
    v_exp_f32 v115, v115
    buffer_load_dwordx4 v[2:5], v15, s[8:11], s39 offen sc1
    v_exp_f32 v116, v116
    v_mfma_f32_32x32x16_bf16 v[128:143], v[36:39], v[164:167], 0
    v_exp_f32 v117, v117
    v_exp_f32 v118, v118
    v_exp_f32 v119, v119
    v_exp_f32 v120, v120
    s_add_u32 m0, s54, 0
    s_nop 0
    buffer_load_dwordx4 v12, s[12:15], s51 offen lds
    v_exp_f32 v121, v121
    v_exp_f32 v122, v122
    v_smfmac_f32_32x32x32_bf16 v[144:159], v[80:83], v[112:119], v13
    v_exp_f32 v123, v123
    s_mul_i32 s60, s4, 7
    s_add_u32 s60, s60, 1
    s_lshr_b32 s60, s60, 1
    s_add_u32 s43, s43, s60
    v_exp_f32 v124, v124
    v_exp_f32 v125, v125
    v_mfma_f32_16x16x32_bf16 v[172:175], v[188:191], v[216:219], v[172:175]
    buffer_load_dwordx4 v[188:191], v6, s[8:11], s49 offen offset:1024 sc1
    v_exp_f32 v126, v126
    v_exp_f32 v127, v127
    s_setprio 2
    v_exp_f32 v128, v128
    v_exp_f32 v129, v129
    v_smfmac_f32_32x32x32_bf16 v[144:159], v[84:87], v[120:127], v13
    v_exp_f32 v130, v130
    v_exp_f32 v131, v131
    v_exp_f32 v132, v132
    v_mfma_f32_32x32x16_bf16 v[112:127], v[40:43], v[164:167], 0
    v_exp_f32 v133, v133
    v_exp_f32 v134, v134
    v_exp_f32 v135, v135
    v_exp_f32 v136, v136
    v_exp_f32 v137, v137
    v_exp_f32 v138, v138
    v_smfmac_f32_32x32x32_bf16 v[144:159], v[88:91], v[128:135], v13
    v_exp_f32 v139, v139
    s_lshl_b32 s43, s43, 10
    s_add_u32 s43, s43, 8388608
    s_movk_i32 s47, 3072
    v_exp_f32 v140, v140
    v_exp_f32 v141, v141
    s_waitcnt vmcnt(11)
    v_mfma_f32_16x16x32_bf16 v[176:179], v[192:195], v[216:219], v[176:179]
    buffer_load_dwordx4 v[192:195], v6, s[8:11], s49 offen offset:2048 sc1
    v_exp_f32 v142, v142
    v_exp_f32 v143, v143
    v_exp_f32 v112, v112
    v_exp_f32 v113, v113
    v_smfmac_f32_32x32x32_bf16 v[144:159], v[92:95], v[136:143], v13
    v_exp_f32 v114, v114
    v_exp_f32 v115, v115
    v_exp_f32 v116, v116
    v_mfma_f32_32x32x16_bf16 v[128:143], v[44:47], v[164:167], 0
    v_exp_f32 v117, v117
    v_exp_f32 v118, v118
    v_exp_f32 v119, v119
    v_exp_f32 v120, v120
    s_add_u32 m0, s54, 7184
    s_add_u32 s60, s51, 229376
    buffer_load_dwordx4 v12, s[16:19], s51 offen lds
    s_cmp_eq_u32 s60, 1835008
    s_cselect_b32 s51, 0, s60
    v_exp_f32 v121, v121
    v_exp_f32 v122, v122
    v_smfmac_f32_32x32x32_bf16 v[144:159], v[96:99], v[112:119], v13
    v_exp_f32 v123, v123
    s_bitcmp1_b32 s4, 0
    s_cselect_b32 s84, 16, 0
    s_cselect_b32 s85, 0, 96
    s_cselect_b32 s47, -512, s47
    s_add_u32 s47, s47, s43
    v_exp_f32 v124, v124
    v_exp_f32 v125, v125
    v_mfma_f32_16x16x32_bf16 v[180:183], v[196:199], v[216:219], v[180:183]
    buffer_load_dwordx4 v[196:199], v6, s[8:11], s49 offen offset:3072 sc1
    v_exp_f32 v126, v126
    v_exp_f32 v127, v127
    s_setprio 1
    v_exp_f32 v128, v128
    v_exp_f32 v129, v129
    v_smfmac_f32_32x32x32_bf16 v[144:159], v[100:103], v[120:127], v13
    v_exp_f32 v130, v130
    v_exp_f32 v131, v131
    s_waitcnt vmcnt(9)
    v_exp_f32 v132, v132
    v_mfma_f32_32x32x16_bf16 v[112:127], v[16:19], v[160:163], 0
    v_exp_f32 v133, v133
    v_exp_f32 v134, v134
    v_exp_f32 v135, v135
    v_exp_f32 v136, v136
    v_exp_f32 v137, v137
    v_exp_f32 v138, v138
    v_smfmac_f32_32x32x32_bf16 v[144:159], v[104:107], v[128:135], v13
    v_exp_f32 v139, v139
    s_lshr_b32 s28, s4, 2
    s_add_u32 s28, s28, s30
    s_lshl_b32 s28, s28, 3
    s_add_u32 s28, s28, s5
    v_exp_f32 v140, v140
    v_exp_f32 v141, v141
    s_waitcnt vmcnt(11)
    v_mfma_f32_16x16x32_bf16 v[168:171], v[200:203], v[220:223], v[168:171]
    buffer_load_dwordx4 v[200:203], v6, s[8:11], s50 offen offset:0 sc1
    v_exp_f32 v142, v142
    v_exp_f32 v143, v143
    v_exp_f32 v112, v112
    v_exp_f32 v113, v113
    v_smfmac_f32_32x32x32_bf16 v[144:159], v[108:111], v[136:143], v13
    v_exp_f32 v114, v114
    v_exp_f32 v115, v115
    v_exp_f32 v116, v116
    v_mfma_f32_32x32x16_bf16 v[128:143], v[20:23], v[160:163], 0
    v_exp_f32 v117, v117
    v_exp_f32 v118, v118
    v_exp_f32 v119, v119
    v_exp_f32 v120, v120
    s_add_u32 m0, s54, 14368
    s_nop 0
    buffer_load_dwordx4 v12, s[12:15], s51 offen lds
    v_exp_f32 v121, v121
    v_exp_f32 v122, v122
    v_exp_f32 v123, v123
    s_lshl_b32 s28, s28, 5
    s_and_b32 s60, s4, 3
    s_add_u32 s28, s28, s60
    s_lshl_b32 s28, s28, 7
    s_add_u32 s28, s28, 6291456
    v_exp_f32 v124, v124
    ds_write_b128 v8, v[144:147] offset:16384
    v_exp_f32 v125, v125
    ds_write_b128 v8, v[148:151] offset:17408
    v_mfma_f32_16x16x32_bf16 v[172:175], v[204:207], v[220:223], v[172:175]
    buffer_load_dwordx4 v[204:207], v6, s[8:11], s50 offen offset:1024 sc1
    v_exp_f32 v126, v126
    s_mov_b32 exec_hi, 0
    ds_write_b32 v252, v152 offset:640
    s_mov_b32 exec_hi, -1
    v_exp_f32 v127, v127
    v_mfma_f32_32x32x16_bf16 v[144:159], v[240:243], v[240:243], 0
    v_smfmac_f32_32x32x32_bf16 v[144:159], v[48:51], v[112:119], v13
    s_setprio 0
    v_exp_f32 v128, v128
    v_exp_f32 v129, v129
    v_smfmac_f32_32x32x32_bf16 v[144:159], v[52:55], v[120:127], v13
    v_exp_f32 v130, v130
    v_exp_f32 v131, v131
    v_exp_f32 v132, v132
    v_mfma_f32_32x32x16_bf16 v[112:127], v[24:27], v[160:163], 0
    v_exp_f32 v133, v133
    v_exp_f32 v134, v134
    v_exp_f32 v135, v135
    v_exp_f32 v136, v136
    v_exp_f32 v137, v137
    v_exp_f32 v138, v138
    v_smfmac_f32_32x32x32_bf16 v[144:159], v[56:59], v[128:135], v13
    v_exp_f32 v139, v139
    v_exp_f32 v140, v140
    v_exp_f32 v141, v141
    s_waitcnt vmcnt(10)
    v_mfma_f32_16x16x32_bf16 v[176:179], v[208:211], v[220:223], v[176:179]
    buffer_load_dwordx4 v[208:211], v6, s[8:11], s50 offen offset:2048 sc1
    v_exp_f32 v142, v142
    v_exp_f32 v143, v143
    s_setprio 3
    v_exp_f32 v112, v112
    v_exp_f32 v113, v113
    v_smfmac_f32_32x32x32_bf16 v[144:159], v[60:63], v[136:143], v13
    v_exp_f32 v114, v114
    s_add_u32 s48, s56, 7168
    s_and_b32 s48, s48, 8191
    s_add_u32 s48, s48, s55
    v_exp_f32 v115, v115
    buffer_load_dwordx4 v[164:167], v6, s[8:11], s48 offen sc1
    v_exp_f32 v116, v116
    v_mfma_f32_32x32x16_bf16 v[128:143], v[28:31], v[160:163], 0
    v_exp_f32 v117, v117
    v_exp_f32 v118, v118
    v_exp_f32 v119, v119
    v_exp_f32 v120, v120
    s_add_u32 m0, s54, 21552
    s_add_u32 s60, s51, 229376
    buffer_load_dwordx4 v12, s[16:19], s51 offen lds
    s_cmp_eq_u32 s60, 1835008
    s_cselect_b32 s51, 0, s60
    v_exp_f32 v121, v121
    v_exp_f32 v122, v122
    v_smfmac_f32_32x32x32_bf16 v[144:159], v[64:67], v[112:119], v13
    v_exp_f32 v123, v123
    ds_read_b32 v251, v14 offset:640
    v_exp_f32 v124, v124
    v_exp_f32 v125, v125
    v_mfma_f32_16x16x32_bf16 v[180:183], v[212:215], v[220:223], v[180:183]
    buffer_load_dwordx4 v[212:215], v6, s[8:11], s50 offen offset:3072 sc1
    v_exp_f32 v126, v126
    v_exp_f32 v127, v127
    s_waitcnt lgkmcnt(0)
    v_cmp_eq_u32 vcc, 0xff800000, v251
    s_cbranch_vccnz FW_6
FW_R6:
    s_mov_b64 exec, s[94:95]
    ds_read_b128 v[216:219], v11 offset:0
    ds_read_b128 v[220:223], v11 offset:512
    s_mov_b64 exec, -1
    v_exp_f32 v128, v128
    s_bitcmp1_b32 s5, 2
    s_cbranch_scc1 CB_35
    ds_read2st64_b32 v[244:245], v253 offset0:2 offset1:6
    ds_read2st64_b32 v[246:247], v253 offset0:10 offset1:14
    ds_read2st64_b32 v[248:249], v253 offset0:18 offset1:22
    ds_read2st64_b32 v[250:251], v253 offset0:26 offset1:30
    ds_read2st64_b64 v[224:227], v9 offset0:32 offset1:36
    ds_read2st64_b64 v[228:231], v9 offset0:40 offset1:44
    ds_read2st64_b64 v[232:235], v9 offset0:48 offset1:52
    ds_read2st64_b64 v[236:239], v9 offset0:56 offset1:60
CB_35:
    v_exp_f32 v129, v129
    v_smfmac_f32_32x32x32_bf16 v[144:159], v[68:71], v[120:127], v13
    v_exp_f32 v130, v130
    v_exp_f32 v131, v131
    v_exp_f32 v132, v132
    v_mfma_f32_32x32x16_bf16 v[112:127], v[32:35], v[160:163], 0
    v_exp_f32 v133, v133
    v_exp_f32 v134, v134
    v_exp_f32 v135, v135
    v_exp_f32 v136, v136
    v_exp_f32 v137, v137
    s_bitcmp1_b32 s5, 2
    s_cbranch_scc1 CB_36
    s_waitcnt lgkmcnt(4)
    v_pk_add_f32 v[244:245], v[244:245], v[246:247]
    v_pk_add_f32 v[248:249], v[248:249], v[250:251]
    v_pk_add_f32 v[244:245], v[244:245], v[248:249]
    v_add_f32 v245, v244, v245
    v_rcp_f32 v244, v245
    s_waitcnt lgkmcnt(0)
    v_pk_add_f32 v[224:225], v[224:225], v[226:227]
    v_pk_add_f32 v[228:229], v[228:229], v[230:231]
    v_pk_add_f32 v[232:233], v[232:233], v[234:235]
    v_pk_add_f32 v[236:237], v[236:237], v[238:239]
    v_pk_add_f32 v[224:225], v[224:225], v[228:229]
    v_pk_add_f32 v[232:233], v[232:233], v[236:237]
    v_pk_add_f32 v[224:225], v[224:225], v[232:233]
    v_mul_f32 v224, v224, v244
    v_mul_f32 v225, v225, v244
    v_cvt_pk_bf16_f32 v226, v224, v225
    ds_write_b32 v10, v226 offset:1024
    v_fma_f32 v245, v224, 0, v245
    v_fma_f32 v245, v225, 0, v245
    v_subrev_u32 v245, 0x1f800000, v245
    v_cmp_le_u32 vcc, 2.0, v245
    s_cbranch_vccnz CB_36_B
CB_36:
    v_exp_f32 v138, v138
    v_smfmac_f32_32x32x32_bf16 v[144:159], v[72:75], v[128:135], v13
    v_exp_f32 v139, v139
    s_add_u32 s49, s56, 5120
    s_and_b32 s49, s49, 8191
    s_lshl_b32 s49, s49, 6
    s_add_u32 s49, s49, s57
    s_add_u32 s50, s49, 32768
    v_exp_f32 v140, v140
    v_exp_f32 v141, v141
    s_waitcnt lgkmcnt(0)
    s_waitcnt vmcnt(10)
    v_mfma_f32_16x16x32_bf16 v[168:171], v[184:187], v[216:219], v[168:171]
    buffer_load_dwordx4 v[184:187], v6, s[8:11], s49 offen offset:0 sc1
    v_exp_f32 v142, v142
    v_exp_f32 v143, v143
    v_exp_f32 v112, v112
    v_exp_f32 v113, v113
    v_smfmac_f32_32x32x32_bf16 v[144:159], v[76:79], v[136:143], v13
    v_exp_f32 v114, v114
    v_exp_f32 v115, v115
    v_exp_f32 v116, v116
    v_mfma_f32_32x32x16_bf16 v[128:143], v[36:39], v[160:163], 0
    v_exp_f32 v117, v117
    v_exp_f32 v118, v118
    v_exp_f32 v119, v119
    v_exp_f32 v120, v120
    s_mov_b32 s24, s80
    s_mov_b32 s25, s81
    s_mov_b32 s26, 1835008
    s_mov_b32 s27, 0x00020000
    s_lshr_b32 s60, s4, 3
    s_lshl_b32 s60, s60, 3
    s_add_u32 s60, s60, s5
    s_mul_i32 s60, s60, 7
    s_add_u32 s60, s60, 4
    s_lshr_b32 s60, s60, 1
    s_lshl_b32 s60, s60, 14
    s_and_b32 s61, s4, 7
    s_lshl_b32 s61, s61, 7
    s_add_u32 s60, s60, s61
    v_and_b32 v254, 1, v1
    v_mul_i32_i24 v254, 0xfffffe40, v254
    v_lshl_add_u32 v254, v1, 9, v254
    buffer_load_dword v254, v254, s[24:27], s60 offen
    v_exp_f32 v121, v121
    v_exp_f32 v122, v122
    v_smfmac_f32_32x32x32_bf16 v[144:159], v[80:83], v[112:119], v13
    v_exp_f32 v123, v123
    v_exp_f32 v124, v124
    v_exp_f32 v125, v125
    v_mfma_f32_16x16x32_bf16 v[172:175], v[188:191], v[216:219], v[172:175]
    buffer_load_dwordx4 v[188:191], v6, s[8:11], s49 offen offset:1024 sc1
    v_exp_f32 v126, v126
    v_exp_f32 v127, v127
    s_setprio 2
    v_exp_f32 v128, v128
    v_exp_f32 v129, v129
    v_smfmac_f32_32x32x32_bf16 v[144:159], v[84:87], v[120:127], v13
    v_exp_f32 v130, v130
    s_waitcnt vmcnt(15)
    v_perm_b32 v244, v3, v2, s58
    v_perm_b32 v245, v5, v4, s59
    v_or_b32 v244, v244, v245
    v_cmp_ne_u32 vcc, s6, v244
    s_cbranch_vccnz MC_37
MC_37_R:
    v_and_b32 v2, 0xffff0000, v2
    v_and_b32 v3, 0xffff0000, v3
    v_and_b32 v4, 0xffff0000, v4
    v_and_b32 v5, 0xffff0000, v5
    s_mov_b32 exec_lo, 0xffff0000
    s_mov_b32 exec_hi, 0xffff
    v_mul_f32 v2, 0xbfb8aa3b, v2
    v_mul_f32 v3, 0xbfb8aa3b, v3
    v_mul_f32 v4, 0xbfb8aa3b, v4
    v_mul_f32 v5, 0xbfb8aa3b, v5
    s_mov_b64 exec, -1
    v_exp_f32 v131, v131
    v_exp_f32 v132, v132
    v_mfma_f32_32x32x16_bf16 v[112:127], v[40:43], v[160:163], 0
    v_exp_f32 v133, v133
    v_exp_f32 v134, v134
    v_exp_f32 v135, v135
    v_exp_f32 v136, v136
    v_exp_f32 v137, v137
    v_exp_f32 v138, v138
    v_smfmac_f32_32x32x32_bf16 v[144:159], v[88:91], v[128:135], v13
    v_exp_f32 v139, v139
    v_exp_f32 v140, v140
    v_exp_f32 v141, v141
    s_waitcnt vmcnt(10)
    v_mfma_f32_16x16x32_bf16 v[176:179], v[192:195], v[216:219], v[176:179]
    buffer_load_dwordx4 v[192:195], v6, s[8:11], s49 offen offset:2048 sc1
    v_exp_f32 v142, v142
    v_exp_f32 v143, v143
    v_exp_f32 v112, v112
    v_exp_f32 v113, v113
    v_smfmac_f32_32x32x32_bf16 v[144:159], v[92:95], v[136:143], v13
    v_exp_f32 v114, v114
    v_exp_f32 v115, v115
    v_exp_f32 v116, v116
    v_mfma_f32_32x32x16_bf16 v[128:143], v[44:47], v[160:163], 0
    v_exp_f32 v117, v117
    v_lshrrev_b32 v0, 3, v1
    v_and_b32 v7, 7, v1
    v_bfe_u32 v12, v1, 4, 1
    v_lshlrev_b32 v12, 2, v12
    v_xor_b32 v7, v7, v12
    v_lshlrev_b32 v12, 10, v0
    s_and_b32 s60, s4, 7
    s_lshl_b32 s61, s60, 7
    v_lshl_add_u32 v7, v7, 4, s61
    s_lshr_b32 s62, s5, 2
    s_mul_i32 s62, s62, 8224
    v_add_u32 v7, v7, v12
    v_xor_b32 v12, s62, v7
    v_exp_f32 v118, v118
    v_exp_f32 v119, v119
    v_exp_f32 v120, v120
    v_exp_f32 v121, v121
    v_exp_f32 v122, v122
    v_smfmac_f32_32x32x32_bf16 v[144:159], v[96:99], v[112:119], v13
    v_exp_f32 v123, v123
    v_exp_f32 v124, v124
    v_exp_f32 v125, v125
    v_mfma_f32_16x16x32_bf16 v[180:183], v[196:199], v[216:219], v[180:183]
    buffer_load_dwordx4 v[196:199], v6, s[8:11], s49 offen offset:3072 sc1
    v_exp_f32 v126, v126
    v_exp_f32 v127, v127
    s_setprio 1
    v_exp_f32 v128, v128
    v_exp_f32 v129, v129
    v_smfmac_f32_32x32x32_bf16 v[144:159], v[100:103], v[120:127], v13
    v_exp_f32 v130, v130
    v_exp_f32 v131, v131
    s_waitcnt vmcnt(7)
    v_exp_f32 v132, v132
    v_mfma_f32_32x32x16_bf16 v[112:127], v[16:19], v[164:167], 0
    v_exp_f32 v133, v133
    s_mov_b32 s12, s86
    s_mov_b32 s13, s87
    s_mov_b32 s14, 2097152
    s_mov_b32 s15, 0x00020000
    v_exp_f32 v134, v134
    v_exp_f32 v135, v135
    v_exp_f32 v136, v136
    v_exp_f32 v137, v137
    v_exp_f32 v138, v138
    v_smfmac_f32_32x32x32_bf16 v[144:159], v[104:107], v[128:135], v13
    v_exp_f32 v139, v139
    v_exp_f32 v140, v140
    v_exp_f32 v141, v141
    s_waitcnt vmcnt(9)
    v_mfma_f32_16x16x32_bf16 v[168:171], v[200:203], v[220:223], v[168:171]
    buffer_load_dwordx4 v[200:203], v6, s[8:11], s50 offen offset:0 sc1
    v_exp_f32 v142, v142
    v_exp_f32 v143, v143
    v_exp_f32 v112, v112
    v_exp_f32 v113, v113
    v_smfmac_f32_32x32x32_bf16 v[144:159], v[108:111], v[136:143], v13
    v_exp_f32 v114, v114
    v_exp_f32 v115, v115
    v_exp_f32 v116, v116
    v_mfma_f32_32x32x16_bf16 v[128:143], v[20:23], v[164:167], 0
    v_exp_f32 v117, v117
    v_exp_f32 v118, v118
    v_exp_f32 v119, v119
    v_mfma_f32_16x16x32_bf16 v[172:175], v[204:207], v[220:223], v[172:175]
    buffer_load_dwordx4 v[204:207], v6, s[8:11], s50 offen offset:1024 sc1
    v_exp_f32 v120, v120
    v_exp_f32 v121, v121
    v_exp_f32 v122, v122
    v_exp_f32 v123, v123
    v_exp_f32 v124, v124
    ds_write_b128 v8, v[144:147] offset:0
    v_exp_f32 v125, v125
    ds_write_b128 v8, v[148:151] offset:1024
    s_waitcnt vmcnt(7)
    v_mfma_f32_16x16x32_bf16 v[176:179], v[208:211], v[220:223], v[176:179]
    buffer_load_dwordx4 v[208:211], v6, s[8:11], s50 offen offset:2048 sc1
    v_exp_f32 v126, v126
    s_mov_b32 exec_hi, 0
    ds_write_b32 v252, v152 offset:768
    s_mov_b32 exec_hi, -1
    v_exp_f32 v127, v127
    v_mfma_f32_32x32x16_bf16 v[144:159], v[240:243], v[240:243], 0
    v_smfmac_f32_32x32x32_bf16 v[144:159], v[48:51], v[112:119], v13
    s_setprio 0
    v_exp_f32 v128, v128
    v_exp_f32 v129, v129
    v_smfmac_f32_32x32x32_bf16 v[144:159], v[52:55], v[120:127], v13
    v_exp_f32 v130, v130
    s_add_u32 s36, s56, 7168
    s_and_b32 s36, s36, 8191
    s_lshl_b32 s36, s36, 6
    s_add_u32 s36, s36, s57
    s_add_u32 s37, s36, 32768
    v_exp_f32 v131, v131
    buffer_load_dwordx4 v[48:51], v6, s[8:11], s36 offen offset:0 sc1
    v_exp_f32 v132, v132
    v_mfma_f32_32x32x16_bf16 v[112:127], v[24:27], v[164:167], 0
    v_exp_f32 v133, v133
    s_mov_b32 s20, s64
    s_mov_b32 s21, s65
    s_mov_b32 s22, 2097152
    s_mov_b32 s23, 0x00020000
    v_and_b32 v24, 7, v1
    v_lshlrev_b32 v24, 10, v24
    v_bfe_u32 v25, v1, 3, 1
    v_lshrrev_b32 v26, 4, v1
    v_lshl_add_u32 v25, v25, 2, v26
    v_lshl_add_u32 v24, v25, 4, v24
    v_lshlrev_b32 v25, 5, v25
    s_sub_u32 s38, s55, 1048576
    s_lshl_b32 s39, s5, 7
    s_add_u32 s38, s38, s39
    s_lshl_b32 s39, s5, 11
    s_add_u32 s39, s39, 147456
    v_add_u32 v26, s39, v25
    s_lshl_b32 s39, s5, 8
    s_add_u32 s39, s39, 116800
    v_add_u32 v27, s39, v6
    v_exp_f32 v134, v134
    buffer_load_dwordx4 v[16:19], v24, s[20:23], s38 offen
    v_exp_f32 v135, v135
    v_mfma_f32_16x16x32_bf16 v[180:183], v[212:215], v[220:223], v[180:183]
    buffer_load_dwordx4 v[212:215], v6, s[8:11], s50 offen offset:3072 sc1
    v_exp_f32 v136, v136
    v_exp_f32 v137, v137
    buffer_load_dwordx4 v[52:55], v6, s[8:11], s36 offen offset:1024 sc1
    v_exp_f32 v138, v138
    v_smfmac_f32_32x32x32_bf16 v[144:159], v[56:59], v[128:135], v13
    v_exp_f32 v139, v139
    ds_read_b32 v251, v14 offset:768
    v_exp_f32 v140, v140
    v_exp_f32 v141, v141
    v_exp_f32 v142, v142
    v_exp_f32 v143, v143
    s_waitcnt lgkmcnt(0)
    v_cmp_eq_u32 vcc, 0xff800000, v251
    s_cbranch_vccnz FW_7
FW_R7:
    s_setprio 3
    s_mov_b64 exec, s[94:95]
    ds_read_b128 v[216:219], v11 offset:1024
    ds_read_b128 v[220:223], v11 offset:1536
    s_mov_b64 exec, -1
    v_exp_f32 v112, v112
    s_bitcmp0_b32 s5, 2
    s_cbranch_scc1 CB_38
    ds_read2st64_b32 v[244:245], v253 offset0:3 offset1:7
    ds_read2st64_b32 v[246:247], v253 offset0:11 offset1:15
    ds_read2st64_b32 v[248:249], v253 offset0:19 offset1:23
    ds_read2st64_b32 v[250:251], v253 offset0:27 offset1:31
    ds_read2st64_b64 v[224:227], v9 offset0:0 offset1:4
    ds_read2st64_b64 v[228:231], v9 offset0:8 offset1:12
    ds_read2st64_b64 v[232:235], v9 offset0:16 offset1:20
    ds_read2st64_b64 v[236:239], v9 offset0:24 offset1:28
CB_38:
    v_exp_f32 v113, v113
    v_smfmac_f32_32x32x32_bf16 v[144:159], v[60:63], v[136:143], v13
    v_exp_f32 v114, v114
    v_exp_f32 v115, v115
    v_exp_f32 v116, v116
    v_mfma_f32_32x32x16_bf16 v[128:143], v[28:31], v[164:167], 0
    v_exp_f32 v117, v117
    s_add_u32 s38, s38, 4194304
    v_exp_f32 v118, v118
    v_exp_f32 v119, v119
    v_exp_f32 v120, v120
    v_exp_f32 v121, v121
    s_bitcmp0_b32 s5, 2
    s_cbranch_scc1 CB_39
    s_waitcnt lgkmcnt(4)
    v_pk_add_f32 v[244:245], v[244:245], v[246:247]
    v_pk_add_f32 v[248:249], v[248:249], v[250:251]
    v_pk_add_f32 v[244:245], v[244:245], v[248:249]
    v_add_f32 v245, v244, v245
    v_rcp_f32 v244, v245
    s_waitcnt lgkmcnt(0)
    v_pk_add_f32 v[224:225], v[224:225], v[226:227]
    v_pk_add_f32 v[228:229], v[228:229], v[230:231]
    v_pk_add_f32 v[232:233], v[232:233], v[234:235]
    v_pk_add_f32 v[236:237], v[236:237], v[238:239]
    v_pk_add_f32 v[224:225], v[224:225], v[228:229]
    v_pk_add_f32 v[232:233], v[232:233], v[236:237]
    v_pk_add_f32 v[224:225], v[224:225], v[232:233]
    v_mul_f32 v224, v224, v244
    v_mul_f32 v225, v225, v244
    v_cvt_pk_bf16_f32 v226, v224, v225
    ds_write_b32 v10, v226 offset:0
    v_fma_f32 v245, v224, 0, v245
    v_fma_f32 v245, v225, 0, v245
    v_subrev_u32 v245, 0x1f800000, v245
    v_cmp_le_u32 vcc, 2.0, v245
    s_cbranch_vccnz CB_39_B
CB_39:
    v_exp_f32 v122, v122
    v_smfmac_f32_32x32x32_bf16 v[144:159], v[64:67], v[112:119], v13
    v_exp_f32 v123, v123
    s_add_u32 s49, s56, 6144
    s_and_b32 s49, s49, 8191
    s_lshl_b32 s49, s49, 6
    s_add_u32 s49, s49, s57
    s_add_u32 s50, s49, 32768
    v_exp_f32 v124, v124
    v_exp_f32 v125, v125
    s_waitcnt lgkmcnt(0)
    s_waitcnt vmcnt(11)
    v_mfma_f32_16x16x32_bf16 v[168:171], v[184:187], v[216:219], v[168:171]
    buffer_load_dwordx4 v[184:187], v6, s[8:11], s49 offen offset:0 sc1
    v_exp_f32 v126, v126
    v_exp_f32 v127, v127
    v_exp_f32 v128, v128
    v_exp_f32 v129, v129
    v_smfmac_f32_32x32x32_bf16 v[144:159], v[68:71], v[120:127], v13
    v_exp_f32 v130, v130
    v_exp_f32 v131, v131
    v_exp_f32 v132, v132
    v_mfma_f32_32x32x16_bf16 v[112:127], v[32:35], v[164:167], 0
    v_exp_f32 v133, v133
    v_exp_f32 v134, v134
    v_exp_f32 v135, v135
    s_waitcnt vmcnt(10)
    v_mfma_f32_16x16x32_bf16 v[172:175], v[188:191], v[216:219], v[172:175]
    buffer_load_dwordx4 v[188:191], v6, s[8:11], s49 offen offset:1024 sc1
    v_exp_f32 v136, v136
    v_exp_f32 v137, v137
    v_exp_f32 v138, v138
    v_smfmac_f32_32x32x32_bf16 v[144:159], v[72:75], v[128:135], v13
    v_exp_f32 v139, v139
    v_exp_f32 v140, v140
    v_exp_f32 v141, v141
    s_waitcnt vmcnt(10)
    v_mfma_f32_16x16x32_bf16 v[176:179], v[192:195], v[216:219], v[176:179]
    buffer_load_dwordx4 v[192:195], v6, s[8:11], s49 offen offset:2048 sc1
    v_exp_f32 v142, v142
    v_exp_f32 v143, v143
    v_exp_f32 v112, v112
    v_exp_f32 v113, v113
    v_smfmac_f32_32x32x32_bf16 v[144:159], v[76:79], v[136:143], v13
    v_exp_f32 v114, v114
    v_exp_f32 v115, v115
    v_exp_f32 v116, v116
    v_mfma_f32_32x32x16_bf16 v[128:143], v[36:39], v[164:167], 0
    v_exp_f32 v117, v117
    v_exp_f32 v118, v118
    v_exp_f32 v119, v119
    s_waitcnt vmcnt(10)
    v_mfma_f32_16x16x32_bf16 v[180:183], v[196:199], v[216:219], v[180:183]
    buffer_load_dwordx4 v[196:199], v6, s[8:11], s49 offen offset:3072 sc1
    v_exp_f32 v120, v120
    v_exp_f32 v121, v121
    v_exp_f32 v122, v122
    v_smfmac_f32_32x32x32_bf16 v[144:159], v[80:83], v[112:119], v13
    v_exp_f32 v123, v123
    v_exp_f32 v124, v124
    v_exp_f32 v125, v125
    s_waitcnt vmcnt(10)
    v_mfma_f32_16x16x32_bf16 v[168:171], v[200:203], v[220:223], v[168:171]
    buffer_load_dwordx4 v[200:203], v6, s[8:11], s50 offen offset:0 sc1
    v_exp_f32 v126, v126
    v_exp_f32 v127, v127
    s_setprio 2
    v_exp_f32 v128, v128
    v_exp_f32 v129, v129
    v_smfmac_f32_32x32x32_bf16 v[144:159], v[84:87], v[120:127], v13
    v_exp_f32 v130, v130
    v_exp_f32 v131, v131
    buffer_load_dwordx4 v[56:59], v6, s[8:11], s36 offen offset:2048 sc1
    v_exp_f32 v132, v132
    v_mfma_f32_32x32x16_bf16 v[112:127], v[40:43], v[164:167], 0
    v_exp_f32 v133, v133
    s_mov_b32 exec_lo, 0
    s_mov_b32 exec_hi, 0xffff0000
    ds_write_b128 v27, v[2:5]
    s_mov_b64 exec, -1
    v_exp_f32 v134, v134
    v_exp_f32 v135, v135
    s_waitcnt vmcnt(11)
    v_mfma_f32_16x16x32_bf16 v[172:175], v[204:207], v[220:223], v[172:175]
    buffer_load_dwordx4 v[204:207], v6, s[8:11], s50 offen offset:1024 sc1
    v_exp_f32 v136, v136
    v_exp_f32 v137, v137
    v_exp_f32 v138, v138
    v_smfmac_f32_32x32x32_bf16 v[144:159], v[88:91], v[128:135], v13
    v_exp_f32 v139, v139
    v_exp_f32 v140, v140
    v_exp_f32 v141, v141
    s_waitcnt vmcnt(11)
    v_mfma_f32_16x16x32_bf16 v[176:179], v[208:211], v[220:223], v[176:179]
    buffer_load_dwordx4 v[208:211], v6, s[8:11], s50 offen offset:2048 sc1
    v_exp_f32 v142, v142
    v_exp_f32 v143, v143
    s_setprio 1
    v_exp_f32 v112, v112
    v_exp_f32 v113, v113
    v_smfmac_f32_32x32x32_bf16 v[144:159], v[92:95], v[136:143], v13
    v_exp_f32 v114, v114
    ds_write_b128 v8, v[2:5] offset:16384
    v_exp_f32 v115, v115
    buffer_load_dwordx4 v[60:63], v6, s[8:11], s36 offen offset:3072 sc1
    v_exp_f32 v116, v116
    v_mfma_f32_32x32x16_bf16 v[128:143], v[44:47], v[164:167], 0
    ds_read_b128 v[80:83], v26 offset:0
    v_exp_f32 v117, v117
    v_exp_f32 v118, v118
    ds_read_b128 v[84:87], v26 offset:16
    v_exp_f32 v119, v119
    s_waitcnt vmcnt(10)
    v_mfma_f32_16x16x32_bf16 v[180:183], v[212:215], v[220:223], v[180:183]
    buffer_load_dwordx4 v[212:215], v6, s[8:11], s50 offen offset:3072 sc1
    v_exp_f32 v120, v120
    ds_read_b128 v[88:91], v26 offset:256
    v_exp_f32 v121, v121
    buffer_load_dwordx4 v[64:67], v6, s[8:11], s37 offen offset:0 sc1
    v_exp_f32 v122, v122
    v_smfmac_f32_32x32x32_bf16 v[144:159], v[96:99], v[112:119], v13
    ds_read_b128 v[92:95], v26 offset:272
    v_exp_f32 v123, v123
    v_exp_f32 v124, v124
    v_exp_f32 v125, v125
    v_exp_f32 v126, v126
    v_exp_f32 v127, v127
    s_setprio 0
    v_exp_f32 v128, v128
    v_exp_f32 v129, v129
    v_smfmac_f32_32x32x32_bf16 v[144:159], v[100:103], v[120:127], v13
    v_exp_f32 v130, v130
    v_exp_f32 v131, v131
    buffer_load_dwordx4 v[68:71], v6, s[8:11], s37 offen offset:1024 sc1
    v_exp_f32 v132, v132
    ds_read_b128 v[96:99], v26 offset:512
    v_exp_f32 v133, v133
    v_exp_f32 v134, v134
    ds_read_b128 v[100:103], v26 offset:528
    v_exp_f32 v135, v135
    v_exp_f32 v136, v136
    v_exp_f32 v137, v137
    buffer_load_dwordx4 v[72:75], v6, s[8:11], s37 offen offset:2048 sc1
    v_exp_f32 v138, v138
    v_smfmac_f32_32x32x32_bf16 v[144:159], v[104:107], v[128:135], v13
    v_exp_f32 v139, v139
    v_exp_f32 v140, v140
    v_exp_f32 v141, v141
    v_exp_f32 v142, v142
    v_exp_f32 v143, v143
    s_nop 1
P2_TAIL:
    v_smfmac_f32_32x32x32_bf16 v[144:159], v[108:111], v[136:143], v13
    s_add_u32 s60, s98, 65536
    v_mov_b32 v0, s60
    v_lshrrev_b32 v28, 5, v1
    v_and_b32 v31, 7, v1
    v_lshlrev_b32 v29, 5, v31
    v_add_u32 v29, 116992, v29
    v_lshl_add_u32 v28, v28, 8, v29
    s_lshl_b32 s60, s5, 2
    v_add_u32 v28, s60, v28
    v_lshlrev_b32 v254, 4, v25
    v_lshl_add_u32 v254, v31, 4, v254
    buffer_load_dwordx4 v[76:79], v6, s[8:11], s37 offen offset:3072 sc1
    ds_write_b128 v8, v[144:147] offset:16384
    ds_write_b128 v8, v[148:151] offset:17408
    s_mov_b32 exec_hi, 0
    ds_write_b32 v252, v152 offset:896
    s_mov_b32 exec_hi, -1
    v_lshrrev_b32 v4, 4, v1
    v_and_b32 v3, 0xf0, v6
    v_lshl_add_u32 v3, v4, 9, v3
    s_cmp_ge_u32 s5, 4
    s_waitcnt lgkmcnt(0)
    s_barrier
    s_cbranch_scc1 P2_T4
    s_setprio 3
    ds_read_b128 v[216:219], v11 offset:0
    ds_read_b128 v[220:223], v11 offset:512
    ds_read2st64_b32 v[244:245], v253 offset0:3 offset1:7
    ds_read2st64_b32 v[246:247], v253 offset0:11 offset1:15
    ds_read2st64_b32 v[248:249], v253 offset0:19 offset1:23
    ds_read2st64_b32 v[250:251], v253 offset0:27 offset1:31
    ds_read2st64_b64 v[224:227], v9 offset0:32 offset1:36
    ds_read2st64_b64 v[228:231], v9 offset0:40 offset1:44
    ds_read2st64_b64 v[232:235], v9 offset0:48 offset1:52
    ds_read2st64_b64 v[236:239], v9 offset0:56 offset1:60
CB_40:
    s_waitcnt vmcnt(4) lgkmcnt(8)
    v_mfma_f32_16x16x32_bf16 v[168:171], v[184:187], v[216:219], v[168:171]
    v_mfma_f32_16x16x32_bf16 v[172:175], v[188:191], v[216:219], v[172:175]
    v_mfma_f32_16x16x32_bf16 v[168:171], v[200:203], v[220:223], v[168:171]
    v_mfma_f32_16x16x32_bf16 v[172:175], v[204:207], v[220:223], v[172:175]
    v_mfma_f32_16x16x32_bf16 v[176:179], v[192:195], v[216:219], v[176:179]
    v_mfma_f32_16x16x32_bf16 v[180:183], v[196:199], v[216:219], v[180:183]
    v_mfma_f32_16x16x32_bf16 v[176:179], v[208:211], v[220:223], v[176:179]
    v_mfma_f32_16x16x32_bf16 v[180:183], v[212:215], v[220:223], v[180:183]
    s_waitcnt lgkmcnt(4)
    v_pk_add_f32 v[244:245], v[244:245], v[246:247]
    v_pk_add_f32 v[248:249], v[248:249], v[250:251]
    v_pk_add_f32 v[244:245], v[244:245], v[248:249]
    v_add_f32 v245, v244, v245
    v_rcp_f32 v244, v245
    s_waitcnt lgkmcnt(0)
    v_pk_add_f32 v[224:225], v[224:225], v[226:227]
    v_pk_add_f32 v[228:229], v[228:229], v[230:231]
    v_pk_add_f32 v[232:233], v[232:233], v[234:235]
    v_pk_add_f32 v[236:237], v[236:237], v[238:239]
    v_pk_add_f32 v[224:225], v[224:225], v[228:229]
    v_pk_add_f32 v[232:233], v[232:233], v[236:237]
    v_pk_add_f32 v[224:225], v[224:225], v[232:233]
    v_mul_f32 v224, v224, v244
    v_mul_f32 v225, v225, v244
    v_cvt_pk_bf16_f32 v226, v224, v225
    ds_write_b32 v10, v226 offset:1024
    v_fma_f32 v245, v224, 0, v245
    v_fma_f32 v245, v225, 0, v245
    v_subrev_u32 v245, 0x1f800000, v245
    v_cmp_le_u32 vcc, 2.0, v245
    s_cbranch_vccnz CB_41_B
CB_41:
    v_lshlrev_b32 v112, 16, v16
    v_and_b32 v113, 0xffff0000, v16
    v_lshlrev_b32 v114, 16, v17
    v_and_b32 v115, 0xffff0000, v17
    v_lshlrev_b32 v116, 16, v18
    v_and_b32 v117, 0xffff0000, v18
    v_lshlrev_b32 v118, 16, v19
    v_and_b32 v119, 0xffff0000, v19
    s_waitcnt lgkmcnt(0)
    s_barrier
    ds_read_b128 v[128:131], v11 offset:1024
    ds_read_b128 v[132:135], v11 offset:1536
    ds_read_b32 v0, v0 offset:51968
    s_waitcnt vmcnt(0)
    s_branch P2_T5
P2_T4:
    ds_read_b128 v[216:219], v11 offset:0
    ds_read_b128 v[220:223], v11 offset:512
    s_waitcnt vmcnt(4)
    v_lshlrev_b32 v112, 16, v16
    v_and_b32 v113, 0xffff0000, v16
    v_lshlrev_b32 v114, 16, v17
    v_and_b32 v115, 0xffff0000, v17
    v_lshlrev_b32 v116, 16, v18
    v_and_b32 v117, 0xffff0000, v18
    v_lshlrev_b32 v118, 16, v19
    v_and_b32 v119, 0xffff0000, v19
    s_waitcnt lgkmcnt(0)
    v_mfma_f32_16x16x32_bf16 v[168:171], v[184:187], v[216:219], v[168:171]
    v_mfma_f32_16x16x32_bf16 v[172:175], v[188:191], v[216:219], v[172:175]
    v_mfma_f32_16x16x32_bf16 v[168:171], v[200:203], v[220:223], v[168:171]
    v_mfma_f32_16x16x32_bf16 v[172:175], v[204:207], v[220:223], v[172:175]
    v_mfma_f32_16x16x32_bf16 v[176:179], v[192:195], v[216:219], v[176:179]
    v_mfma_f32_16x16x32_bf16 v[180:183], v[196:199], v[216:219], v[180:183]
    v_mfma_f32_16x16x32_bf16 v[176:179], v[208:211], v[220:223], v[176:179]
    v_mfma_f32_16x16x32_bf16 v[180:183], v[212:215], v[220:223], v[180:183]
    s_add_u32 m0, s44, 131072
    s_add_u32 s60, s32, 0
    buffer_load_dwordx4 v12, s[24:27], s60 offen lds
    s_sub_u32 m0, m0, 1024
    s_nop 0
    buffer_load_dwordx4 v7, s[24:27], s60 offen lds
    s_add_u32 m0, s44, 139264
    s_add_u32 s60, s32, 65536
    buffer_load_dwordx4 v12, s[24:27], s60 offen lds
    s_sub_u32 m0, m0, 1024
    s_nop 0
    buffer_load_dwordx4 v7, s[24:27], s60 offen lds
    s_barrier
    ds_read_b128 v[128:131], v11 offset:1024
    ds_read_b128 v[132:135], v11 offset:1536
    ds_read_b32 v0, v0 offset:51968
    s_waitcnt vmcnt(4)
P2_T5:
    s_add_u32 m0, s44, 147456
    s_add_u32 s60, s33, 0
    buffer_load_dwordx4 v12, s[24:27], s60 offen lds
    s_setprio 1
    s_waitcnt lgkmcnt(1)
    v_mfma_f32_16x16x32_bf16 v[168:171], v[48:51], v[128:131], v[168:171]
    v_mfma_f32_16x16x32_bf16 v[172:175], v[52:55], v[128:131], v[172:175]
    v_mfma_f32_16x16x32_bf16 v[168:171], v[64:67], v[132:135], v[168:171]
    v_mfma_f32_16x16x32_bf16 v[172:175], v[68:71], v[132:135], v[172:175]
    s_waitcnt lgkmcnt(0)
    v_cmp_ne_u32 vcc, 0, v0
    v_mfma_f32_16x16x32_bf16 v[176:179], v[56:59], v[128:131], v[176:179]
    v_mfma_f32_16x16x32_bf16 v[180:183], v[60:63], v[128:131], v[180:183]
    v_mfma_f32_16x16x32_bf16 v[176:179], v[72:75], v[132:135], v[176:179]
    v_mfma_f32_16x16x32_bf16 v[180:183], v[76:79], v[132:135], v[180:183]
    s_add_u32 m0, s44, 155648
    s_add_u32 s60, s33, 65536
    buffer_load_dwordx4 v12, s[24:27], s60 offen lds
    s_cbranch_vccnz P2_SLOW
    s_mov_b64 exec, s[94:95]
    v_pk_fma_f32 v[112:113], v[168:169], v[80:81], v[112:113]
    v_pk_fma_f32 v[114:115], v[170:171], v[82:83], v[114:115]
    v_pk_fma_f32 v[116:117], v[172:173], v[84:85], v[116:117]
    v_pk_fma_f32 v[118:119], v[174:175], v[86:87], v[118:119]
    s_mov_b64 exec, -1
    v_fmac_f32_dpp v112, v176, v80 row_shr:8 row_mask:0xf bank_mask:0xc
    v_fmac_f32_dpp v113, v177, v81 row_shr:8 row_mask:0xf bank_mask:0xc
    v_fmac_f32_dpp v114, v178, v82 row_shr:8 row_mask:0xf bank_mask:0xc
    v_fmac_f32_dpp v115, v179, v83 row_shr:8 row_mask:0xf bank_mask:0xc
    v_fmac_f32_dpp v116, v180, v84 row_shr:8 row_mask:0xf bank_mask:0xc
    v_fmac_f32_dpp v117, v181, v85 row_shr:8 row_mask:0xf bank_mask:0xc
    v_fmac_f32_dpp v118, v182, v86 row_shr:8 row_mask:0xf bank_mask:0xc
    v_fmac_f32_dpp v119, v183, v87 row_shr:8 row_mask:0xf bank_mask:0xc
    v_pk_add_f32 v[128:129], v[112:113], v[114:115]
    v_pk_mul_f32 v[132:133], v[112:113], v[112:113]
    v_pk_add_f32 v[130:131], v[116:117], v[118:119]
    v_pk_fma_f32 v[132:133], v[114:115], v[114:115], v[132:133]
    v_pk_add_f32 v[128:129], v[128:129], v[130:131]
    v_pk_fma_f32 v[132:133], v[116:117], v[116:117], v[132:133]
    v_add_f32 v128, v128, v129
    v_pk_fma_f32 v[132:133], v[118:119], v[118:119], v[132:133]
    v_add_f32 v129, v132, v133
    s_nop 1
    v_permlane32_swap_b32 v128, v129
    v_add_f32 v128, v128, v129
    v_mov_b32 v129, v128
    s_nop 1
    v_permlane16_swap_b32 v128, v129
    v_add_f32 v128, v128, v129
    s_nop 1
    v_add_f32_dpp v128, v128, v128 row_ror:8 row_mask:0xf bank_mask:0xf
    s_mov_b32 exec_lo, 0xff
    s_mov_b32 exec_hi, 0xff
    ds_write_b32 v28, v128
    s_mov_b64 exec, -1
    v_cvt_pk_bf16_f32 v236, v112, v113
    v_cvt_pk_bf16_f32 v237, v114, v115
    v_cvt_pk_bf16_f32 v238, v116, v117
    v_cvt_pk_bf16_f32 v239, v118, v119
    v_mov_b32 v250, v24
    s_waitcnt lgkmcnt(0)
    s_barrier
    ds_read_b128 v[128:131], v29
    ds_read_b128 v[132:135], v29 offset:16
    ds_read_b128 v[136:139], v29 offset:256
    ds_read_b128 v[140:143], v29 offset:272
    v_pk_mul_f32 v[112:113], v[112:113], v[96:97]
    v_pk_mul_f32 v[114:115], v[114:115], v[98:99]
    v_pk_mul_f32 v[116:117], v[116:117], v[100:101]
    v_pk_mul_f32 v[118:119], v[118:119], v[102:103]
    s_waitcnt lgkmcnt(2)
    v_pk_add_f32 v[128:129], v[128:129], v[130:131]
    v_pk_add_f32 v[132:133], v[132:133], v[134:135]
    v_pk_add_f32 v[128:129], v[128:129], v[132:133]
    s_waitcnt lgkmcnt(0)
    v_pk_add_f32 v[136:137], v[136:137], v[138:139]
    v_pk_add_f32 v[140:141], v[140:141], v[142:143]
    v_add_f32 v128, v128, v129
    v_pk_add_f32 v[136:137], v[136:137], v[140:141]
    v_mul_f32 v128, 0xbb000000, v128
    v_add_f32 v129, v136, v137
    v_mul_f32 v129, 0x3b000000, v129
    v_fma_f32 v129, -v128, v128, v129
    v_max_f32 v129, 0, v129
    v_add_f32 v129, 0x3727c5ac, v129
    v_rsq_f32 v129, v129
    s_nop 0
    v_pk_fma_f32 v[112:113], v[96:97], v[128:129], v[112:113] op_sel_hi:[1,0,1]
    v_pk_fma_f32 v[114:115], v[98:99], v[128:129], v[114:115] op_sel_hi:[1,0,1]
    v_pk_fma_f32 v[116:117], v[100:101], v[128:129], v[116:117] op_sel_hi:[1,0,1]
    v_pk_fma_f32 v[118:119], v[102:103], v[128:129], v[118:119] op_sel_hi:[1,0,1]
    v_pk_fma_f32 v[112:113], v[112:113], v[128:129], v[88:89] op_sel:[0,1,0] op_sel_hi:[1,1,1]
    v_pk_fma_f32 v[114:115], v[114:115], v[128:129], v[90:91] op_sel:[0,1,0] op_sel_hi:[1,1,1]
    v_pk_fma_f32 v[116:117], v[116:117], v[128:129], v[92:93] op_sel:[0,1,0] op_sel_hi:[1,1,1]
    v_pk_fma_f32 v[118:119], v[118:119], v[128:129], v[94:95] op_sel:[0,1,0] op_sel_hi:[1,1,1]
    v_cvt_pk_bf16_f32 v232, v112, v114
    v_cvt_pk_bf16_f32 v233, v116, v118
    v_cvt_pk_bf16_f32 v234, v113, v115
    v_cvt_pk_bf16_f32 v235, v117, v119
    buffer_store_dwordx4 v[232:235], v254, s[8:11], s28 offen
    s_setprio 0
    v_lshrrev_b32 v4, 2, v1
    v_and_b32 v5, 3, v1
    v_mul_u32_u24 v4, 224, v4
    v_lshl_add_u32 v7, v5, 3, s84
    v_bfe_u32 v5, v1, 1, 1
    v_add_u32 v7, v7, v4
    v_mul_u32_u24 v5, 7168, v5
    s_sub_u32 s85, s85, s84
    v_add_u32 v8, 57472, v7
    v_add3_u32 v9, v7, v5, s85
    v_add_u32 v10, 57472, v9
    ds_read_b64_tr_b16 v[16:17], v8 offset:28736
    ds_read_b64_tr_b16 v[18:19], v8 offset:28848
    ds_read_b64_tr_b16 v[20:21], v8 offset:35920
    ds_read_b64_tr_b16 v[22:23], v8 offset:36032
    ds_read_b64_tr_b16 v[24:25], v8 offset:28768
    ds_read_b64_tr_b16 v[26:27], v8 offset:28880
    ds_read_b64_tr_b16 v[28:29], v8 offset:35952
    ds_read_b64_tr_b16 v[30:31], v8 offset:36064
    ds_read_b64_tr_b16 v[32:33], v8 offset:28800
    ds_read_b64_tr_b16 v[34:35], v8 offset:28912
    ds_read_b64_tr_b16 v[36:37], v8 offset:35984
    ds_read_b64_tr_b16 v[38:39], v8 offset:36096
    buffer_load_dwordx4 v[104:107], v3, s[8:11], s66 offen offset:0 sc1
    buffer_load_dwordx4 v[108:111], v3, s[8:11], s66 offen offset:256 sc1
    buffer_load_dwordx4 v[112:115], v3, s[8:11], s66 offen offset:2048 sc1
    buffer_load_dwordx4 v[116:119], v3, s[8:11], s66 offen offset:2304 sc1
    v_lshrrev_b32 v0, 3, v1
    v_lshl_add_u32 v4, v0, 5, s41
    ds_read_b128 v[240:243], v4
    ds_read_b128 v[244:247], v4 offset:16
    v_and_b32 v5, 7, v1
    v_lshlrev_b32 v2, 10, v5
    v_lshl_add_u32 v2, v0, 4, v2
    v_add_u32 v248, s45, v6
    v_xor_b32 v251, 128, v248
    v_lshl_add_u32 v249, v5, 4, s46
    v_and_b32 v14, 1, v0
    v_lshl_add_u32 v249, v14, 9, v249
    v_lshrrev_b32 v5, 4, v1
    v_lshl_add_u32 v249, v5, 13, v249
    v_and_b32 v5, 1, v5
    v_lshlrev_b32 v0, 7, v5
    v_xor_b32 v249, v249, v0
    v_add_u32 v252, s44, v6
    v_and_b32 v0, 3, v1
    v_lshl_add_u32 v13, v0, 3, s40
    v_lshl_add_u32 v13, v14, 6, v13
    v_bfe_u32 v0, v1, 2, 2
    v_lshl_add_u32 v13, v0, 7, v13
    v_mul_u32_u24 v0, 1056, v5
    v_lshrrev_b32 v253, 5, v1
    v_add_u32 v13, v13, v0
    v_lshl_add_u32 v13, v253, 13, v13
    v_xor_b32 v14, 32, v13
    v_xor_b32 v15, 64, v13
    v_and_b32 v11, 0xf0, v6
    v_lshl_add_u32 v0, v5, 9, v11
    v_lshl_add_u32 v11, v5, 3, v11
    v_lshl_add_u32 v11, v253, 8, v11
    v_lshl_add_u32 v4, v253, 12, v0
    s_and_b32 s60, s4, 1
    v_xor_b32 v253, s60, v253
    v_mul_u32_u24 v253, 7168, v253
    v_add_u32 v5, v253, v0
    v_xor_b32 v253, 96, v13
    s_waitcnt lgkmcnt(0)
    v_mul_f32 v240, 0xbf317218, v240
    v_mul_f32 v241, 0xbf317218, v241
    v_mul_f32 v242, 0xbf317218, v242
    v_mul_f32 v243, 0xbf317218, v243
    v_mul_f32 v244, 0xbf317218, v244
    v_mul_f32 v245, 0xbf317218, v245
    v_mul_f32 v246, 0xbf317218, v246
    v_mul_f32 v247, 0xbf317218, v247
    s_or_b32 s60, s2, s5
    s_cbranch_scc0 EP_W
EP_R:
    s_waitcnt vmcnt(0)
    v_max3_u32 v0, v104, v108, v112
    v_max_u32 v0, v116, v0
    v_cmp_eq_u32 vcc, 0xffbfffbf, v0
    s_cbranch_vccnz SC_42
SC_42_R:
    buffer_load_dwordx4 v[120:123], v3, s[8:11], s67 offen offset:0 sc1
    buffer_load_dwordx4 v[124:127], v3, s[8:11], s67 offen offset:256 sc1
    buffer_load_dwordx4 v[128:131], v3, s[8:11], s67 offen offset:2048 sc1
    buffer_load_dwordx4 v[132:135], v3, s[8:11], s67 offen offset:2304 sc1
    s_setprio 3
    s_waitcnt lgkmcnt(10)
    v_mfma_f32_16x16x32_bf16 v[48:51], v[16:19], v[104:107], 0
    ds_read_b64_tr_b16 v[40:41], v10 offset:28736
    ds_read_b64_tr_b16 v[42:43], v10 offset:28848
    v_mfma_f32_16x16x32_bf16 v[52:55], v[16:19], v[108:111], 0
    s_waitcnt lgkmcnt(10)
    v_mfma_f32_16x16x32_bf16 v[56:59], v[20:23], v[104:107], 0
    ds_read_b64_tr_b16 v[44:45], v8 offset:32320
    ds_read_b64_tr_b16 v[46:47], v8 offset:32432
    v_mfma_f32_16x16x32_bf16 v[60:63], v[20:23], v[108:111], 0
    s_waitcnt lgkmcnt(10)
    v_mfma_f32_16x16x32_bf16 v[64:67], v[24:27], v[104:107], 0
    ds_read_b64_tr_b16 v[16:17], v8 offset:39504
    ds_read_b64_tr_b16 v[18:19], v8 offset:39616
    v_mfma_f32_16x16x32_bf16 v[68:71], v[24:27], v[108:111], 0
    buffer_load_dwordx4 v[136:139], v3, s[8:11], s68 offen offset:0 sc1
    s_waitcnt lgkmcnt(10)
    v_mfma_f32_16x16x32_bf16 v[72:75], v[28:31], v[104:107], 0
    ds_read_b64_tr_b16 v[20:21], v8 offset:32352
    ds_read_b64_tr_b16 v[22:23], v8 offset:32464
    v_mfma_f32_16x16x32_bf16 v[76:79], v[28:31], v[108:111], 0
    s_waitcnt lgkmcnt(10)
    v_mfma_f32_16x16x32_bf16 v[80:83], v[32:35], v[104:107], 0
    ds_read_b64_tr_b16 v[24:25], v8 offset:39536
    ds_read_b64_tr_b16 v[26:27], v8 offset:39648
    v_mfma_f32_16x16x32_bf16 v[84:87], v[32:35], v[108:111], 0
    s_waitcnt lgkmcnt(10)
    v_mfma_f32_16x16x32_bf16 v[88:91], v[36:39], v[104:107], 0
    ds_read_b64_tr_b16 v[28:29], v8 offset:32384
    ds_read_b64_tr_b16 v[30:31], v8 offset:32496
    v_mfma_f32_16x16x32_bf16 v[92:95], v[36:39], v[108:111], 0
    buffer_load_dwordx4 v[140:143], v3, s[8:11], s68 offen offset:256 sc1
    s_waitcnt lgkmcnt(10)
    v_mfma_f32_16x16x32_bf16 v[96:99], v[40:43], v[104:107], 0
    ds_read_b64_tr_b16 v[32:33], v8 offset:39568
    ds_read_b64_tr_b16 v[34:35], v8 offset:39680
    v_mfma_f32_16x16x32_bf16 v[100:103], v[40:43], v[108:111], 0
    s_setprio 2
    s_waitcnt lgkmcnt(10)
    v_mfma_f32_16x16x32_bf16 v[48:51], v[44:47], v[112:115], v[48:51]
    ds_read_b64_tr_b16 v[36:37], v10 offset:32320
    ds_read_b64_tr_b16 v[38:39], v10 offset:32432
    v_mfma_f32_16x16x32_bf16 v[52:55], v[44:47], v[116:119], v[52:55]
    buffer_load_dwordx4 v[144:147], v3, s[8:11], s68 offen offset:2048 sc1
    s_waitcnt lgkmcnt(10)
    v_mfma_f32_16x16x32_bf16 v[56:59], v[16:19], v[112:115], v[56:59]
    ds_read_b64_tr_b16 v[40:41], v8 offset:43104
    ds_read_b64_tr_b16 v[42:43], v8 offset:43216
    v_mfma_f32_16x16x32_bf16 v[60:63], v[16:19], v[116:119], v[60:63]
    s_waitcnt lgkmcnt(10)
    v_mfma_f32_16x16x32_bf16 v[64:67], v[20:23], v[112:115], v[64:67]
    ds_read_b64_tr_b16 v[44:45], v8 offset:50288
    ds_read_b64_tr_b16 v[46:47], v8 offset:50400
    v_mfma_f32_16x16x32_bf16 v[68:71], v[20:23], v[116:119], v[68:71]
    buffer_load_dwordx4 v[148:151], v3, s[8:11], s68 offen offset:2304 sc1
    s_waitcnt lgkmcnt(10)
    v_mfma_f32_16x16x32_bf16 v[72:75], v[24:27], v[112:115], v[72:75]
    ds_read_b64_tr_b16 v[16:17], v8 offset:43136
    ds_read_b64_tr_b16 v[18:19], v8 offset:43248
    v_mfma_f32_16x16x32_bf16 v[76:79], v[24:27], v[116:119], v[76:79]
    s_waitcnt lgkmcnt(10)
    v_mfma_f32_16x16x32_bf16 v[80:83], v[28:31], v[112:115], v[80:83]
    ds_read_b64_tr_b16 v[20:21], v8 offset:50320
    ds_read_b64_tr_b16 v[22:23], v8 offset:50432
    v_mfma_f32_16x16x32_bf16 v[84:87], v[28:31], v[116:119], v[84:87]
    buffer_load_dwordx4 v[152:155], v3, s[8:11], s69 offen offset:0 sc1
    s_waitcnt lgkmcnt(10)
    v_mfma_f32_16x16x32_bf16 v[88:91], v[32:35], v[112:115], v[88:91]
    ds_read_b64_tr_b16 v[24:25], v8 offset:43168
    ds_read_b64_tr_b16 v[26:27], v8 offset:43280
    v_mfma_f32_16x16x32_bf16 v[92:95], v[32:35], v[116:119], v[92:95]
    s_waitcnt vmcnt(7)
    v_max_u32 v0, v120, v124
    v_cmp_eq_u32 vcc, 0xffbfffbf, v0
    s_waitcnt lgkmcnt(10)
    v_mfma_f32_16x16x32_bf16 v[96:99], v[36:39], v[112:115], v[96:99]
    ds_read_b64_tr_b16 v[28:29], v8 offset:50352
    ds_read_b64_tr_b16 v[30:31], v8 offset:50464
    v_mfma_f32_16x16x32_bf16 v[100:103], v[36:39], v[116:119], v[100:103]
    buffer_load_dwordx4 v[156:159], v3, s[8:11], s69 offen offset:256 sc1
    s_cbranch_vccnz SC_43
SC_43_R:
    s_setprio 1
    s_waitcnt lgkmcnt(10)
    v_mfma_f32_16x16x32_bf16 v[48:51], v[40:43], v[120:123], v[48:51]
    ds_read_b64_tr_b16 v[32:33], v10 offset:43104
    ds_read_b64_tr_b16 v[34:35], v10 offset:43216
    v_mfma_f32_16x16x32_bf16 v[52:55], v[40:43], v[124:127], v[52:55]
    s_waitcnt lgkmcnt(10)
    v_mfma_f32_16x16x32_bf16 v[56:59], v[44:47], v[120:123], v[56:59]
    ds_read_b64_tr_b16 v[36:37], v8 offset:46688
    ds_read_b64_tr_b16 v[38:39], v8 offset:46800
    v_mfma_f32_16x16x32_bf16 v[60:63], v[44:47], v[124:127], v[60:63]
    s_waitcnt lgkmcnt(10)
    v_mfma_f32_16x16x32_bf16 v[64:67], v[16:19], v[120:123], v[64:67]
    ds_read_b64_tr_b16 v[40:41], v8 offset:53872
    ds_read_b64_tr_b16 v[42:43], v8 offset:53984
    v_mfma_f32_16x16x32_bf16 v[68:71], v[16:19], v[124:127], v[68:71]
    buffer_load_dwordx4 v[160:163], v3, s[8:11], s69 offen offset:2048 sc1
    s_waitcnt lgkmcnt(10)
    v_mfma_f32_16x16x32_bf16 v[72:75], v[20:23], v[120:123], v[72:75]
    ds_read_b64_tr_b16 v[44:45], v8 offset:46720
    ds_read_b64_tr_b16 v[46:47], v8 offset:46832
    v_mfma_f32_16x16x32_bf16 v[76:79], v[20:23], v[124:127], v[76:79]
    s_waitcnt lgkmcnt(10)
    v_mfma_f32_16x16x32_bf16 v[80:83], v[24:27], v[120:123], v[80:83]
    ds_read_b64_tr_b16 v[16:17], v8 offset:53904
    ds_read_b64_tr_b16 v[18:19], v8 offset:54016
    v_mfma_f32_16x16x32_bf16 v[84:87], v[24:27], v[124:127], v[84:87]
    buffer_load_dwordx4 v[164:167], v3, s[8:11], s69 offen offset:2304 sc1
    s_waitcnt lgkmcnt(10)
    v_mfma_f32_16x16x32_bf16 v[88:91], v[28:31], v[120:123], v[88:91]
    ds_read_b64_tr_b16 v[20:21], v8 offset:46752
    ds_read_b64_tr_b16 v[22:23], v8 offset:46864
    v_mfma_f32_16x16x32_bf16 v[92:95], v[28:31], v[124:127], v[92:95]
    s_waitcnt vmcnt(8)
    v_max_u32 v0, v128, v132
    v_cmp_eq_u32 vcc, 0xffbfffbf, v0
    s_waitcnt lgkmcnt(10)
    v_mfma_f32_16x16x32_bf16 v[96:99], v[32:35], v[120:123], v[96:99]
    ds_read_b64_tr_b16 v[24:25], v8 offset:53936
    ds_read_b64_tr_b16 v[26:27], v8 offset:54048
    v_mfma_f32_16x16x32_bf16 v[100:103], v[32:35], v[124:127], v[100:103]
    buffer_load_dwordx4 v[104:107], v3, s[8:11], s70 offen offset:0 sc1
    s_cbranch_vccnz SC_44
SC_44_R:
    s_setprio 0
    s_waitcnt lgkmcnt(10)
    v_mfma_f32_16x16x32_bf16 v[48:51], v[36:39], v[128:131], v[48:51]
    ds_read_b64_tr_b16 v[28:29], v10 offset:46688
    ds_read_b64_tr_b16 v[30:31], v10 offset:46800
    v_mfma_f32_16x16x32_bf16 v[52:55], v[36:39], v[132:135], v[52:55]
    s_waitcnt lgkmcnt(10)
    v_mfma_f32_16x16x32_bf16 v[56:59], v[40:43], v[128:131], v[56:59]
    ds_read_b64_tr_b16 v[32:33], v8 offset:0
    ds_read_b64_tr_b16 v[34:35], v8 offset:112
    v_mfma_f32_16x16x32_bf16 v[60:63], v[40:43], v[132:135], v[60:63]
    buffer_load_dwordx4 v[108:111], v3, s[8:11], s70 offen offset:256 sc1
    s_waitcnt lgkmcnt(10)
    v_mfma_f32_16x16x32_bf16 v[64:67], v[44:47], v[128:131], v[64:67]
    ds_read_b64_tr_b16 v[36:37], v8 offset:7184
    ds_read_b64_tr_b16 v[38:39], v8 offset:7296
    v_mfma_f32_16x16x32_bf16 v[68:71], v[44:47], v[132:135], v[68:71]
    s_waitcnt lgkmcnt(10)
    v_mfma_f32_16x16x32_bf16 v[72:75], v[16:19], v[128:131], v[72:75]
    ds_read_b64_tr_b16 v[40:41], v8 offset:32
    ds_read_b64_tr_b16 v[42:43], v8 offset:144
    v_mfma_f32_16x16x32_bf16 v[76:79], v[16:19], v[132:135], v[76:79]
    buffer_load_dwordx4 v[112:115], v3, s[8:11], s70 offen offset:2048 sc1
    s_waitcnt lgkmcnt(10)
    v_mfma_f32_16x16x32_bf16 v[80:83], v[20:23], v[128:131], v[80:83]
    ds_read_b64_tr_b16 v[44:45], v8 offset:7216
    ds_read_b64_tr_b16 v[46:47], v8 offset:7328
    v_mfma_f32_16x16x32_bf16 v[84:87], v[20:23], v[132:135], v[84:87]
    s_waitcnt lgkmcnt(10)
    v_mfma_f32_16x16x32_bf16 v[88:91], v[24:27], v[128:131], v[88:91]
    ds_read_b64_tr_b16 v[16:17], v8 offset:64
    ds_read_b64_tr_b16 v[18:19], v8 offset:176
    v_mfma_f32_16x16x32_bf16 v[92:95], v[24:27], v[132:135], v[92:95]
    s_waitcnt vmcnt(9)
    v_max_u32 v0, v136, v140
    v_cmp_eq_u32 vcc, 0xffbfffbf, v0
    s_waitcnt lgkmcnt(10)
    v_mfma_f32_16x16x32_bf16 v[96:99], v[28:31], v[128:131], v[96:99]
    ds_read_b64_tr_b16 v[20:21], v8 offset:7248
    ds_read_b64_tr_b16 v[22:23], v8 offset:7360
    v_mfma_f32_16x16x32_bf16 v[100:103], v[28:31], v[132:135], v[100:103]
    s_barrier
    s_add_u32 m0, s44, 114688
    s_add_u32 s60, s34, 0
    buffer_load_dwordx4 v12, s[24:27], s60 offen lds
    s_cbranch_vccnz SC_45
SC_45_R:
    s_setprio 3
    s_waitcnt lgkmcnt(10)
    v_mfma_f32_16x16x32_bf16 v[48:51], v[32:35], v[136:139], v[48:51]
    ds_read_b64_tr_b16 v[24:25], v10 offset:0
    ds_read_b64_tr_b16 v[26:27], v10 offset:112
    v_mfma_f32_16x16x32_bf16 v[52:55], v[32:35], v[140:143], v[52:55]
    ds_read_b64_tr_b16 v[168:169], v13 offset:32768
    ds_read_b64_tr_b16 v[170:171], v13 offset:33280
    s_waitcnt lgkmcnt(12)
    v_mfma_f32_16x16x32_bf16 v[56:59], v[36:39], v[136:139], v[56:59]
    ds_read_b64_tr_b16 v[28:29], v8 offset:3584
    ds_read_b64_tr_b16 v[30:31], v8 offset:3696
    v_mfma_f32_16x16x32_bf16 v[60:63], v[36:39], v[140:143], v[60:63]
    s_add_u32 m0, s44, 122880
    s_add_u32 s60, s34, 65536
    buffer_load_dwordx4 v12, s[24:27], s60 offen lds
    s_waitcnt lgkmcnt(12)
    v_mfma_f32_16x16x32_bf16 v[64:67], v[40:43], v[136:139], v[64:67]
    ds_read_b64_tr_b16 v[32:33], v8 offset:10768
    ds_read_b64_tr_b16 v[34:35], v8 offset:10880
    v_mfma_f32_16x16x32_bf16 v[68:71], v[40:43], v[140:143], v[68:71]
    ds_read_b64_tr_b16 v[172:173], v15 offset:32768
    ds_read_b64_tr_b16 v[174:175], v15 offset:33280
    s_waitcnt lgkmcnt(14)
    v_mfma_f32_16x16x32_bf16 v[72:75], v[44:47], v[136:139], v[72:75]
    ds_read_b64_tr_b16 v[36:37], v8 offset:3616
    ds_read_b64_tr_b16 v[38:39], v8 offset:3728
    v_mfma_f32_16x16x32_bf16 v[76:79], v[44:47], v[140:143], v[76:79]
    s_add_u32 m0, s44, 98304
    s_add_u32 s60, s35, 0
    buffer_load_dwordx4 v12, s[24:27], s60 offen lds
    s_waitcnt lgkmcnt(14)
    v_mfma_f32_16x16x32_bf16 v[80:83], v[16:19], v[136:139], v[80:83]
    ds_read_b64_tr_b16 v[40:41], v8 offset:10800
    ds_read_b64_tr_b16 v[42:43], v8 offset:10912
    v_mfma_f32_16x16x32_bf16 v[84:87], v[16:19], v[140:143], v[84:87]
    ds_read_b64_tr_b16 v[176:177], v14 offset:32768
    ds_read_b64_tr_b16 v[178:179], v14 offset:33280
    s_waitcnt lgkmcnt(15)
    v_mfma_f32_16x16x32_bf16 v[88:91], v[20:23], v[136:139], v[88:91]
    ds_read_b64_tr_b16 v[44:45], v8 offset:3648
    ds_read_b64_tr_b16 v[46:47], v8 offset:3760
    v_mfma_f32_16x16x32_bf16 v[92:95], v[20:23], v[140:143], v[92:95]
    s_add_u32 m0, s44, 106496
    s_add_u32 s60, s35, 65536
    buffer_load_dwordx4 v12, s[24:27], s60 offen lds
    s_waitcnt vmcnt(11)
    v_max_u32 v0, v144, v148
    v_cmp_eq_u32 vcc, 0xffbfffbf, v0
    s_waitcnt lgkmcnt(15)
    v_mfma_f32_16x16x32_bf16 v[96:99], v[24:27], v[136:139], v[96:99]
    ds_read_b64_tr_b16 v[16:17], v8 offset:10832
    ds_read_b64_tr_b16 v[18:19], v8 offset:10944
    v_mfma_f32_16x16x32_bf16 v[100:103], v[24:27], v[140:143], v[100:103]
    s_cbranch_vccnz SC_46
SC_46_R:
    ds_read_b64_tr_b16 v[180:181], v253 offset:32768
    ds_read_b64_tr_b16 v[182:183], v253 offset:33280
    s_setprio 2
    s_waitcnt lgkmcnt(15)
    v_mfma_f32_16x16x32_bf16 v[48:51], v[28:31], v[144:147], v[48:51]
    ds_read_b64_tr_b16 v[20:21], v10 offset:3584
    ds_read_b64_tr_b16 v[22:23], v10 offset:3696
    v_mfma_f32_16x16x32_bf16 v[52:55], v[28:31], v[148:151], v[52:55]
    buffer_load_dwordx4 v[116:119], v3, s[8:11], s70 offen offset:2304 sc1
    s_waitcnt lgkmcnt(15)
    v_mfma_f32_16x16x32_bf16 v[56:59], v[32:35], v[144:147], v[56:59]
    ds_read_b64_tr_b16 v[24:25], v8 offset:14368
    ds_read_b64_tr_b16 v[26:27], v8 offset:14480
    v_mfma_f32_16x16x32_bf16 v[60:63], v[32:35], v[148:151], v[60:63]
    ds_read_b64_tr_b16 v[184:185], v13 offset:49152
    ds_read_b64_tr_b16 v[186:187], v13 offset:49664
    s_waitcnt lgkmcnt(15)
    v_mfma_f32_16x16x32_bf16 v[64:67], v[36:39], v[144:147], v[64:67]
    ds_read_b64_tr_b16 v[28:29], v8 offset:21552
    ds_read_b64_tr_b16 v[30:31], v8 offset:21664
    v_mfma_f32_16x16x32_bf16 v[68:71], v[36:39], v[148:151], v[68:71]
    ds_read_b64_tr_b16 v[188:189], v15 offset:49152
    ds_read_b64_tr_b16 v[190:191], v15 offset:49664
    s_waitcnt lgkmcnt(15)
    v_mfma_f32_16x16x32_bf16 v[72:75], v[40:43], v[144:147], v[72:75]
    ds_read_b64_tr_b16 v[32:33], v8 offset:14400
    ds_read_b64_tr_b16 v[34:35], v8 offset:14512
    v_mfma_f32_16x16x32_bf16 v[76:79], v[40:43], v[148:151], v[76:79]
    buffer_load_dwordx4 v[120:123], v3, s[8:11], s71 offen offset:0 sc1
    s_waitcnt lgkmcnt(15)
    v_mfma_f32_16x16x32_bf16 v[80:83], v[44:47], v[144:147], v[80:83]
    ds_read_b64_tr_b16 v[36:37], v8 offset:21584
    ds_read_b64_tr_b16 v[38:39], v8 offset:21696
    v_mfma_f32_16x16x32_bf16 v[84:87], v[44:47], v[148:151], v[84:87]
    ds_read_b64_tr_b16 v[192:193], v14 offset:49152
    ds_read_b64_tr_b16 v[194:195], v14 offset:49664
    s_waitcnt lgkmcnt(15)
    v_mfma_f32_16x16x32_bf16 v[88:91], v[16:19], v[144:147], v[88:91]
    ds_read_b64_tr_b16 v[40:41], v8 offset:14432
    ds_read_b64_tr_b16 v[42:43], v8 offset:14544
    v_mfma_f32_16x16x32_bf16 v[92:95], v[16:19], v[148:151], v[92:95]
    buffer_store_dwordx4 v[236:239], v250, s[8:11], s38 offen sc1
    s_waitcnt vmcnt(12)
    v_max_u32 v0, v152, v156
    v_cmp_eq_u32 vcc, 0xffbfffbf, v0
    s_waitcnt lgkmcnt(15)
    v_mfma_f32_16x16x32_bf16 v[96:99], v[20:23], v[144:147], v[96:99]
    ds_read_b64_tr_b16 v[44:45], v8 offset:21616
    ds_read_b64_tr_b16 v[46:47], v8 offset:21728
    v_mfma_f32_16x16x32_bf16 v[100:103], v[20:23], v[148:151], v[100:103]
    s_cbranch_vccnz SC_47
SC_47_R:
    ds_read_b64_tr_b16 v[196:197], v253 offset:49152
    ds_read_b64_tr_b16 v[198:199], v253 offset:49664
    s_setprio 1
    s_waitcnt lgkmcnt(15)
    v_mfma_f32_16x16x32_bf16 v[48:51], v[24:27], v[152:155], v[48:51]
    ds_read_b64_tr_b16 v[16:17], v10 offset:14368
    ds_read_b64_tr_b16 v[18:19], v10 offset:14480
    v_mfma_f32_16x16x32_bf16 v[52:55], v[24:27], v[156:159], v[52:55]
    buffer_load_dwordx4 v[124:127], v3, s[8:11], s71 offen offset:256 sc1
    s_waitcnt lgkmcnt(15)
    v_mfma_f32_16x16x32_bf16 v[56:59], v[28:31], v[152:155], v[56:59]
    ds_read_b64_tr_b16 v[20:21], v8 offset:17952
    ds_read_b64_tr_b16 v[22:23], v8 offset:18064
    v_mfma_f32_16x16x32_bf16 v[60:63], v[28:31], v[156:159], v[60:63]
    s_waitcnt lgkmcnt(14)
    v_mfma_f32_16x16x32_bf16 v[64:67], v[32:35], v[152:155], v[64:67]
    ds_read_b64_tr_b16 v[24:25], v8 offset:25136
    ds_read_b64_tr_b16 v[26:27], v8 offset:25248
    v_mfma_f32_16x16x32_bf16 v[68:71], v[32:35], v[156:159], v[68:71]
    buffer_load_dwordx4 v[128:131], v3, s[8:11], s71 offen offset:2048 sc1
    s_waitcnt lgkmcnt(14)
    v_mfma_f32_16x16x32_bf16 v[72:75], v[36:39], v[152:155], v[72:75]
    ds_read_b64_tr_b16 v[28:29], v8 offset:17984
    ds_read_b64_tr_b16 v[30:31], v8 offset:18096
    v_mfma_f32_16x16x32_bf16 v[76:79], v[36:39], v[156:159], v[76:79]
    s_waitcnt lgkmcnt(12)
    v_mfma_f32_16x16x32_bf16 v[80:83], v[40:43], v[152:155], v[80:83]
    ds_read_b64_tr_b16 v[32:33], v8 offset:25168
    ds_read_b64_tr_b16 v[34:35], v8 offset:25280
    v_mfma_f32_16x16x32_bf16 v[84:87], v[40:43], v[156:159], v[84:87]
    s_waitcnt lgkmcnt(12)
    v_mfma_f32_16x16x32_bf16 v[88:91], v[44:47], v[152:155], v[88:91]
    ds_read_b64_tr_b16 v[36:37], v8 offset:18016
    ds_read_b64_tr_b16 v[38:39], v8 offset:18128
    v_mfma_f32_16x16x32_bf16 v[92:95], v[44:47], v[156:159], v[92:95]
    buffer_load_dwordx4 v[132:135], v3, s[8:11], s71 offen offset:2304 sc1
    s_waitcnt vmcnt(13)
    v_max_u32 v0, v160, v164
    v_cmp_eq_u32 vcc, 0xffbfffbf, v0
    s_waitcnt lgkmcnt(10)
    v_mfma_f32_16x16x32_bf16 v[96:99], v[16:19], v[152:155], v[96:99]
    ds_read_b64_tr_b16 v[40:41], v8 offset:25200
    ds_read_b64_tr_b16 v[42:43], v8 offset:25312
    v_mfma_f32_16x16x32_bf16 v[100:103], v[16:19], v[156:159], v[100:103]
    s_cbranch_vccnz SC_48
SC_48_R:
    s_setprio 0
    s_waitcnt lgkmcnt(10)
    v_mfma_f32_16x16x32_bf16 v[48:51], v[20:23], v[160:163], v[48:51]
    ds_read_b64_tr_b16 v[44:45], v10 offset:17952
    ds_read_b64_tr_b16 v[46:47], v10 offset:18064
    v_mfma_f32_16x16x32_bf16 v[52:55], v[20:23], v[164:167], v[52:55]
    buffer_load_dwordx4 v[136:139], v3, s[8:11], s72 offen offset:0 sc1
    s_waitcnt lgkmcnt(10)
    v_mfma_f32_16x16x32_bf16 v[56:59], v[24:27], v[160:163], v[56:59]
    ds_read_b64_tr_b16 v[16:17], v7 offset:28736
    ds_read_b64_tr_b16 v[18:19], v7 offset:28848
    v_mfma_f32_16x16x32_bf16 v[60:63], v[24:27], v[164:167], v[60:63]
    s_waitcnt lgkmcnt(10)
    v_mfma_f32_16x16x32_bf16 v[64:67], v[28:31], v[160:163], v[64:67]
    ds_read_b64_tr_b16 v[20:21], v7 offset:35920
    ds_read_b64_tr_b16 v[22:23], v7 offset:36032
    v_mfma_f32_16x16x32_bf16 v[68:71], v[28:31], v[164:167], v[68:71]
    buffer_load_dwordx4 v[140:143], v3, s[8:11], s72 offen offset:256 sc1
    s_waitcnt lgkmcnt(10)
    v_mfma_f32_16x16x32_bf16 v[72:75], v[32:35], v[160:163], v[72:75]
    ds_read_b64_tr_b16 v[24:25], v7 offset:28768
    ds_read_b64_tr_b16 v[26:27], v7 offset:28880
    v_mfma_f32_16x16x32_bf16 v[76:79], v[32:35], v[164:167], v[76:79]
    s_waitcnt lgkmcnt(10)
    v_mfma_f32_16x16x32_bf16 v[80:83], v[36:39], v[160:163], v[80:83]
    ds_read_b64_tr_b16 v[28:29], v7 offset:35952
    ds_read_b64_tr_b16 v[30:31], v7 offset:36064
    v_mfma_f32_16x16x32_bf16 v[84:87], v[36:39], v[164:167], v[84:87]
    buffer_load_dwordx4 v[144:147], v3, s[8:11], s72 offen offset:2048 sc1
    s_waitcnt lgkmcnt(10)
    v_mfma_f32_16x16x32_bf16 v[88:91], v[40:43], v[160:163], v[88:91]
    ds_read_b64_tr_b16 v[32:33], v7 offset:28800
    ds_read_b64_tr_b16 v[34:35], v7 offset:28912
    v_mfma_f32_16x16x32_bf16 v[92:95], v[40:43], v[164:167], v[92:95]
    s_waitcnt vmcnt(14)
    v_max_u32 v0, v104, v108
    v_cmp_eq_u32 vcc, 0xffbfffbf, v0
    s_waitcnt lgkmcnt(10)
    v_mfma_f32_16x16x32_bf16 v[96:99], v[44:47], v[160:163], v[96:99]
    ds_read_b64_tr_b16 v[36:37], v7 offset:35984
    ds_read_b64_tr_b16 v[38:39], v7 offset:36096
    v_mfma_f32_16x16x32_bf16 v[100:103], v[44:47], v[164:167], v[100:103]
    s_waitcnt vmcnt(9)
    s_barrier
    buffer_load_dwordx4 v[148:151], v3, s[8:11], s72 offen offset:2304 sc1
    s_cbranch_vccnz SC_49
SC_49_R:
    s_setprio 3
    s_waitcnt lgkmcnt(10)
    v_mfma_f32_16x16x32_bf16 v[48:51], v[16:19], v[104:107], v[48:51]
    ds_read_b64_tr_b16 v[40:41], v9 offset:28736
    ds_read_b64_tr_b16 v[42:43], v9 offset:28848
    v_mfma_f32_16x16x32_bf16 v[52:55], v[16:19], v[108:111], v[52:55]
    ds_read_b64_tr_b16 v[200:201], v13 offset:16384
    ds_read_b64_tr_b16 v[202:203], v13 offset:16896
    s_waitcnt lgkmcnt(12)
    v_mfma_f32_16x16x32_bf16 v[56:59], v[20:23], v[104:107], v[56:59]
    ds_read_b64_tr_b16 v[44:45], v7 offset:32320
    ds_read_b64_tr_b16 v[46:47], v7 offset:32432
    v_mfma_f32_16x16x32_bf16 v[60:63], v[20:23], v[108:111], v[60:63]
    ds_read_b64_tr_b16 v[204:205], v15 offset:16384
    ds_read_b64_tr_b16 v[206:207], v15 offset:16896
    s_waitcnt lgkmcnt(14)
    v_mfma_f32_16x16x32_bf16 v[64:67], v[24:27], v[104:107], v[64:67]
    ds_read_b64_tr_b16 v[16:17], v7 offset:39504
    ds_read_b64_tr_b16 v[18:19], v7 offset:39616
    v_mfma_f32_16x16x32_bf16 v[68:71], v[24:27], v[108:111], v[68:71]
    buffer_load_dwordx4 v[152:155], v3, s[8:11], s73 offen offset:0 sc1
    s_waitcnt lgkmcnt(14)
    v_mfma_f32_16x16x32_bf16 v[72:75], v[28:31], v[104:107], v[72:75]
    ds_read_b64_tr_b16 v[20:21], v7 offset:32352
    ds_read_b64_tr_b16 v[22:23], v7 offset:32464
    v_mfma_f32_16x16x32_bf16 v[76:79], v[28:31], v[108:111], v[76:79]
    ds_read_b64_tr_b16 v[208:209], v14 offset:16384
    ds_read_b64_tr_b16 v[210:211], v14 offset:16896
    s_waitcnt lgkmcnt(15)
    v_mfma_f32_16x16x32_bf16 v[80:83], v[32:35], v[104:107], v[80:83]
    ds_read_b64_tr_b16 v[24:25], v7 offset:39536
    ds_read_b64_tr_b16 v[26:27], v7 offset:39648
    v_mfma_f32_16x16x32_bf16 v[84:87], v[32:35], v[108:111], v[84:87]
    buffer_load_dwordx4 v[156:159], v3, s[8:11], s73 offen offset:256 sc1
    s_waitcnt lgkmcnt(15)
    v_mfma_f32_16x16x32_bf16 v[88:91], v[36:39], v[104:107], v[88:91]
    ds_read_b64_tr_b16 v[28:29], v7 offset:32384
    ds_read_b64_tr_b16 v[30:31], v7 offset:32496
    v_mfma_f32_16x16x32_bf16 v[92:95], v[36:39], v[108:111], v[92:95]
    s_waitcnt vmcnt(11)
    v_max_u32 v0, v112, v116
    v_cmp_eq_u32 vcc, 0xffbfffbf, v0
    ds_read_b64_tr_b16 v[212:213], v253 offset:16384
    ds_read_b64_tr_b16 v[214:215], v253 offset:16896
    s_waitcnt lgkmcnt(15)
    v_mfma_f32_16x16x32_bf16 v[96:99], v[40:43], v[104:107], v[96:99]
    ds_read_b64_tr_b16 v[32:33], v7 offset:39568
    ds_read_b64_tr_b16 v[34:35], v7 offset:39680
    v_mfma_f32_16x16x32_bf16 v[100:103], v[40:43], v[108:111], v[100:103]
    buffer_load_dwordx4 v[160:163], v3, s[8:11], s73 offen offset:2048 sc1
    s_cbranch_vccnz SC_50
SC_50_R:
    s_setprio 2
    s_waitcnt lgkmcnt(15)
    v_mfma_f32_16x16x32_bf16 v[48:51], v[44:47], v[112:115], v[48:51]
    ds_read_b64_tr_b16 v[36:37], v9 offset:32320
    ds_read_b64_tr_b16 v[38:39], v9 offset:32432
    v_mfma_f32_16x16x32_bf16 v[52:55], v[44:47], v[116:119], v[52:55]
    ds_read_b64_tr_b16 v[216:217], v13 offset:0
    ds_read_b64_tr_b16 v[218:219], v13 offset:512
    s_waitcnt lgkmcnt(15)
    v_mfma_f32_16x16x32_bf16 v[56:59], v[16:19], v[112:115], v[56:59]
    ds_read_b64_tr_b16 v[40:41], v7 offset:43104
    ds_read_b64_tr_b16 v[42:43], v7 offset:43216
    v_mfma_f32_16x16x32_bf16 v[60:63], v[16:19], v[116:119], v[60:63]
    buffer_load_dwordx4 v[164:167], v3, s[8:11], s73 offen offset:2304 sc1
    s_waitcnt lgkmcnt(15)
    v_mfma_f32_16x16x32_bf16 v[64:67], v[20:23], v[112:115], v[64:67]
    ds_read_b64_tr_b16 v[44:45], v7 offset:50288
    ds_read_b64_tr_b16 v[46:47], v7 offset:50400
    v_mfma_f32_16x16x32_bf16 v[68:71], v[20:23], v[116:119], v[68:71]
    ds_read_b64_tr_b16 v[220:221], v15 offset:0
    ds_read_b64_tr_b16 v[222:223], v15 offset:512
    s_waitcnt lgkmcnt(15)
    v_mfma_f32_16x16x32_bf16 v[72:75], v[24:27], v[112:115], v[72:75]
    ds_read_b64_tr_b16 v[16:17], v7 offset:43136
    ds_read_b64_tr_b16 v[18:19], v7 offset:43248
    v_mfma_f32_16x16x32_bf16 v[76:79], v[24:27], v[116:119], v[76:79]
    s_add_u32 m0, s44, 131072
    s_add_u32 s60, s32, 16384
    buffer_load_dwordx4 v12, s[24:27], s60 offen lds
    s_waitcnt lgkmcnt(15)
    v_mfma_f32_16x16x32_bf16 v[80:83], v[28:31], v[112:115], v[80:83]
    ds_read_b64_tr_b16 v[20:21], v7 offset:50320
    ds_read_b64_tr_b16 v[22:23], v7 offset:50432
    v_mfma_f32_16x16x32_bf16 v[84:87], v[28:31], v[116:119], v[84:87]
    ds_read_b64_tr_b16 v[224:225], v14 offset:0
    ds_read_b64_tr_b16 v[226:227], v14 offset:512
    s_waitcnt lgkmcnt(15)
    v_mfma_f32_16x16x32_bf16 v[88:91], v[32:35], v[112:115], v[88:91]
    ds_read_b64_tr_b16 v[24:25], v7 offset:43168
    ds_read_b64_tr_b16 v[26:27], v7 offset:43280
    v_mfma_f32_16x16x32_bf16 v[92:95], v[32:35], v[116:119], v[92:95]
    s_waitcnt vmcnt(11)
    v_max_u32 v0, v120, v124
    v_cmp_eq_u32 vcc, 0xffbfffbf, v0
    ds_read_b64_tr_b16 v[228:229], v253 offset:0
    ds_read_b64_tr_b16 v[230:231], v253 offset:512
    s_waitcnt lgkmcnt(15)
    v_mfma_f32_16x16x32_bf16 v[96:99], v[36:39], v[112:115], v[96:99]
    ds_read_b64_tr_b16 v[28:29], v7 offset:50352
    ds_read_b64_tr_b16 v[30:31], v7 offset:50464
    v_mfma_f32_16x16x32_bf16 v[100:103], v[36:39], v[116:119], v[100:103]
    s_add_u32 m0, s44, 139264
    s_add_u32 s60, s32, 81920
    buffer_load_dwordx4 v12, s[24:27], s60 offen lds
    s_cbranch_vccnz SC_51
SC_51_R:
    s_setprio 1
    s_waitcnt lgkmcnt(15)
    v_mfma_f32_16x16x32_bf16 v[48:51], v[40:43], v[120:123], v[48:51]
    ds_read_b64_tr_b16 v[32:33], v9 offset:43104
    ds_read_b64_tr_b16 v[34:35], v9 offset:43216
    v_mfma_f32_16x16x32_bf16 v[52:55], v[40:43], v[124:127], v[52:55]
    s_waitcnt lgkmcnt(15)
    v_mfma_f32_16x16x32_bf16 v[56:59], v[44:47], v[120:123], v[56:59]
    ds_read_b64_tr_b16 v[36:37], v7 offset:46688
    ds_read_b64_tr_b16 v[38:39], v7 offset:46800
    v_mfma_f32_16x16x32_bf16 v[60:63], v[44:47], v[124:127], v[60:63]
    s_add_u32 m0, s44, 147456
    s_add_u32 s60, s33, 16384
    buffer_load_dwordx4 v12, s[24:27], s60 offen lds
    s_waitcnt lgkmcnt(14)
    v_mfma_f32_16x16x32_bf16 v[64:67], v[16:19], v[120:123], v[64:67]
    ds_read_b64_tr_b16 v[40:41], v7 offset:53872
    ds_read_b64_tr_b16 v[42:43], v7 offset:53984
    v_mfma_f32_16x16x32_bf16 v[68:71], v[16:19], v[124:127], v[68:71]
    s_waitcnt lgkmcnt(14)
    v_mfma_f32_16x16x32_bf16 v[72:75], v[20:23], v[120:123], v[72:75]
    ds_read_b64_tr_b16 v[44:45], v7 offset:46720
    ds_read_b64_tr_b16 v[46:47], v7 offset:46832
    v_mfma_f32_16x16x32_bf16 v[76:79], v[20:23], v[124:127], v[76:79]
    s_add_u32 m0, s44, 155648
    s_add_u32 s60, s33, 81920
    buffer_load_dwordx4 v12, s[24:27], s60 offen lds
    s_waitcnt lgkmcnt(12)
    v_mfma_f32_16x16x32_bf16 v[80:83], v[24:27], v[120:123], v[80:83]
    ds_read_b64_tr_b16 v[16:17], v7 offset:53904
    ds_read_b64_tr_b16 v[18:19], v7 offset:54016
    v_mfma_f32_16x16x32_bf16 v[84:87], v[24:27], v[124:127], v[84:87]
    s_waitcnt lgkmcnt(10)
    v_mfma_f32_16x16x32_bf16 v[88:91], v[28:31], v[120:123], v[88:91]
    ds_read_b64_tr_b16 v[20:21], v7 offset:46752
    ds_read_b64_tr_b16 v[22:23], v7 offset:46864
    v_mfma_f32_16x16x32_bf16 v[92:95], v[28:31], v[124:127], v[92:95]
    s_add_u32 m0, s44, 65536
    s_add_u32 s60, s34, 16384
    buffer_load_dwordx4 v12, s[24:27], s60 offen lds
    s_waitcnt vmcnt(13)
    v_max_u32 v0, v128, v132
    v_cmp_eq_u32 vcc, 0xffbfffbf, v0
    s_waitcnt lgkmcnt(10)
    v_mfma_f32_16x16x32_bf16 v[96:99], v[32:35], v[120:123], v[96:99]
    ds_read_b64_tr_b16 v[24:25], v7 offset:53936
    ds_read_b64_tr_b16 v[26:27], v7 offset:54048
    v_mfma_f32_16x16x32_bf16 v[100:103], v[32:35], v[124:127], v[100:103]
    s_cbranch_vccnz SC_52
SC_52_R:
    s_setprio 0
    s_waitcnt lgkmcnt(10)
    v_mfma_f32_16x16x32_bf16 v[48:51], v[36:39], v[128:131], v[48:51]
    ds_read_b64_tr_b16 v[28:29], v9 offset:46688
    ds_read_b64_tr_b16 v[30:31], v9 offset:46800
    v_mfma_f32_16x16x32_bf16 v[52:55], v[36:39], v[132:135], v[52:55]
    s_add_u32 m0, s44, 73728
    s_add_u32 s60, s34, 81920
    buffer_load_dwordx4 v12, s[24:27], s60 offen lds
    s_waitcnt lgkmcnt(10)
    v_mfma_f32_16x16x32_bf16 v[56:59], v[40:43], v[128:131], v[56:59]
    ds_read_b64_tr_b16 v[32:33], v7 offset:0
    ds_read_b64_tr_b16 v[34:35], v7 offset:112
    v_mfma_f32_16x16x32_bf16 v[60:63], v[40:43], v[132:135], v[60:63]
    s_waitcnt lgkmcnt(10)
    v_mfma_f32_16x16x32_bf16 v[64:67], v[44:47], v[128:131], v[64:67]
    ds_read_b64_tr_b16 v[36:37], v7 offset:7184
    ds_read_b64_tr_b16 v[38:39], v7 offset:7296
    v_mfma_f32_16x16x32_bf16 v[68:71], v[44:47], v[132:135], v[68:71]
    s_waitcnt lgkmcnt(10)
    v_mfma_f32_16x16x32_bf16 v[72:75], v[16:19], v[128:131], v[72:75]
    ds_read_b64_tr_b16 v[40:41], v7 offset:3584
    ds_read_b64_tr_b16 v[42:43], v7 offset:3696
    v_mfma_f32_16x16x32_bf16 v[76:79], v[16:19], v[132:135], v[76:79]
    s_add_u32 m0, s44, 81920
    s_add_u32 s60, s35, 16384
    buffer_load_dwordx4 v12, s[24:27], s60 offen lds
    s_waitcnt lgkmcnt(10)
    v_mfma_f32_16x16x32_bf16 v[80:83], v[20:23], v[128:131], v[80:83]
    ds_read_b64_tr_b16 v[44:45], v7 offset:10768
    ds_read_b64_tr_b16 v[46:47], v7 offset:10880
    v_mfma_f32_16x16x32_bf16 v[84:87], v[20:23], v[132:135], v[84:87]
    s_waitcnt lgkmcnt(10)
    v_mfma_f32_16x16x32_bf16 v[88:91], v[24:27], v[128:131], v[88:91]
    ds_read_b64_tr_b16 v[16:17], v7 offset:14368
    ds_read_b64_tr_b16 v[18:19], v7 offset:14480
    v_mfma_f32_16x16x32_bf16 v[92:95], v[24:27], v[132:135], v[92:95]
    s_add_u32 m0, s44, 90112
    s_add_u32 s60, s35, 81920
    buffer_load_dwordx4 v12, s[24:27], s60 offen lds
    s_waitcnt vmcnt(14)
    v_max_u32 v0, v136, v140
    v_cmp_eq_u32 vcc, 0xffbfffbf, v0
    s_waitcnt lgkmcnt(10)
    v_mfma_f32_16x16x32_bf16 v[96:99], v[28:31], v[128:131], v[96:99]
    ds_read_b64_tr_b16 v[20:21], v7 offset:21552
    ds_read_b64_tr_b16 v[22:23], v7 offset:21664
    v_mfma_f32_16x16x32_bf16 v[100:103], v[28:31], v[132:135], v[100:103]
    s_waitcnt vmcnt(19)
    s_barrier
    s_cbranch_vccnz SC_53
SC_53_R:
    s_setprio 3
    s_waitcnt lgkmcnt(10)
    v_mfma_f32_16x16x32_bf16 v[48:51], v[32:35], v[136:139], v[48:51]
    ds_read_b64_tr_b16 v[24:25], v7 offset:17952
    ds_read_b64_tr_b16 v[26:27], v7 offset:18064
    v_mfma_f32_16x16x32_bf16 v[52:55], v[32:35], v[140:143], v[52:55]
    s_add_u32 m0, s44, 98304
    s_add_u32 s60, s32, 32768
    buffer_load_dwordx4 v12, s[24:27], s60 offen lds
    s_waitcnt vmcnt(13)
    v_max_u32 v0, v144, v148
    v_cmp_eq_u32 vcc, 0xffbfffbf, v0
    s_waitcnt lgkmcnt(10)
    v_mfma_f32_16x16x32_bf16 v[56:59], v[36:39], v[136:139], v[56:59]
    ds_read_b64_tr_b16 v[28:29], v7 offset:25136
    ds_read_b64_tr_b16 v[30:31], v7 offset:25248
    v_mfma_f32_16x16x32_bf16 v[60:63], v[36:39], v[140:143], v[60:63]
    s_add_u32 m0, s44, 106496
    s_add_u32 s60, s32, 98304
    buffer_load_dwordx4 v12, s[24:27], s60 offen lds
    s_cbranch_vccnz SC_54
SC_54_R:
    s_waitcnt lgkmcnt(10)
    v_mfma_f32_16x16x32_bf16 v[48:51], v[40:43], v[144:147], v[48:51]
    ds_read_b64_tr_b16 v[32:33], v7 offset:32
    ds_read_b64_tr_b16 v[34:35], v7 offset:144
    v_mfma_f32_16x16x32_bf16 v[52:55], v[40:43], v[148:151], v[52:55]
    s_add_u32 m0, s44, 114688
    s_add_u32 s60, s33, 32768
    buffer_load_dwordx4 v12, s[24:27], s60 offen lds
    s_waitcnt vmcnt(13)
    v_max_u32 v0, v152, v156
    v_cmp_eq_u32 vcc, 0xffbfffbf, v0
    s_waitcnt lgkmcnt(10)
    v_mfma_f32_16x16x32_bf16 v[56:59], v[44:47], v[144:147], v[56:59]
    ds_read_b64_tr_b16 v[36:37], v7 offset:7216
    ds_read_b64_tr_b16 v[38:39], v7 offset:7328
    v_mfma_f32_16x16x32_bf16 v[60:63], v[44:47], v[148:151], v[60:63]
    s_cbranch_vccnz SC_55
SC_55_R:
    s_waitcnt lgkmcnt(10)
    v_mfma_f32_16x16x32_bf16 v[48:51], v[16:19], v[152:155], v[48:51]
    ds_read_b64_tr_b16 v[40:41], v7 offset:3616
    ds_read_b64_tr_b16 v[42:43], v7 offset:3728
    v_mfma_f32_16x16x32_bf16 v[52:55], v[16:19], v[156:159], v[52:55]
    s_add_u32 m0, s44, 122880
    s_add_u32 s60, s33, 98304
    buffer_load_dwordx4 v12, s[24:27], s60 offen lds
    s_waitcnt vmcnt(12)
    v_max_u32 v0, v160, v164
    v_cmp_eq_u32 vcc, 0xffbfffbf, v0
    s_waitcnt lgkmcnt(10)
    v_mfma_f32_16x16x32_bf16 v[56:59], v[20:23], v[152:155], v[56:59]
    ds_read_b64_tr_b16 v[44:45], v7 offset:10800
    ds_read_b64_tr_b16 v[46:47], v7 offset:10912
    v_mfma_f32_16x16x32_bf16 v[60:63], v[20:23], v[156:159], v[60:63]
    s_add_u32 m0, s44, 32768
    s_add_u32 s60, s34, 32768
    buffer_load_dwordx4 v12, s[24:27], s60 offen lds
    s_cbranch_vccnz SC_56
SC_56_R:
    s_waitcnt lgkmcnt(10)
    v_mfma_f32_16x16x32_bf16 v[48:51], v[24:27], v[160:163], v[48:51]
    ds_read_b64_tr_b16 v[16:17], v7 offset:14400
    ds_read_b64_tr_b16 v[18:19], v7 offset:14512
    v_mfma_f32_16x16x32_bf16 v[52:55], v[24:27], v[164:167], v[52:55]
    s_add_u32 m0, s44, 40960
    s_add_u32 s60, s34, 98304
    buffer_load_dwordx4 v12, s[24:27], s60 offen lds
    s_waitcnt lgkmcnt(10)
    v_mfma_f32_16x16x32_bf16 v[56:59], v[28:31], v[160:163], v[56:59]
    ds_read_b64_tr_b16 v[20:21], v7 offset:21584
    ds_read_b64_tr_b16 v[22:23], v7 offset:21696
    v_mfma_f32_16x16x32_bf16 v[60:63], v[28:31], v[164:167], v[60:63]
    s_add_u32 m0, s44, 49152
    s_add_u32 s60, s35, 32768
    buffer_load_dwordx4 v12, s[24:27], s60 offen lds
    s_setprio 2
    s_waitcnt lgkmcnt(10)
    v_mfma_f32_16x16x32_bf16 v[64:67], v[32:35], v[136:139], v[64:67]
    ds_read_b64_tr_b16 v[24:25], v7 offset:17984
    ds_read_b64_tr_b16 v[26:27], v7 offset:18096
    v_mfma_f32_16x16x32_bf16 v[68:71], v[32:35], v[140:143], v[68:71]
    s_add_u32 m0, s44, 57344
    s_add_u32 s60, s35, 98304
    buffer_load_dwordx4 v12, s[24:27], s60 offen lds
    s_waitcnt lgkmcnt(10)
    v_mfma_f32_16x16x32_bf16 v[72:75], v[36:39], v[136:139], v[72:75]
    ds_read_b64_tr_b16 v[28:29], v7 offset:25168
    ds_read_b64_tr_b16 v[30:31], v7 offset:25280
    v_mfma_f32_16x16x32_bf16 v[76:79], v[36:39], v[140:143], v[76:79]
    v_exp_f32 v48, v48
    v_exp_f32 v49, v49
    v_exp_f32 v50, v50
    s_waitcnt lgkmcnt(10)
    v_mfma_f32_16x16x32_bf16 v[64:67], v[40:43], v[144:147], v[64:67]
    ds_read_b64_tr_b16 v[32:33], v7 offset:64
    ds_read_b64_tr_b16 v[34:35], v7 offset:176
    v_exp_f32 v51, v51
    v_exp_f32 v52, v52
    v_exp_f32 v53, v53
    v_mfma_f32_16x16x32_bf16 v[68:71], v[40:43], v[148:151], v[68:71]
    s_add_u32 s60, s32, 49152
    buffer_load_dwordx4 v[120:123], v12, s[24:27], s60 offen
    v_exp_f32 v54, v54
    v_exp_f32 v55, v55
    v_add_f32 v48, 1.0, v48
    s_waitcnt lgkmcnt(10)
    v_mfma_f32_16x16x32_bf16 v[72:75], v[44:47], v[144:147], v[72:75]
    ds_read_b64_tr_b16 v[36:37], v7 offset:7248
    ds_read_b64_tr_b16 v[38:39], v7 offset:7360
    v_add_f32 v49, 1.0, v49
    v_add_f32 v50, 1.0, v50
    v_add_f32 v51, 1.0, v51
    v_mfma_f32_16x16x32_bf16 v[76:79], v[44:47], v[148:151], v[76:79]
    s_add_u32 s60, s33, 49152
    buffer_load_dwordx4 v[124:127], v12, s[24:27], s60 offen
    v_add_f32 v52, 1.0, v52
    v_add_f32 v53, 1.0, v53
    v_add_f32 v54, 1.0, v54
    s_waitcnt lgkmcnt(10)
    v_mfma_f32_16x16x32_bf16 v[64:67], v[16:19], v[152:155], v[64:67]
    ds_read_b64_tr_b16 v[40:41], v7 offset:3648
    ds_read_b64_tr_b16 v[42:43], v7 offset:3760
    v_add_f32 v55, 1.0, v55
    v_rcp_f32 v48, v48
    v_rcp_f32 v49, v49
    v_mfma_f32_16x16x32_bf16 v[68:71], v[16:19], v[156:159], v[68:71]
    s_add_u32 s60, s34, 49152
    buffer_load_dwordx4 v[128:131], v12, s[24:27], s60 offen
    v_rcp_f32 v50, v50
    v_rcp_f32 v51, v51
    v_rcp_f32 v52, v52
    s_waitcnt lgkmcnt(10)
    v_mfma_f32_16x16x32_bf16 v[72:75], v[20:23], v[152:155], v[72:75]
    ds_read_b64_tr_b16 v[44:45], v7 offset:10832
    ds_read_b64_tr_b16 v[46:47], v7 offset:10944
    v_rcp_f32 v53, v53
    v_rcp_f32 v54, v54
    v_rcp_f32 v55, v55
    v_mfma_f32_16x16x32_bf16 v[76:79], v[20:23], v[156:159], v[76:79]
    s_add_u32 s60, s35, 49152
    buffer_load_dwordx4 v[132:135], v12, s[24:27], s60 offen
    v_mul_f32 v48, v48, v56
    v_mul_f32 v49, v49, v57
    v_mul_f32 v50, v50, v58
    s_waitcnt lgkmcnt(10)
    v_mfma_f32_16x16x32_bf16 v[64:67], v[24:27], v[160:163], v[64:67]
    ds_read_b64_tr_b16 v[16:17], v7 offset:14432
    ds_read_b64_tr_b16 v[18:19], v7 offset:14544
    v_mul_f32 v51, v51, v59
    v_mul_f32 v52, v52, v60
    v_mul_f32 v53, v53, v61
    v_mfma_f32_16x16x32_bf16 v[68:71], v[24:27], v[164:167], v[68:71]
    v_mul_f32 v54, v54, v62
    v_mul_f32 v55, v55, v63
    v_cvt_pk_bf16_f32 v56, v48, v49
    s_waitcnt lgkmcnt(10)
    v_mfma_f32_16x16x32_bf16 v[72:75], v[28:31], v[160:163], v[72:75]
    ds_read_b64_tr_b16 v[20:21], v7 offset:21616
    ds_read_b64_tr_b16 v[22:23], v7 offset:21728
    v_cvt_pk_bf16_f32 v57, v50, v51
    v_cvt_pk_bf16_f32 v58, v52, v53
    v_cvt_pk_bf16_f32 v59, v54, v55
    v_mfma_f32_16x16x32_bf16 v[76:79], v[28:31], v[164:167], v[76:79]
    v_permlane16_swap_b32 v56, v58
    v_permlane16_swap_b32 v57, v59
    buffer_store_dwordx4 v[56:59], v6, s[8:11], s43 offen offset:0 sc1
    s_setprio 1
    s_waitcnt lgkmcnt(10)
    v_mfma_f32_16x16x32_bf16 v[80:83], v[32:35], v[136:139], v[80:83]
    ds_read_b64_tr_b16 v[24:25], v7 offset:18016
    ds_read_b64_tr_b16 v[26:27], v7 offset:18128
    v_mfma_f32_16x16x32_bf16 v[84:87], v[32:35], v[140:143], v[84:87]
    s_waitcnt lgkmcnt(10)
    v_mfma_f32_16x16x32_bf16 v[88:91], v[36:39], v[136:139], v[88:91]
    ds_read_b64_tr_b16 v[28:29], v7 offset:25200
    ds_read_b64_tr_b16 v[30:31], v7 offset:25312
    v_mfma_f32_16x16x32_bf16 v[92:95], v[36:39], v[140:143], v[92:95]
    v_exp_f32 v64, v64
    v_exp_f32 v65, v65
    v_exp_f32 v66, v66
    s_waitcnt lgkmcnt(10)
    v_mfma_f32_16x16x32_bf16 v[80:83], v[40:43], v[144:147], v[80:83]
    ds_read_b64_tr_b16 v[32:33], v9 offset:0
    ds_read_b64_tr_b16 v[34:35], v9 offset:112
    v_exp_f32 v67, v67
    v_exp_f32 v68, v68
    v_exp_f32 v69, v69
    v_mfma_f32_16x16x32_bf16 v[84:87], v[40:43], v[148:151], v[84:87]
    v_exp_f32 v70, v70
    v_exp_f32 v71, v71
    v_add_f32 v64, 1.0, v64
    s_waitcnt lgkmcnt(10)
    v_mfma_f32_16x16x32_bf16 v[88:91], v[44:47], v[144:147], v[88:91]
    ds_read_b64_tr_b16 v[36:37], v9 offset:3584
    ds_read_b64_tr_b16 v[38:39], v9 offset:3696
    v_add_f32 v65, 1.0, v65
    v_add_f32 v66, 1.0, v66
    v_add_f32 v67, 1.0, v67
    v_mfma_f32_16x16x32_bf16 v[92:95], v[44:47], v[148:151], v[92:95]
    v_add_f32 v68, 1.0, v68
    v_add_f32 v69, 1.0, v69
    v_add_f32 v70, 1.0, v70
    s_waitcnt lgkmcnt(10)
    v_mfma_f32_16x16x32_bf16 v[80:83], v[16:19], v[152:155], v[80:83]
    ds_read_b64_tr_b16 v[40:41], v9 offset:14368
    ds_read_b64_tr_b16 v[42:43], v9 offset:14480
    v_add_f32 v71, 1.0, v71
    v_rcp_f32 v64, v64
    v_rcp_f32 v65, v65
    v_mfma_f32_16x16x32_bf16 v[84:87], v[16:19], v[156:159], v[84:87]
    v_rcp_f32 v66, v66
    v_rcp_f32 v67, v67
    v_rcp_f32 v68, v68
    s_waitcnt lgkmcnt(10)
    v_mfma_f32_16x16x32_bf16 v[88:91], v[20:23], v[152:155], v[88:91]
    ds_read_b64_tr_b16 v[44:45], v9 offset:17952
    ds_read_b64_tr_b16 v[46:47], v9 offset:18064
    v_rcp_f32 v69, v69
    v_rcp_f32 v70, v70
    v_rcp_f32 v71, v71
    v_mfma_f32_16x16x32_bf16 v[92:95], v[20:23], v[156:159], v[92:95]
    v_mul_f32 v64, v64, v72
    v_mul_f32 v65, v65, v73
    v_mul_f32 v66, v66, v74
    s_waitcnt lgkmcnt(10)
    v_mfma_f32_16x16x32_bf16 v[80:83], v[24:27], v[160:163], v[80:83]
    v_mul_f32 v67, v67, v75
    v_mul_f32 v68, v68, v76
    v_mul_f32 v69, v69, v77
    v_mfma_f32_16x16x32_bf16 v[84:87], v[24:27], v[164:167], v[84:87]
    v_mul_f32 v70, v70, v78
    v_mul_f32 v71, v71, v79
    v_cvt_pk_bf16_f32 v72, v64, v65
    s_waitcnt lgkmcnt(8)
    v_mfma_f32_16x16x32_bf16 v[88:91], v[28:31], v[160:163], v[88:91]
    v_cvt_pk_bf16_f32 v73, v66, v67
    v_cvt_pk_bf16_f32 v74, v68, v69
    v_cvt_pk_bf16_f32 v75, v70, v71
    v_mfma_f32_16x16x32_bf16 v[92:95], v[28:31], v[164:167], v[92:95]
    v_permlane16_swap_b32 v72, v74
    v_permlane16_swap_b32 v73, v75
    buffer_store_dwordx4 v[72:75], v6, s[8:11], s43 offen offset:1024 sc1
    s_setprio 0
    s_waitcnt lgkmcnt(6)
    v_mfma_f32_16x16x32_bf16 v[96:99], v[32:35], v[136:139], v[96:99]
    v_mfma_f32_16x16x32_bf16 v[100:103], v[32:35], v[140:143], v[100:103]
    v_exp_f32 v80, v80
    v_exp_f32 v81, v81
    v_exp_f32 v82, v82
    v_exp_f32 v83, v83
    s_waitcnt lgkmcnt(4)
    v_mfma_f32_16x16x32_bf16 v[96:99], v[36:39], v[144:147], v[96:99]
    v_exp_f32 v84, v84
    v_exp_f32 v85, v85
    v_exp_f32 v86, v86
    v_exp_f32 v87, v87
    v_mfma_f32_16x16x32_bf16 v[100:103], v[36:39], v[148:151], v[100:103]
    v_add_f32 v80, 1.0, v80
    v_add_f32 v81, 1.0, v81
    v_add_f32 v82, 1.0, v82
    v_add_f32 v83, 1.0, v83
    s_waitcnt lgkmcnt(2)
    v_mfma_f32_16x16x32_bf16 v[96:99], v[40:43], v[152:155], v[96:99]
    v_add_f32 v84, 1.0, v84
    v_add_f32 v85, 1.0, v85
    v_add_f32 v86, 1.0, v86
    v_add_f32 v87, 1.0, v87
    v_mfma_f32_16x16x32_bf16 v[100:103], v[40:43], v[156:159], v[100:103]
    v_rcp_f32 v80, v80
    v_rcp_f32 v81, v81
    v_rcp_f32 v82, v82
    v_rcp_f32 v83, v83
    s_waitcnt lgkmcnt(0)
    v_mfma_f32_16x16x32_bf16 v[96:99], v[44:47], v[160:163], v[96:99]
    v_rcp_f32 v84, v84
    v_rcp_f32 v85, v85
    v_rcp_f32 v86, v86
    v_rcp_f32 v87, v87
    v_mfma_f32_16x16x32_bf16 v[100:103], v[44:47], v[164:167], v[100:103]
    v_mul_f32 v80, v80, v88
    v_mul_f32 v81, v81, v89
    v_mul_f32 v82, v82, v90
    v_mul_f32 v83, v83, v91
    v_mul_f32 v84, v84, v92
    v_mul_f32 v85, v85, v93
    v_mul_f32 v86, v86, v94
    v_mul_f32 v87, v87, v95
    v_cvt_pk_bf16_f32 v88, v80, v81
    v_cvt_pk_bf16_f32 v89, v82, v83
    v_cvt_pk_bf16_f32 v90, v84, v85
    v_cvt_pk_bf16_f32 v91, v86, v87
    s_nop 0
    v_permlane16_swap_b32 v88, v90
    v_permlane16_swap_b32 v89, v91
    buffer_store_dwordx4 v[88:91], v6, s[8:11], s43 offen offset:2048 sc1
    v_permlane32_swap_b32 v96, v100
    v_permlane32_swap_b32 v97, v101
    v_permlane32_swap_b32 v98, v102
    v_permlane32_swap_b32 v99, v103
    v_exp_f32 v96, v96
    v_exp_f32 v97, v97
    v_exp_f32 v98, v98
    v_exp_f32 v99, v99
    v_add_f32 v96, 1.0, v96
    v_add_f32 v97, 1.0, v97
    v_add_f32 v98, 1.0, v98
    v_add_f32 v99, 1.0, v99
    v_rcp_f32 v96, v96
    v_rcp_f32 v97, v97
    v_rcp_f32 v98, v98
    v_rcp_f32 v99, v99
    v_mul_f32 v96, v96, v100
    v_mul_f32 v97, v97, v101
    v_mul_f32 v98, v98, v102
    v_mul_f32 v99, v99, v103
    v_cvt_pk_bf16_f32 v100, v96, v97
    v_cvt_pk_bf16_f32 v101, v98, v99
    buffer_store_dwordx2 v[100:101], v11, s[8:11], s47 offen sc1
    buffer_load_dwordx4 v[104:107], v4, s[8:11], s76 offen offset:0 sc1
    buffer_load_dwordx4 v[108:111], v4, s[8:11], s76 offen offset:256 sc1
    s_waitcnt vmcnt(6)
    s_barrier
    s_setprio 3
    buffer_load_dwordx4 v[112:115], v4, s[8:11], s77 offen offset:0 sc1
    ds_write_b128 v252, v[120:123] offset:0
    buffer_load_dwordx4 v[116:119], v4, s[8:11], s77 offen offset:256 sc1
    ds_write_b128 v252, v[124:127] offset:8192
    buffer_load_dwordx4 v[136:139], v4, s[8:11], s78 offen offset:0 sc1
    ds_write_b128 v252, v[128:131] offset:16384
    buffer_load_dwordx4 v[140:143], v4, s[8:11], s78 offen offset:256 sc1
    ds_write_b128 v252, v[132:135] offset:24576
    buffer_load_dwordx4 v[144:147], v4, s[8:11], s79 offen offset:0 sc1
    buffer_load_dwordx4 v[148:151], v4, s[8:11], s79 offen offset:256 sc1
    v_subrev_u32 v7, 65536, v13
    v_subrev_u32 v8, 65536, v14
    v_subrev_u32 v9, 65536, v15
    v_subrev_u32 v10, 65536, v253
    v_subrev_u32 v11, 98304, v13
    v_subrev_u32 v12, 98304, v14
    v_subrev_u32 v92, 98304, v15
    v_subrev_u32 v93, 98304, v253
    s_waitcnt lgkmcnt(0)
    s_waitcnt vmcnt(6)
    v_max_u32 v0, v104, v108
    v_cmp_eq_u32 vcc, 0xffbfffbf, v0
    s_cbranch_vccnz SC_57
SC_57_R:
    s_setprio 2
    v_mfma_f32_16x16x32_bf16 v[48:51], v[168:171], v[104:107], 0
    v_mfma_f32_16x16x32_bf16 v[52:55], v[168:171], v[108:111], 0
    buffer_load_dwordx4 v[152:155], v4, s[8:11], s76 offen offset:1024 sc1
    v_mfma_f32_16x16x32_bf16 v[64:67], v[172:175], v[104:107], 0
    v_mfma_f32_16x16x32_bf16 v[68:71], v[172:175], v[108:111], 0
    buffer_load_dwordx4 v[156:159], v4, s[8:11], s76 offen offset:1280 sc1
    s_waitcnt vmcnt(6)
    v_max_u32 v0, v112, v116
    v_mfma_f32_16x16x32_bf16 v[56:59], v[176:179], v[104:107], 0
    v_mfma_f32_16x16x32_bf16 v[60:63], v[176:179], v[108:111], 0
    buffer_load_dwordx4 v[160:163], v4, s[8:11], s77 offen offset:1024 sc1
    v_cmp_eq_u32 vcc, 0xffbfffbf, v0
    v_mfma_f32_16x16x32_bf16 v[72:75], v[180:183], v[104:107], 0
    v_mfma_f32_16x16x32_bf16 v[76:79], v[180:183], v[108:111], 0
    buffer_load_dwordx4 v[164:167], v4, s[8:11], s77 offen offset:1280 sc1
    s_cbranch_vccnz SC_58
SC_58_R:
    v_mfma_f32_16x16x32_bf16 v[48:51], v[184:187], v[112:115], v[48:51]
    v_mfma_f32_16x16x32_bf16 v[52:55], v[184:187], v[116:119], v[52:55]
    v_mfma_f32_16x16x32_bf16 v[64:67], v[188:191], v[112:115], v[64:67]
    v_mfma_f32_16x16x32_bf16 v[68:71], v[188:191], v[116:119], v[68:71]
    buffer_load_dwordx4 v[120:123], v4, s[8:11], s78 offen offset:1024 sc1
    s_waitcnt vmcnt(7)
    v_max_u32 v0, v136, v140
    v_mfma_f32_16x16x32_bf16 v[56:59], v[192:195], v[112:115], v[56:59]
    v_mfma_f32_16x16x32_bf16 v[60:63], v[192:195], v[116:119], v[60:63]
    v_cmp_eq_u32 vcc, 0xffbfffbf, v0
    v_mfma_f32_16x16x32_bf16 v[72:75], v[196:199], v[112:115], v[72:75]
    v_mfma_f32_16x16x32_bf16 v[76:79], v[196:199], v[116:119], v[76:79]
    buffer_load_dwordx4 v[124:127], v4, s[8:11], s78 offen offset:1280 sc1
    s_cbranch_vccnz SC_59
SC_59_R:
    v_mfma_f32_16x16x32_bf16 v[48:51], v[200:203], v[136:139], v[48:51]
    v_mfma_f32_16x16x32_bf16 v[52:55], v[200:203], v[140:143], v[52:55]
    v_mfma_f32_16x16x32_bf16 v[64:67], v[204:207], v[136:139], v[64:67]
    v_mfma_f32_16x16x32_bf16 v[68:71], v[204:207], v[140:143], v[68:71]
    buffer_load_dwordx4 v[128:131], v4, s[8:11], s79 offen offset:1024 sc1
    s_waitcnt vmcnt(7)
    v_max_u32 v0, v144, v148
    v_mfma_f32_16x16x32_bf16 v[56:59], v[208:211], v[136:139], v[56:59]
    ds_read_b64_tr_b16 v[16:17], v13 offset:32768
    ds_read_b64_tr_b16 v[18:19], v13 offset:33280
    v_mfma_f32_16x16x32_bf16 v[60:63], v[208:211], v[140:143], v[60:63]
    v_cmp_eq_u32 vcc, 0xffbfffbf, v0
    s_setprio 1
    v_mfma_f32_16x16x32_bf16 v[72:75], v[212:215], v[136:139], v[72:75]
    ds_read_b64_tr_b16 v[20:21], v15 offset:32768
    ds_read_b64_tr_b16 v[22:23], v15 offset:33280
    v_mfma_f32_16x16x32_bf16 v[76:79], v[212:215], v[140:143], v[76:79]
    buffer_load_dwordx4 v[132:135], v4, s[8:11], s79 offen offset:1280 sc1
    s_cbranch_vccnz SC_60
SC_60_R:
    v_mfma_f32_16x16x32_bf16 v[48:51], v[216:219], v[144:147], v[48:51]
    ds_read_b64_tr_b16 v[24:25], v14 offset:32768
    ds_read_b64_tr_b16 v[26:27], v14 offset:33280
    v_mfma_f32_16x16x32_bf16 v[52:55], v[216:219], v[148:151], v[52:55]
    v_mfma_f32_16x16x32_bf16 v[64:67], v[220:223], v[144:147], v[64:67]
    ds_read_b64_tr_b16 v[28:29], v253 offset:32768
    ds_read_b64_tr_b16 v[30:31], v253 offset:33280
    v_mfma_f32_16x16x32_bf16 v[68:71], v[220:223], v[148:151], v[68:71]
    buffer_load_dwordx4 v[104:107], v4, s[8:11], s76 offen offset:2048 sc1
    s_waitcnt vmcnt(7)
    v_max_u32 v0, v152, v156
    v_mfma_f32_16x16x32_bf16 v[56:59], v[224:227], v[144:147], v[56:59]
    ds_read_b64_tr_b16 v[32:33], v13 offset:49152
    ds_read_b64_tr_b16 v[34:35], v13 offset:49664
    v_mfma_f32_16x16x32_bf16 v[60:63], v[224:227], v[148:151], v[60:63]
    v_cmp_eq_u32 vcc, 0xffbfffbf, v0
    v_mfma_f32_16x16x32_bf16 v[72:75], v[228:231], v[144:147], v[72:75]
    ds_read_b64_tr_b16 v[36:37], v15 offset:49152
    ds_read_b64_tr_b16 v[38:39], v15 offset:49664
    v_mfma_f32_16x16x32_bf16 v[76:79], v[228:231], v[148:151], v[76:79]
    buffer_load_dwordx4 v[108:111], v4, s[8:11], s76 offen offset:2304 sc1
    s_cbranch_vccnz SC_61
SC_61_R:
    s_waitcnt lgkmcnt(10)
    v_mfma_f32_16x16x32_bf16 v[48:51], v[16:19], v[152:155], v[48:51]
    ds_read_b64_tr_b16 v[40:41], v14 offset:49152
    ds_read_b64_tr_b16 v[42:43], v14 offset:49664
    v_mfma_f32_16x16x32_bf16 v[52:55], v[16:19], v[156:159], v[52:55]
    s_waitcnt lgkmcnt(10)
    v_mfma_f32_16x16x32_bf16 v[64:67], v[20:23], v[152:155], v[64:67]
    ds_read_b64_tr_b16 v[44:45], v253 offset:49152
    ds_read_b64_tr_b16 v[46:47], v253 offset:49664
    v_mfma_f32_16x16x32_bf16 v[68:71], v[20:23], v[156:159], v[68:71]
    buffer_load_dwordx4 v[112:115], v4, s[8:11], s77 offen offset:2048 sc1
    s_waitcnt vmcnt(7)
    v_max_u32 v0, v160, v164
    s_waitcnt lgkmcnt(10)
    v_mfma_f32_16x16x32_bf16 v[56:59], v[24:27], v[152:155], v[56:59]
    ds_read_b64_tr_b16 v[16:17], v7 offset:32768
    ds_read_b64_tr_b16 v[18:19], v7 offset:33280
    v_mfma_f32_16x16x32_bf16 v[60:63], v[24:27], v[156:159], v[60:63]
    v_cmp_eq_u32 vcc, 0xffbfffbf, v0
    s_waitcnt lgkmcnt(10)
    v_mfma_f32_16x16x32_bf16 v[72:75], v[28:31], v[152:155], v[72:75]
    ds_read_b64_tr_b16 v[20:21], v9 offset:32768
    ds_read_b64_tr_b16 v[22:23], v9 offset:33280
    v_mfma_f32_16x16x32_bf16 v[76:79], v[28:31], v[156:159], v[76:79]
    buffer_load_dwordx4 v[116:119], v4, s[8:11], s77 offen offset:2304 sc1
    s_cbranch_vccnz SC_62
SC_62_R:
    s_waitcnt lgkmcnt(10)
    v_mfma_f32_16x16x32_bf16 v[48:51], v[32:35], v[160:163], v[48:51]
    ds_read_b64_tr_b16 v[24:25], v8 offset:32768
    ds_read_b64_tr_b16 v[26:27], v8 offset:33280
    v_mfma_f32_16x16x32_bf16 v[52:55], v[32:35], v[164:167], v[52:55]
    s_waitcnt lgkmcnt(10)
    v_mfma_f32_16x16x32_bf16 v[64:67], v[36:39], v[160:163], v[64:67]
    ds_read_b64_tr_b16 v[28:29], v10 offset:32768
    ds_read_b64_tr_b16 v[30:31], v10 offset:33280
    v_mfma_f32_16x16x32_bf16 v[68:71], v[36:39], v[164:167], v[68:71]
    buffer_load_dwordx4 v[136:139], v4, s[8:11], s78 offen offset:2048 sc1
    s_waitcnt vmcnt(7)
    v_max_u32 v0, v120, v124
    s_setprio 0
    s_waitcnt lgkmcnt(10)
    v_mfma_f32_16x16x32_bf16 v[56:59], v[40:43], v[160:163], v[56:59]
    ds_read_b64_tr_b16 v[32:33], v7 offset:49152
    ds_read_b64_tr_b16 v[34:35], v7 offset:49664
    v_mfma_f32_16x16x32_bf16 v[60:63], v[40:43], v[164:167], v[60:63]
    v_cmp_eq_u32 vcc, 0xffbfffbf, v0
    s_waitcnt lgkmcnt(10)
    v_mfma_f32_16x16x32_bf16 v[72:75], v[44:47], v[160:163], v[72:75]
    ds_read_b64_tr_b16 v[36:37], v9 offset:49152
    ds_read_b64_tr_b16 v[38:39], v9 offset:49664
    v_mfma_f32_16x16x32_bf16 v[76:79], v[44:47], v[164:167], v[76:79]
    buffer_load_dwordx4 v[140:143], v4, s[8:11], s78 offen offset:2304 sc1
    s_cbranch_vccnz SC_63
SC_63_R:
    s_waitcnt lgkmcnt(10)
    v_mfma_f32_16x16x32_bf16 v[48:51], v[16:19], v[120:123], v[48:51]
    ds_read_b64_tr_b16 v[40:41], v8 offset:49152
    ds_read_b64_tr_b16 v[42:43], v8 offset:49664
    v_mfma_f32_16x16x32_bf16 v[52:55], v[16:19], v[124:127], v[52:55]
    s_waitcnt lgkmcnt(10)
    v_mfma_f32_16x16x32_bf16 v[64:67], v[20:23], v[120:123], v[64:67]
    ds_read_b64_tr_b16 v[44:45], v10 offset:49152
    ds_read_b64_tr_b16 v[46:47], v10 offset:49664
    v_mfma_f32_16x16x32_bf16 v[68:71], v[20:23], v[124:127], v[68:71]
    buffer_load_dwordx4 v[144:147], v4, s[8:11], s79 offen offset:2048 sc1
    s_waitcnt vmcnt(7)
    v_max_u32 v0, v128, v132
    s_waitcnt lgkmcnt(10)
    v_mfma_f32_16x16x32_bf16 v[56:59], v[24:27], v[120:123], v[56:59]
    ds_read_b64_tr_b16 v[16:17], v13 offset:0
    ds_read_b64_tr_b16 v[18:19], v13 offset:512
    v_mfma_f32_16x16x32_bf16 v[60:63], v[24:27], v[124:127], v[60:63]
    v_cmp_eq_u32 vcc, 0xffbfffbf, v0
    s_waitcnt lgkmcnt(10)
    v_mfma_f32_16x16x32_bf16 v[72:75], v[28:31], v[120:123], v[72:75]
    ds_read_b64_tr_b16 v[20:21], v15 offset:0
    ds_read_b64_tr_b16 v[22:23], v15 offset:512
    v_mfma_f32_16x16x32_bf16 v[76:79], v[28:31], v[124:127], v[76:79]
    buffer_load_dwordx4 v[148:151], v4, s[8:11], s79 offen offset:2304 sc1
    s_cbranch_vccnz SC_64
SC_64_R:
    s_waitcnt lgkmcnt(10)
    v_mfma_f32_16x16x32_bf16 v[48:51], v[32:35], v[128:131], v[48:51]
    ds_read_b64_tr_b16 v[24:25], v14 offset:0
    ds_read_b64_tr_b16 v[26:27], v14 offset:512
    v_mfma_f32_16x16x32_bf16 v[52:55], v[32:35], v[132:135], v[52:55]
    s_waitcnt lgkmcnt(10)
    v_mfma_f32_16x16x32_bf16 v[64:67], v[36:39], v[128:131], v[64:67]
    ds_read_b64_tr_b16 v[28:29], v253 offset:0
    ds_read_b64_tr_b16 v[30:31], v253 offset:512
    v_mfma_f32_16x16x32_bf16 v[68:71], v[36:39], v[132:135], v[68:71]
    buffer_load_dwordx4 v[152:155], v5, s[8:11], s82 offen offset:3072 sc1
    s_waitcnt vmcnt(7)
    v_max_u32 v0, v104, v108
    s_waitcnt lgkmcnt(10)
    v_mfma_f32_16x16x32_bf16 v[56:59], v[40:43], v[128:131], v[56:59]
    ds_read_b64_tr_b16 v[32:33], v13 offset:16384
    ds_read_b64_tr_b16 v[34:35], v13 offset:16896
    v_mfma_f32_16x16x32_bf16 v[60:63], v[40:43], v[132:135], v[60:63]
    v_cmp_eq_u32 vcc, 0xffbfffbf, v0
    s_waitcnt lgkmcnt(10)
    v_mfma_f32_16x16x32_bf16 v[72:75], v[44:47], v[128:131], v[72:75]
    ds_read_b64_tr_b16 v[36:37], v15 offset:16384
    ds_read_b64_tr_b16 v[38:39], v15 offset:16896
    v_mfma_f32_16x16x32_bf16 v[76:79], v[44:47], v[132:135], v[76:79]
    buffer_load_dwordx4 v[156:159], v5, s[8:11], s82 offen offset:3328 sc1
    s_cbranch_vccnz SC_65
SC_65_R:
    s_waitcnt lgkmcnt(10)
    v_mfma_f32_16x16x32_bf16 v[48:51], v[16:19], v[104:107], v[48:51]
    ds_read_b64_tr_b16 v[40:41], v14 offset:16384
    ds_read_b64_tr_b16 v[42:43], v14 offset:16896
    v_mfma_f32_16x16x32_bf16 v[52:55], v[16:19], v[108:111], v[52:55]
    s_waitcnt lgkmcnt(10)
    v_mfma_f32_16x16x32_bf16 v[64:67], v[20:23], v[104:107], v[64:67]
    ds_read_b64_tr_b16 v[44:45], v253 offset:16384
    ds_read_b64_tr_b16 v[46:47], v253 offset:16896
    v_mfma_f32_16x16x32_bf16 v[68:71], v[20:23], v[108:111], v[68:71]
    buffer_load_dwordx4 v[160:163], v5, s[8:11], s83 offen offset:3072 sc1
    s_waitcnt vmcnt(7)
    v_max_u32 v0, v112, v116
    s_waitcnt lgkmcnt(10)
    v_mfma_f32_16x16x32_bf16 v[56:59], v[24:27], v[104:107], v[56:59]
    v_mfma_f32_16x16x32_bf16 v[60:63], v[24:27], v[108:111], v[60:63]
    s_waitcnt lgkmcnt(0)
    s_barrier
    s_setprio 3
    ds_read_b64_tr_b16 v[16:17], v7 offset:0
    ds_read_b64_tr_b16 v[18:19], v7 offset:512
    v_cmp_eq_u32 vcc, 0xffbfffbf, v0
    s_waitcnt lgkmcnt(10)
    v_mfma_f32_16x16x32_bf16 v[72:75], v[28:31], v[104:107], v[72:75]
    ds_read_b64_tr_b16 v[20:21], v9 offset:0
    ds_read_b64_tr_b16 v[22:23], v9 offset:512
    v_mfma_f32_16x16x32_bf16 v[76:79], v[28:31], v[108:111], v[76:79]
    buffer_load_dwordx4 v[164:167], v5, s[8:11], s83 offen offset:3328 sc1
    s_cbranch_vccnz SC_66
SC_66_R:
    s_waitcnt lgkmcnt(10)
    v_mfma_f32_16x16x32_bf16 v[48:51], v[32:35], v[112:115], v[48:51]
    ds_read_b64_tr_b16 v[24:25], v8 offset:0
    ds_read_b64_tr_b16 v[26:27], v8 offset:512
    v_mfma_f32_16x16x32_bf16 v[52:55], v[32:35], v[116:119], v[52:55]
    buffer_load_dwordx4 v[236:239], v2, s[8:11], s75 offen sc1
    s_waitcnt lgkmcnt(10)
    v_mfma_f32_16x16x32_bf16 v[64:67], v[36:39], v[112:115], v[64:67]
    ds_read_b64_tr_b16 v[28:29], v10 offset:0
    ds_read_b64_tr_b16 v[30:31], v10 offset:512
    v_mfma_f32_16x16x32_bf16 v[68:71], v[36:39], v[116:119], v[68:71]
    s_waitcnt vmcnt(7)
    v_max_u32 v0, v136, v140
    s_waitcnt lgkmcnt(10)
    v_mfma_f32_16x16x32_bf16 v[56:59], v[40:43], v[112:115], v[56:59]
    ds_read_b64_tr_b16 v[32:33], v7 offset:16384
    ds_read_b64_tr_b16 v[34:35], v7 offset:16896
    v_mfma_f32_16x16x32_bf16 v[60:63], v[40:43], v[116:119], v[60:63]
    v_cmp_eq_u32 vcc, 0xffbfffbf, v0
    s_setprio 2
    s_waitcnt lgkmcnt(10)
    v_mfma_f32_16x16x32_bf16 v[72:75], v[44:47], v[112:115], v[72:75]
    ds_read_b64_tr_b16 v[36:37], v9 offset:16384
    ds_read_b64_tr_b16 v[38:39], v9 offset:16896
    v_mfma_f32_16x16x32_bf16 v[76:79], v[44:47], v[116:119], v[76:79]
    s_cbranch_vccnz SC_67
SC_67_R:
    s_waitcnt lgkmcnt(10)
    v_mfma_f32_16x16x32_bf16 v[48:51], v[16:19], v[136:139], v[48:51]
    ds_read_b64_tr_b16 v[40:41], v8 offset:16384
    ds_read_b64_tr_b16 v[42:43], v8 offset:16896
    v_mfma_f32_16x16x32_bf16 v[52:55], v[16:19], v[140:143], v[52:55]
    s_waitcnt lgkmcnt(10)
    v_mfma_f32_16x16x32_bf16 v[64:67], v[20:23], v[136:139], v[64:67]
    ds_read_b64_tr_b16 v[44:45], v10 offset:16384
    ds_read_b64_tr_b16 v[46:47], v10 offset:16896
    v_mfma_f32_16x16x32_bf16 v[68:71], v[20:23], v[140:143], v[68:71]
    s_waitcnt vmcnt(5)
    v_max_u32 v0, v144, v148
    s_waitcnt lgkmcnt(10)
    v_mfma_f32_16x16x32_bf16 v[56:59], v[24:27], v[136:139], v[56:59]
    ds_read_b64_tr_b16 v[16:17], v11 offset:0
    ds_read_b64_tr_b16 v[18:19], v11 offset:512
    v_mfma_f32_16x16x32_bf16 v[60:63], v[24:27], v[140:143], v[60:63]
    v_cmp_eq_u32 vcc, 0xffbfffbf, v0
    s_waitcnt lgkmcnt(10)
    v_mfma_f32_16x16x32_bf16 v[72:75], v[28:31], v[136:139], v[72:75]
    ds_read_b64_tr_b16 v[20:21], v12 offset:0
    ds_read_b64_tr_b16 v[22:23], v12 offset:512
    v_mfma_f32_16x16x32_bf16 v[76:79], v[28:31], v[140:143], v[76:79]
    s_cbranch_vccnz SC_68
SC_68_R:
    s_waitcnt lgkmcnt(10)
    v_mfma_f32_16x16x32_bf16 v[48:51], v[32:35], v[144:147], v[48:51]
    ds_read_b64_tr_b16 v[24:25], v11 offset:16384
    ds_read_b64_tr_b16 v[26:27], v11 offset:16896
    v_mfma_f32_16x16x32_bf16 v[52:55], v[32:35], v[148:151], v[52:55]
    s_setprio 1
    s_waitcnt lgkmcnt(10)
    v_mfma_f32_16x16x32_bf16 v[64:67], v[36:39], v[144:147], v[64:67]
    ds_read_b64_tr_b16 v[28:29], v12 offset:16384
    ds_read_b64_tr_b16 v[30:31], v12 offset:16896
    v_mfma_f32_16x16x32_bf16 v[68:71], v[36:39], v[148:151], v[68:71]
    s_waitcnt vmcnt(3)
    v_max3_u32 v0, v152, v154, v156
    v_max_u32 v0, v158, v0
    s_waitcnt lgkmcnt(10)
    v_mfma_f32_16x16x32_bf16 v[56:59], v[40:43], v[144:147], v[56:59]
    ds_read_b64_tr_b16 v[32:33], v92 offset:0
    ds_read_b64_tr_b16 v[34:35], v92 offset:512
    v_mfma_f32_16x16x32_bf16 v[60:63], v[40:43], v[148:151], v[60:63]
    v_cmp_eq_u32 vcc, 0xffbfffbf, v0
    s_waitcnt lgkmcnt(10)
    v_mfma_f32_16x16x32_bf16 v[72:75], v[44:47], v[144:147], v[72:75]
    ds_read_b64_tr_b16 v[36:37], v93 offset:0
    ds_read_b64_tr_b16 v[38:39], v93 offset:512
    v_mfma_f32_16x16x32_bf16 v[76:79], v[44:47], v[148:151], v[76:79]
    s_cbranch_vccnz SC_69
SC_69_R:
    s_waitcnt lgkmcnt(10)
    v_mfma_f32_16x16x32_bf16 v[48:51], v[16:19], v[152:155], v[48:51]
    ds_read_b64_tr_b16 v[40:41], v92 offset:16384
    ds_read_b64_tr_b16 v[42:43], v92 offset:16896
    v_mfma_f32_16x16x32_bf16 v[52:55], v[16:19], v[156:159], v[52:55]
    s_waitcnt vmcnt(1)
    v_max3_u32 v0, v160, v162, v164
    v_max_u32 v0, v166, v0
    v_cmp_eq_u32 vcc, 0xffbfffbf, v0
    s_waitcnt lgkmcnt(10)
    v_mfma_f32_16x16x32_bf16 v[56:59], v[20:23], v[152:155], v[56:59]
    ds_read_b64_tr_b16 v[44:45], v93 offset:16384
    ds_read_b64_tr_b16 v[46:47], v93 offset:16896
    v_mfma_f32_16x16x32_bf16 v[60:63], v[20:23], v[156:159], v[60:63]
    s_cbranch_vccnz SC_70
SC_70_R:
    s_setprio 0
    s_waitcnt lgkmcnt(10)
    v_mfma_f32_16x16x32_bf16 v[48:51], v[24:27], v[160:163], v[48:51]
    v_mfma_f32_16x16x32_bf16 v[52:55], v[24:27], v[164:167], v[52:55]
    s_waitcnt vmcnt(0)
    s_waitcnt lgkmcnt(8)
    v_mfma_f32_16x16x32_bf16 v[56:59], v[28:31], v[160:163], v[56:59]
    v_mfma_f32_16x16x32_bf16 v[60:63], v[28:31], v[164:167], v[60:63]
    v_lshlrev_b32 v80, 16, v236
    v_and_b32 v81, 0xffff0000, v236
    s_waitcnt lgkmcnt(6)
    v_mfma_f32_16x16x32_bf16 v[64:67], v[32:35], v[152:155], v[64:67]
    v_mfma_f32_16x16x32_bf16 v[68:71], v[32:35], v[156:159], v[68:71]
    v_lshlrev_b32 v82, 16, v237
    v_and_b32 v83, 0xffff0000, v237
    s_waitcnt lgkmcnt(4)
    v_mfma_f32_16x16x32_bf16 v[72:75], v[36:39], v[152:155], v[72:75]
    v_mfma_f32_16x16x32_bf16 v[76:79], v[36:39], v[156:159], v[76:79]
    v_lshlrev_b32 v84, 16, v238
    v_and_b32 v85, 0xffff0000, v238
    s_waitcnt lgkmcnt(2)
    v_mfma_f32_16x16x32_bf16 v[64:67], v[40:43], v[160:163], v[64:67]
    v_mfma_f32_16x16x32_bf16 v[68:71], v[40:43], v[164:167], v[68:71]
    v_lshlrev_b32 v86, 16, v239
    v_and_b32 v87, 0xffff0000, v239
    ds_write_b128 v248, v[48:51] offset:0
    ds_write_b128 v248, v[52:55] offset:1024
    s_waitcnt lgkmcnt(2)
    v_mfma_f32_16x16x32_bf16 v[72:75], v[44:47], v[160:163], v[72:75]
    v_mfma_f32_16x16x32_bf16 v[76:79], v[44:47], v[164:167], v[76:79]
    ds_write_b128 v251, v[56:59] offset:8192
    ds_write_b128 v251, v[60:63] offset:9216
    ds_write_b128 v248, v[64:67] offset:16384
    ds_write_b128 v248, v[68:71] offset:17408
    s_nop 2
    ds_write_b128 v251, v[72:75] offset:24576
    ds_write_b128 v251, v[76:79] offset:25600
    s_waitcnt lgkmcnt(0)
    s_barrier
    ds_read_b128 v[48:51], v249 offset:0
    ds_read_b128 v[52:55], v249 offset:256
    ds_read_b128 v[56:59], v249 offset:2048
    ds_read_b128 v[60:63], v249 offset:2304
    ds_read_b128 v[64:67], v249 offset:4096
    ds_read_b128 v[68:71], v249 offset:4352
    ds_read_b128 v[72:75], v249 offset:6144
    ds_read_b128 v[76:79], v249 offset:6400
    s_waitcnt lgkmcnt(4)
    v_pk_add_f32 v[48:49], v[48:49], v[56:57]
    v_pk_add_f32 v[50:51], v[50:51], v[58:59]
    v_pk_add_f32 v[52:53], v[52:53], v[60:61]
    v_pk_add_f32 v[54:55], v[54:55], v[62:63]
    s_waitcnt lgkmcnt(0)
    v_pk_add_f32 v[64:65], v[64:65], v[72:73]
    v_pk_add_f32 v[66:67], v[66:67], v[74:75]
    v_pk_add_f32 v[68:69], v[68:69], v[76:77]
    v_pk_add_f32 v[70:71], v[70:71], v[78:79]
    v_pk_add_f32 v[48:49], v[48:49], v[64:65]
    v_pk_add_f32 v[50:51], v[50:51], v[66:67]
    v_pk_add_f32 v[52:53], v[52:53], v[68:69]
    v_pk_add_f32 v[54:55], v[54:55], v[70:71]
    v_pk_fma_f32 v[48:49], v[48:49], v[240:241], v[80:81]
    v_pk_fma_f32 v[50:51], v[50:51], v[242:243], v[82:83]
    v_pk_fma_f32 v[52:53], v[52:53], v[244:245], v[84:85]
    v_pk_fma_f32 v[54:55], v[54:55], v[246:247], v[86:87]
    v_cvt_pk_bf16_f32 v236, v48, v49
    v_cvt_pk_bf16_f32 v237, v50, v51
    v_cvt_pk_bf16_f32 v238, v52, v53
    v_cvt_pk_bf16_f32 v239, v54, v55
    buffer_store_dwordx4 v[236:239], v2, s[12:15], s74 offen nt
END:
    s_endpgm
FW_7:
    s_sub_u32 s7, s7, 1
    s_cbranch_scc1 FW_X7
    ds_read_b32 v251, v14 offset:768
    s_waitcnt lgkmcnt(0)
    v_cmp_eq_u32 vcc, 0xff800000, v251
    s_cbranch_vccnz FW_7
    s_branch FW_R7
FW_X7:
    s_mov_b32 s7, 0
    s_branch FW_R7
FW_6:
    s_sub_u32 s7, s7, 1
    s_cbranch_scc1 FW_X6
    ds_read_b32 v251, v14 offset:640
    s_waitcnt lgkmcnt(0)
    v_cmp_eq_u32 vcc, 0xff800000, v251
    s_cbranch_vccnz FW_6
    s_branch FW_R6
FW_X6:
    s_mov_b32 s7, 0
    s_branch FW_R6
FW_5:
    s_sub_u32 s7, s7, 1
    s_cbranch_scc1 FW_X5
    ds_read_b32 v251, v14 offset:512
    s_waitcnt lgkmcnt(0)
    v_cmp_eq_u32 vcc, 0xff800000, v251
    s_cbranch_vccnz FW_5
    s_branch FW_R5
FW_X5:
    s_mov_b32 s7, 0
    s_branch FW_R5
FW_4:
    s_sub_u32 s7, s7, 1
    s_cbranch_scc1 FW_X4
    ds_read_b32 v251, v14 offset:384
    s_waitcnt lgkmcnt(0)
    v_cmp_eq_u32 vcc, 0xff800000, v251
    s_cbranch_vccnz FW_4
    s_branch FW_R4
FW_X4:
    s_mov_b32 s7, 0
    s_branch FW_R4
FW_3:
    s_sub_u32 s7, s7, 1
    s_cbranch_scc1 FW_X3
    ds_read_b32 v251, v14 offset:256
    s_waitcnt lgkmcnt(0)
    v_cmp_eq_u32 vcc, 0xff800000, v251
    s_cbranch_vccnz FW_3
    s_branch FW_R3
FW_X3:
    s_mov_b32 s7, 0
    s_branch FW_R3
FW_2:
    s_sub_u32 s7, s7, 1
    s_cbranch_scc1 FW_X2
    ds_read_b32 v251, v14 offset:128
    s_waitcnt lgkmcnt(0)
    v_cmp_eq_u32 vcc, 0xff800000, v251
    s_cbranch_vccnz FW_2
    s_branch FW_R2
FW_X2:
    s_mov_b32 s7, 0
    s_branch FW_R2
FW_1:
    s_sub_u32 s7, s7, 1
    s_cbranch_scc1 FW_X1
    ds_read_b32 v251, v14 offset:0
    s_waitcnt lgkmcnt(0)
    v_cmp_eq_u32 vcc, 0xff800000, v251
    s_cbranch_vccnz FW_1
    s_branch FW_R1
FW_X1:
    s_mov_b32 s7, 0
    s_branch FW_R1
SC_16:
    s_sub_u32 s7, s7, 1
    s_cbranch_scc1 SC_16_X
    buffer_load_dwordx4 v[16:19], v6, s[8:11], s40 offen sc1
    buffer_load_dwordx4 v[48:51], v6, s[8:11], s40 offen offset:1024 sc1
    buffer_load_dwordx4 v[20:23], v6, s[8:11], s41 offen sc1
    buffer_load_dwordx4 v[56:59], v6, s[8:11], s41 offen offset:1024 sc1
    buffer_load_dwordx4 v[24:27], v6, s[8:11], s42 offen sc1
    buffer_load_dwordx4 v[64:67], v6, s[8:11], s42 offen offset:1024 sc1
    buffer_load_dwordx4 v[28:31], v6, s[8:11], s43 offen sc1
    s_waitcnt vmcnt(0)
    v_max_u32 v0, v16, v18
    v_cmp_eq_u32 vcc, 0xffbfffbf, v0
    s_cbranch_vccnz SC_16
    s_branch SC_16_R
SC_16_X:
    s_mov_b32 s7, 0
    s_branch SC_16_R
SC_17:
    s_sub_u32 s7, s7, 1
    s_cbranch_scc1 SC_17_X
    buffer_load_dwordx4 v[48:51], v6, s[8:11], s40 offen offset:1024 sc1
    buffer_load_dwordx4 v[20:23], v6, s[8:11], s41 offen sc1
    buffer_load_dwordx4 v[56:59], v6, s[8:11], s41 offen offset:1024 sc1
    buffer_load_dwordx4 v[24:27], v6, s[8:11], s42 offen sc1
    buffer_load_dwordx4 v[64:67], v6, s[8:11], s42 offen offset:1024 sc1
    buffer_load_dwordx4 v[28:31], v6, s[8:11], s43 offen sc1
    s_waitcnt vmcnt(0)
    v_max3_u32 v0, v20, v22, v48
    v_max_u32 v0, v50, v0
    v_cmp_eq_u32 vcc, 0xffbfffbf, v0
    s_cbranch_vccnz SC_17
    s_branch SC_17_R
SC_17_X:
    s_mov_b32 s7, 0
    s_branch SC_17_R
SC_18:
    s_sub_u32 s7, s7, 1
    s_cbranch_scc1 SC_18_X
    buffer_load_dwordx4 v[56:59], v6, s[8:11], s41 offen offset:1024 sc1
    buffer_load_dwordx4 v[24:27], v6, s[8:11], s42 offen sc1
    buffer_load_dwordx4 v[64:67], v6, s[8:11], s42 offen offset:1024 sc1
    buffer_load_dwordx4 v[28:31], v6, s[8:11], s43 offen sc1
    buffer_load_dwordx4 v[72:75], v6, s[8:11], s43 offen offset:1024 sc1
    buffer_load_dwordx4 v[32:35], v6, s[8:11], s44 offen sc1
    s_waitcnt vmcnt(0)
    v_max3_u32 v0, v24, v26, v56
    v_max_u32 v0, v58, v0
    v_cmp_eq_u32 vcc, 0xffbfffbf, v0
    s_cbranch_vccnz SC_18
    s_branch SC_18_R
SC_18_X:
    s_mov_b32 s7, 0
    s_branch SC_18_R
SC_19:
    s_sub_u32 s7, s7, 1
    s_cbranch_scc1 SC_19_X
    buffer_load_dwordx4 v[64:67], v6, s[8:11], s42 offen offset:1024 sc1
    buffer_load_dwordx4 v[28:31], v6, s[8:11], s43 offen sc1
    buffer_load_dwordx4 v[72:75], v6, s[8:11], s43 offen offset:1024 sc1
    buffer_load_dwordx4 v[32:35], v6, s[8:11], s44 offen sc1
    buffer_load_dwordx4 v[80:83], v6, s[8:11], s44 offen offset:1024 sc1
    buffer_load_dwordx4 v[36:39], v6, s[8:11], s45 offen sc1
    s_waitcnt vmcnt(0)
    v_max3_u32 v0, v28, v30, v64
    v_max_u32 v0, v66, v0
    v_cmp_eq_u32 vcc, 0xffbfffbf, v0
    s_cbranch_vccnz SC_19
    s_branch SC_19_R
SC_19_X:
    s_mov_b32 s7, 0
    s_branch SC_19_R
SC_20:
    s_sub_u32 s7, s7, 1
    s_cbranch_scc1 SC_20_X
    buffer_load_dwordx4 v[72:75], v6, s[8:11], s43 offen offset:1024 sc1
    buffer_load_dwordx4 v[32:35], v6, s[8:11], s44 offen sc1
    buffer_load_dwordx4 v[80:83], v6, s[8:11], s44 offen offset:1024 sc1
    buffer_load_dwordx4 v[36:39], v6, s[8:11], s45 offen sc1
    buffer_load_dwordx4 v[88:91], v6, s[8:11], s45 offen offset:1024 sc1
    buffer_load_dwordx4 v[40:43], v6, s[8:11], s46 offen sc1
    s_waitcnt vmcnt(0)
    v_max3_u32 v0, v32, v34, v72
    v_max_u32 v0, v74, v0
    v_cmp_eq_u32 vcc, 0xffbfffbf, v0
    s_cbranch_vccnz SC_20
    s_branch SC_20_R
SC_20_X:
    s_mov_b32 s7, 0
    s_branch SC_20_R
QF_P:
    v_mov_b32 v3, s6
    s_mov_b64 exec, 1
    buffer_store_dword v3, off, s[8:11], s32 sc1
    s_mov_b64 exec, -1
    s_branch QF_PR
SC_21:
    s_sub_u32 s7, s7, 1
    s_cbranch_scc1 SC_21_X
    buffer_load_dwordx4 v[80:83], v6, s[8:11], s44 offen offset:1024 sc1
    buffer_load_dwordx4 v[36:39], v6, s[8:11], s45 offen sc1
    buffer_load_dwordx4 v[88:91], v6, s[8:11], s45 offen offset:1024 sc1
    buffer_load_dwordx4 v[40:43], v6, s[8:11], s46 offen sc1
    buffer_load_dwordx4 v[96:99], v6, s[8:11], s46 offen offset:1024 sc1
    buffer_load_dwordx4 v[44:47], v6, s[8:11], s47 offen sc1
    s_waitcnt vmcnt(0)
    v_max3_u32 v0, v36, v38, v80
    v_max_u32 v0, v82, v0
    v_cmp_eq_u32 vcc, 0xffbfffbf, v0
    s_cbranch_vccnz SC_21
    s_branch SC_21_R
SC_21_X:
    s_mov_b32 s7, 0
    s_branch SC_21_R
SC_22:
    s_sub_u32 s7, s7, 1
    s_cbranch_scc1 SC_22_X
    buffer_load_dwordx4 v[88:91], v6, s[8:11], s45 offen offset:1024 sc1
    buffer_load_dwordx4 v[40:43], v6, s[8:11], s46 offen sc1
    buffer_load_dwordx4 v[96:99], v6, s[8:11], s46 offen offset:1024 sc1
    buffer_load_dwordx4 v[44:47], v6, s[8:11], s47 offen sc1
    buffer_load_dwordx4 v[104:107], v6, s[8:11], s47 offen offset:1024 sc1
    s_waitcnt vmcnt(0)
    v_max3_u32 v0, v40, v42, v88
    v_max_u32 v0, v90, v0
    v_cmp_eq_u32 vcc, 0xffbfffbf, v0
    s_cbranch_vccnz SC_22
    s_branch SC_22_R
SC_22_X:
    s_mov_b32 s7, 0
    s_branch SC_22_R
SC_23:
    s_sub_u32 s7, s7, 1
    s_cbranch_scc1 SC_23_X
    buffer_load_dwordx4 v[96:99], v6, s[8:11], s46 offen offset:1024 sc1
    buffer_load_dwordx4 v[44:47], v6, s[8:11], s47 offen sc1
    buffer_load_dwordx4 v[104:107], v6, s[8:11], s47 offen offset:1024 sc1
    s_waitcnt vmcnt(0)
    v_max3_u32 v0, v44, v46, v96
    v_max_u32 v0, v98, v0
    v_cmp_eq_u32 vcc, 0xffbfffbf, v0
    s_cbranch_vccnz SC_23
    s_branch SC_23_R
SC_23_X:
    s_mov_b32 s7, 0
    s_branch SC_23_R
SC_24:
    s_sub_u32 s7, s7, 1
    s_cbranch_scc1 SC_24_X
    buffer_load_dwordx4 v[104:107], v6, s[8:11], s47 offen offset:1024 sc1
    s_waitcnt vmcnt(0)
    v_max_u32 v0, v104, v106
    v_cmp_eq_u32 vcc, 0xffbfffbf, v0
    s_cbranch_vccnz SC_24
    s_branch SC_24_R
SC_24_X:
    s_mov_b32 s7, 0
    s_branch SC_24_R
QF_C:
    s_sub_u32 s7, s7, 1
    s_cbranch_scc1 QF_X
    s_lshl_b32 s60, s34, 7
    v_and_b32 v15, 15, v1
    s_add_u32 s60, s60, 32768
    v_lshlrev_b32 v15, 2, v15
    buffer_load_dword v15, v15, s[8:11], s60 offen sc1
    s_waitcnt vmcnt(0)
    v_cmp_ne_u32 vcc, s6, v15
    s_cbranch_vccnz QF_C
    s_branch QF_CR
QF_X:
    s_mov_b32 s7, 0
    s_branch QF_CR
CB_26_B:
    v_mov_b32 v245, 117504
    ds_write_b32 v245, v13
    s_branch CB_26
LP_A:
    v_lshrrev_b32 v248, 1, v1
    v_lshlrev_b32 v248, 13, v248
    v_and_b32 v244, 16, v6
    v_add3_u32 v248, v248, v244, s38
    s_lshl_b32 s60, s3, 10
    s_lshl_b32 s61, s4, 5
    s_add_u32 s60, s60, s61
    buffer_load_dwordx4 v[244:247], v248, s[8:11], s60 offen sc1
    s_branch LP_AR
LP_B:
    s_lshl_b32 s60, s3, 10
    s_lshl_b32 s61, s4, 5
    s_add_u32 s60, s60, s61
    s_waitcnt vmcnt(6)
LP_C:
    v_perm_b32 v249, v245, v244, s58
    v_perm_b32 v250, v247, v246, s59
    v_or_b32 v249, v249, v250
    v_cmp_ne_u32 vcc, s6, v249
    s_cbranch_vccz LP_X
    s_sub_u32 s7, s7, 1
    s_cbranch_scc1 LP_E
    buffer_load_dwordx4 v[244:247], v248, s[8:11], s60 offen sc1
    s_waitcnt vmcnt(0)
    s_branch LP_C
LP_E:
    s_mov_b32 s7, 0
LP_X:
    v_and_b32 v244, 0xffffff00, v244
    v_and_b32 v245, 0xffffff00, v245
    v_and_b32 v246, 0xffffff00, v246
    v_and_b32 v247, 0xffffff00, v247
    s_lshr_b32 s61, s3, 1
    s_cmp_eq_u32 s61, 2
    s_cselect_b32 s62, 1.0, 0
    s_add_u32 s60, s60, 20480
    v_mov_b32 v248, s6
    v_permlane32_swap_b32 v244, v245
    v_permlane32_swap_b32 v246, v247
    v_add_f32 v244, v244, v245
    v_add_f32 v246, v246, v247
    s_nop 1
    v_permlane16_swap_b32 v244, v246
    v_add_f32 v244, v244, v246
    s_nop 1
    v_add_f32_dpp v244, v244, v244 row_ror:8 row_mask:0xf bank_mask:0xf
    s_nop 1
    v_add_f32_dpp v244, v244, v244 row_ror:4 row_mask:0xf bank_mask:0xf
    s_nop 1
    v_add_f32_dpp v244, v244, v244 row_ror:2 row_mask:0xf bank_mask:0xf
    v_cvt_pk_bf16_f32 v244, v244, v244
    v_and_b32 v244, 0xffff0000, v244
    v_add_f32 v244, s62, v244
    v_cvt_pk_bf16_f32 v244, v244, v244
    v_mov_b32 v246, v244
    s_nop 1
    v_permlane16_swap_b32 v244, v246
    v_mov_b32 v245, v244
    v_mov_b32 v247, v246
    s_nop 0
    v_permlane32_swap_b32 v244, v245
    v_permlane32_swap_b32 v246, v247
    s_mov_b32 s61, 0x7060c00
    v_perm_b32 v244, v244, v248, s61
    s_mov_b32 s61, 0x7060c01
    v_perm_b32 v245, v245, v248, s61
    s_mov_b32 s61, 0x7060c02
    v_perm_b32 v246, v246, v248, s61
    s_mov_b32 s61, 0x7060c03
    v_perm_b32 v247, v247, v248, s61
    s_mov_b64 exec, 3
    buffer_store_dwordx4 v[244:247], v6, s[8:11], s60 offen sc1
    s_mov_b64 exec, -1
    s_branch LP_BR
CB_28_B:
    v_mov_b32 v245, 117504
    ds_write_b32 v245, v13
    s_branch CB_28
CB_30_B:
    v_mov_b32 v245, 117504
    ds_write_b32 v245, v13
    s_branch CB_30
CB_32_B:
    v_mov_b32 v245, 117504
    ds_write_b32 v245, v13
    s_branch CB_32
CB_34_B:
    v_mov_b32 v245, 117504
    ds_write_b32 v245, v13
    s_branch CB_34
CB_36_B:
    v_mov_b32 v245, 117504
    ds_write_b32 v245, v13
    s_branch CB_36
MC_37:
    s_mov_b32 s61, 200000
MC_37_L:
    buffer_load_dwordx4 v[2:5], v15, s[8:11], s39 offen sc1
    s_waitcnt vmcnt(0)
    v_perm_b32 v244, v3, v2, s58
    v_perm_b32 v245, v5, v4, s59
    v_or_b32 v244, v244, v245
    v_cmp_ne_u32 vcc, s6, v244
    s_nop 4
    s_cbranch_vccz MC_37_R
    s_sub_u32 s61, s61, 1
    s_cbranch_scc0 MC_37_L
    s_branch MC_37_R
CB_39_B:
    v_mov_b32 v245, 117504
    ds_write_b32 v245, v13
    s_branch CB_39
CB_41_B:
    v_mov_b32 v245, 117504
    ds_write_b32 v245, v13
    s_branch CB_41
EP_W:
    v_mov_b32 v0, s6
    s_mov_b64 exec, 1
    buffer_store_dword v0, off, s[8:11], 0 sc1
    s_mov_b64 exec, -1
    s_branch EP_R
SC_42:
    s_sub_u32 s7, s7, 1
    s_cbranch_scc1 SC_42_X
    s_and_b32 s60, s7, 31
    s_cbranch_scc1 SC_42_F
    buffer_wbl2 sc1
SC_42_F:
    buffer_load_dwordx4 v[104:107], v3, s[8:11], s66 offen offset:0 sc1
    buffer_load_dwordx4 v[108:111], v3, s[8:11], s66 offen offset:256 sc1
    buffer_load_dwordx4 v[112:115], v3, s[8:11], s66 offen offset:2048 sc1
    buffer_load_dwordx4 v[116:119], v3, s[8:11], s66 offen offset:2304 sc1
    s_waitcnt vmcnt(0)
    v_max3_u32 v0, v104, v108, v112
    v_max_u32 v0, v116, v0
    v_cmp_eq_u32 vcc, 0xffbfffbf, v0
    s_cbranch_vccnz SC_42
    s_branch SC_42_R
SC_42_X:
    s_mov_b32 s7, 0
    s_branch SC_42_R
SC_43:
    s_sub_u32 s7, s7, 1
    s_cbranch_scc1 SC_43_X
    s_and_b32 s60, s7, 31
    s_cbranch_scc1 SC_43_F
    buffer_wbl2 sc1
SC_43_F:
    buffer_load_dwordx4 v[120:123], v3, s[8:11], s67 offen offset:0 sc1
    buffer_load_dwordx4 v[124:127], v3, s[8:11], s67 offen offset:256 sc1
    s_waitcnt vmcnt(0)
    v_max_u32 v0, v120, v124
    v_cmp_eq_u32 vcc, 0xffbfffbf, v0
    s_cbranch_vccnz SC_43
    s_branch SC_43_R
SC_43_X:
    s_mov_b32 s7, 0
    s_branch SC_43_R
SC_44:
    s_sub_u32 s7, s7, 1
    s_cbranch_scc1 SC_44_X
    s_and_b32 s60, s7, 31
    s_cbranch_scc1 SC_44_F
    buffer_wbl2 sc1
SC_44_F:
    buffer_load_dwordx4 v[128:131], v3, s[8:11], s67 offen offset:2048 sc1
    buffer_load_dwordx4 v[132:135], v3, s[8:11], s67 offen offset:2304 sc1
    s_waitcnt vmcnt(0)
    v_max_u32 v0, v128, v132
    v_cmp_eq_u32 vcc, 0xffbfffbf, v0
    s_cbranch_vccnz SC_44
    s_branch SC_44_R
SC_44_X:
    s_mov_b32 s7, 0
    s_branch SC_44_R
SC_45:
    s_sub_u32 s7, s7, 1
    s_cbranch_scc1 SC_45_X
    s_and_b32 s60, s7, 31
    s_cbranch_scc1 SC_45_F
    buffer_wbl2 sc1
SC_45_F:
    buffer_load_dwordx4 v[136:139], v3, s[8:11], s68 offen offset:0 sc1
    buffer_load_dwordx4 v[140:143], v3, s[8:11], s68 offen offset:256 sc1
    s_waitcnt vmcnt(0)
    v_max_u32 v0, v136, v140
    v_cmp_eq_u32 vcc, 0xffbfffbf, v0
    s_cbranch_vccnz SC_45
    s_branch SC_45_R
SC_45_X:
    s_mov_b32 s7, 0
    s_branch SC_45_R
SC_46:
    s_sub_u32 s7, s7, 1
    s_cbranch_scc1 SC_46_X
    s_and_b32 s60, s7, 31
    s_cbranch_scc1 SC_46_F
    buffer_wbl2 sc1
SC_46_F:
    buffer_load_dwordx4 v[144:147], v3, s[8:11], s68 offen offset:2048 sc1
    buffer_load_dwordx4 v[148:151], v3, s[8:11], s68 offen offset:2304 sc1
    s_waitcnt vmcnt(0)
    v_max_u32 v0, v144, v148
    v_cmp_eq_u32 vcc, 0xffbfffbf, v0
    s_cbranch_vccnz SC_46
    s_branch SC_46_R
SC_46_X:
    s_mov_b32 s7, 0
    s_branch SC_46_R
SC_47:
    s_sub_u32 s7, s7, 1
    s_cbranch_scc1 SC_47_X
    s_and_b32 s60, s7, 31
    s_cbranch_scc1 SC_47_F
    buffer_wbl2 sc1
SC_47_F:
    buffer_load_dwordx4 v[152:155], v3, s[8:11], s69 offen offset:0 sc1
    buffer_load_dwordx4 v[156:159], v3, s[8:11], s69 offen offset:256 sc1
    s_waitcnt vmcnt(0)
    v_max_u32 v0, v152, v156
    v_cmp_eq_u32 vcc, 0xffbfffbf, v0
    s_cbranch_vccnz SC_47
    s_branch SC_47_R
SC_47_X:
    s_mov_b32 s7, 0
    s_branch SC_47_R
SC_48:
    s_sub_u32 s7, s7, 1
    s_cbranch_scc1 SC_48_X
    s_and_b32 s60, s7, 31
    s_cbranch_scc1 SC_48_F
    buffer_wbl2 sc1
SC_48_F:
    buffer_load_dwordx4 v[160:163], v3, s[8:11], s69 offen offset:2048 sc1
    buffer_load_dwordx4 v[164:167], v3, s[8:11], s69 offen offset:2304 sc1
    s_waitcnt vmcnt(0)
    v_max_u32 v0, v160, v164
    v_cmp_eq_u32 vcc, 0xffbfffbf, v0
    s_cbranch_vccnz SC_48
    s_branch SC_48_R
SC_48_X:
    s_mov_b32 s7, 0
    s_branch SC_48_R
SC_49:
    s_sub_u32 s7, s7, 1
    s_cbranch_scc1 SC_49_X
    s_and_b32 s60, s7, 31
    s_cbranch_scc1 SC_49_F
    buffer_wbl2 sc1
SC_49_F:
    buffer_load_dwordx4 v[104:107], v3, s[8:11], s70 offen offset:0 sc1
    buffer_load_dwordx4 v[108:111], v3, s[8:11], s70 offen offset:256 sc1
    s_waitcnt vmcnt(0)
    v_max_u32 v0, v104, v108
    v_cmp_eq_u32 vcc, 0xffbfffbf, v0
    s_cbranch_vccnz SC_49
    s_branch SC_49_R
SC_49_X:
    s_mov_b32 s7, 0
    s_branch SC_49_R
SC_50:
    s_sub_u32 s7, s7, 1
    s_cbranch_scc1 SC_50_X
    s_and_b32 s60, s7, 31
    s_cbranch_scc1 SC_50_F
    buffer_wbl2 sc1
SC_50_F:
    buffer_load_dwordx4 v[112:115], v3, s[8:11], s70 offen offset:2048 sc1
    buffer_load_dwordx4 v[116:119], v3, s[8:11], s70 offen offset:2304 sc1
    s_waitcnt vmcnt(0)
    v_max_u32 v0, v112, v116
    v_cmp_eq_u32 vcc, 0xffbfffbf, v0
    s_cbranch_vccnz SC_50
    s_branch SC_50_R
SC_50_X:
    s_mov_b32 s7, 0
    s_branch SC_50_R
SC_51:
    s_sub_u32 s7, s7, 1
    s_cbranch_scc1 SC_51_X
    s_and_b32 s60, s7, 31
    s_cbranch_scc1 SC_51_F
    buffer_wbl2 sc1
SC_51_F:
    buffer_load_dwordx4 v[120:123], v3, s[8:11], s71 offen offset:0 sc1
    buffer_load_dwordx4 v[124:127], v3, s[8:11], s71 offen offset:256 sc1
    s_waitcnt vmcnt(0)
    v_max_u32 v0, v120, v124
    v_cmp_eq_u32 vcc, 0xffbfffbf, v0
    s_cbranch_vccnz SC_51
    s_branch SC_51_R
SC_51_X:
    s_mov_b32 s7, 0
    s_branch SC_51_R
SC_52:
    s_sub_u32 s7, s7, 1
    s_cbranch_scc1 SC_52_X
    s_and_b32 s60, s7, 31
    s_cbranch_scc1 SC_52_F
    buffer_wbl2 sc1
SC_52_F:
    buffer_load_dwordx4 v[128:131], v3, s[8:11], s71 offen offset:2048 sc1
    buffer_load_dwordx4 v[132:135], v3, s[8:11], s71 offen offset:2304 sc1
    s_waitcnt vmcnt(0)
    v_max_u32 v0, v128, v132
    v_cmp_eq_u32 vcc, 0xffbfffbf, v0
    s_cbranch_vccnz SC_52
    s_branch SC_52_R
SC_52_X:
    s_mov_b32 s7, 0
    s_branch SC_52_R
SC_53:
    s_sub_u32 s7, s7, 1
    s_cbranch_scc1 SC_53_X
    s_and_b32 s60, s7, 31
    s_cbranch_scc1 SC_53_F
    buffer_wbl2 sc1
SC_53_F:
    buffer_load_dwordx4 v[136:139], v3, s[8:11], s72 offen offset:0 sc1
    buffer_load_dwordx4 v[140:143], v3, s[8:11], s72 offen offset:256 sc1
    s_waitcnt vmcnt(0)
    v_max_u32 v0, v136, v140
    v_cmp_eq_u32 vcc, 0xffbfffbf, v0
    s_cbranch_vccnz SC_53
    s_branch SC_53_R
SC_53_X:
    s_mov_b32 s7, 0
    s_branch SC_53_R
SC_54:
    s_sub_u32 s7, s7, 1
    s_cbranch_scc1 SC_54_X
    s_and_b32 s60, s7, 31
    s_cbranch_scc1 SC_54_F
    buffer_wbl2 sc1
SC_54_F:
    buffer_load_dwordx4 v[144:147], v3, s[8:11], s72 offen offset:2048 sc1
    buffer_load_dwordx4 v[148:151], v3, s[8:11], s72 offen offset:2304 sc1
    s_waitcnt vmcnt(0)
    v_max_u32 v0, v144, v148
    v_cmp_eq_u32 vcc, 0xffbfffbf, v0
    s_cbranch_vccnz SC_54
    s_branch SC_54_R
SC_54_X:
    s_mov_b32 s7, 0
    s_branch SC_54_R
SC_55:
    s_sub_u32 s7, s7, 1
    s_cbranch_scc1 SC_55_X
    s_and_b32 s60, s7, 31
    s_cbranch_scc1 SC_55_F
    buffer_wbl2 sc1
SC_55_F:
    buffer_load_dwordx4 v[152:155], v3, s[8:11], s73 offen offset:0 sc1
    buffer_load_dwordx4 v[156:159], v3, s[8:11], s73 offen offset:256 sc1
    s_waitcnt vmcnt(0)
    v_max_u32 v0, v152, v156
    v_cmp_eq_u32 vcc, 0xffbfffbf, v0
    s_cbranch_vccnz SC_55
    s_branch SC_55_R
SC_55_X:
    s_mov_b32 s7, 0
    s_branch SC_55_R
SC_56:
    s_sub_u32 s7, s7, 1
    s_cbranch_scc1 SC_56_X
    s_and_b32 s60, s7, 31
    s_cbranch_scc1 SC_56_F
    buffer_wbl2 sc1
SC_56_F:
    buffer_load_dwordx4 v[160:163], v3, s[8:11], s73 offen offset:2048 sc1
    buffer_load_dwordx4 v[164:167], v3, s[8:11], s73 offen offset:2304 sc1
    s_waitcnt vmcnt(0)
    v_max_u32 v0, v160, v164
    v_cmp_eq_u32 vcc, 0xffbfffbf, v0
    s_cbranch_vccnz SC_56
    s_branch SC_56_R
SC_56_X:
    s_mov_b32 s7, 0
    s_branch SC_56_R
SC_57:
    s_sub_u32 s7, s7, 1
    s_cbranch_scc1 SC_57_X
    s_and_b32 s60, s7, 31
    s_cbranch_scc1 SC_57_F
    buffer_wbl2 sc1
SC_57_F:
    buffer_load_dwordx4 v[104:107], v4, s[8:11], s76 offen offset:0 sc1
    buffer_load_dwordx4 v[108:111], v4, s[8:11], s76 offen offset:256 sc1
    s_waitcnt vmcnt(0)
    v_max_u32 v0, v104, v108
    v_cmp_eq_u32 vcc, 0xffbfffbf, v0
    s_cbranch_vccnz SC_57
    s_branch SC_57_R
SC_57_X:
    s_mov_b32 s7, 0
    s_branch SC_57_R
SC_58:
    s_sub_u32 s7, s7, 1
    s_cbranch_scc1 SC_58_X
    s_and_b32 s60, s7, 31
    s_cbranch_scc1 SC_58_F
    buffer_wbl2 sc1
SC_58_F:
    buffer_load_dwordx4 v[112:115], v4, s[8:11], s77 offen offset:0 sc1
    buffer_load_dwordx4 v[116:119], v4, s[8:11], s77 offen offset:256 sc1
    s_waitcnt vmcnt(0)
    v_max_u32 v0, v112, v116
    v_cmp_eq_u32 vcc, 0xffbfffbf, v0
    s_cbranch_vccnz SC_58
    s_branch SC_58_R
SC_58_X:
    s_mov_b32 s7, 0
    s_branch SC_58_R
SC_59:
    s_sub_u32 s7, s7, 1
    s_cbranch_scc1 SC_59_X
    s_and_b32 s60, s7, 31
    s_cbranch_scc1 SC_59_F
    buffer_wbl2 sc1
SC_59_F:
    buffer_load_dwordx4 v[136:139], v4, s[8:11], s78 offen offset:0 sc1
    buffer_load_dwordx4 v[140:143], v4, s[8:11], s78 offen offset:256 sc1
    s_waitcnt vmcnt(0)
    v_max_u32 v0, v136, v140
    v_cmp_eq_u32 vcc, 0xffbfffbf, v0
    s_cbranch_vccnz SC_59
    s_branch SC_59_R
SC_59_X:
    s_mov_b32 s7, 0
    s_branch SC_59_R
SC_60:
    s_sub_u32 s7, s7, 1
    s_cbranch_scc1 SC_60_X
    s_and_b32 s60, s7, 31
    s_cbranch_scc1 SC_60_F
    buffer_wbl2 sc1
SC_60_F:
    buffer_load_dwordx4 v[144:147], v4, s[8:11], s79 offen offset:0 sc1
    buffer_load_dwordx4 v[148:151], v4, s[8:11], s79 offen offset:256 sc1
    s_waitcnt vmcnt(0)
    v_max_u32 v0, v144, v148
    v_cmp_eq_u32 vcc, 0xffbfffbf, v0
    s_cbranch_vccnz SC_60
    s_branch SC_60_R
SC_60_X:
    s_mov_b32 s7, 0
    s_branch SC_60_R
SC_61:
    s_sub_u32 s7, s7, 1
    s_cbranch_scc1 SC_61_X
    s_and_b32 s60, s7, 31
    s_cbranch_scc1 SC_61_F
    buffer_wbl2 sc1
SC_61_F:
    buffer_load_dwordx4 v[152:155], v4, s[8:11], s76 offen offset:1024 sc1
    buffer_load_dwordx4 v[156:159], v4, s[8:11], s76 offen offset:1280 sc1
    s_waitcnt vmcnt(0)
    v_max_u32 v0, v152, v156
    v_cmp_eq_u32 vcc, 0xffbfffbf, v0
    s_cbranch_vccnz SC_61
    s_branch SC_61_R
SC_61_X:
    s_mov_b32 s7, 0
    s_branch SC_61_R
SC_62:
    s_sub_u32 s7, s7, 1
    s_cbranch_scc1 SC_62_X
    s_and_b32 s60, s7, 31
    s_cbranch_scc1 SC_62_F
    buffer_wbl2 sc1
SC_62_F:
    buffer_load_dwordx4 v[160:163], v4, s[8:11], s77 offen offset:1024 sc1
    buffer_load_dwordx4 v[164:167], v4, s[8:11], s77 offen offset:1280 sc1
    s_waitcnt vmcnt(0)
    v_max_u32 v0, v160, v164
    v_cmp_eq_u32 vcc, 0xffbfffbf, v0
    s_cbranch_vccnz SC_62
    s_branch SC_62_R
SC_62_X:
    s_mov_b32 s7, 0
    s_branch SC_62_R
SC_63:
    s_sub_u32 s7, s7, 1
    s_cbranch_scc1 SC_63_X
    s_and_b32 s60, s7, 31
    s_cbranch_scc1 SC_63_F
    buffer_wbl2 sc1
SC_63_F:
    buffer_load_dwordx4 v[120:123], v4, s[8:11], s78 offen offset:1024 sc1
    buffer_load_dwordx4 v[124:127], v4, s[8:11], s78 offen offset:1280 sc1
    s_waitcnt vmcnt(0)
    v_max_u32 v0, v120, v124
    v_cmp_eq_u32 vcc, 0xffbfffbf, v0
    s_cbranch_vccnz SC_63
    s_branch SC_63_R
SC_63_X:
    s_mov_b32 s7, 0
    s_branch SC_63_R
SC_64:
    s_sub_u32 s7, s7, 1
    s_cbranch_scc1 SC_64_X
    s_and_b32 s60, s7, 31
    s_cbranch_scc1 SC_64_F
    buffer_wbl2 sc1
SC_64_F:
    buffer_load_dwordx4 v[128:131], v4, s[8:11], s79 offen offset:1024 sc1
    buffer_load_dwordx4 v[132:135], v4, s[8:11], s79 offen offset:1280 sc1
    s_waitcnt vmcnt(0)
    v_max_u32 v0, v128, v132
    v_cmp_eq_u32 vcc, 0xffbfffbf, v0
    s_cbranch_vccnz SC_64
    s_branch SC_64_R
SC_64_X:
    s_mov_b32 s7, 0
    s_branch SC_64_R
SC_65:
    s_sub_u32 s7, s7, 1
    s_cbranch_scc1 SC_65_X
    s_and_b32 s60, s7, 31
    s_cbranch_scc1 SC_65_F
    buffer_wbl2 sc1
SC_65_F:
    buffer_load_dwordx4 v[104:107], v4, s[8:11], s76 offen offset:2048 sc1
    buffer_load_dwordx4 v[108:111], v4, s[8:11], s76 offen offset:2304 sc1
    s_waitcnt vmcnt(0)
    v_max_u32 v0, v104, v108
    v_cmp_eq_u32 vcc, 0xffbfffbf, v0
    s_cbranch_vccnz SC_65
    s_branch SC_65_R
SC_65_X:
    s_mov_b32 s7, 0
    s_branch SC_65_R
SC_66:
    s_sub_u32 s7, s7, 1
    s_cbranch_scc1 SC_66_X
    s_and_b32 s60, s7, 31
    s_cbranch_scc1 SC_66_F
    buffer_wbl2 sc1
SC_66_F:
    buffer_load_dwordx4 v[112:115], v4, s[8:11], s77 offen offset:2048 sc1
    buffer_load_dwordx4 v[116:119], v4, s[8:11], s77 offen offset:2304 sc1
    s_waitcnt vmcnt(0)
    v_max_u32 v0, v112, v116
    v_cmp_eq_u32 vcc, 0xffbfffbf, v0
    s_cbranch_vccnz SC_66
    s_branch SC_66_R
SC_66_X:
    s_mov_b32 s7, 0
    s_branch SC_66_R
SC_67:
    s_sub_u32 s7, s7, 1
    s_cbranch_scc1 SC_67_X
    s_and_b32 s60, s7, 31
    s_cbranch_scc1 SC_67_F
    buffer_wbl2 sc1
SC_67_F:
    buffer_load_dwordx4 v[136:139], v4, s[8:11], s78 offen offset:2048 sc1
    buffer_load_dwordx4 v[140:143], v4, s[8:11], s78 offen offset:2304 sc1
    s_waitcnt vmcnt(0)
    v_max_u32 v0, v136, v140
    v_cmp_eq_u32 vcc, 0xffbfffbf, v0
    s_cbranch_vccnz SC_67
    s_branch SC_67_R
SC_67_X:
    s_mov_b32 s7, 0
    s_branch SC_67_R
SC_68:
    s_sub_u32 s7, s7, 1
    s_cbranch_scc1 SC_68_X
    s_and_b32 s60, s7, 31
    s_cbranch_scc1 SC_68_F
    buffer_wbl2 sc1
SC_68_F:
    buffer_load_dwordx4 v[144:147], v4, s[8:11], s79 offen offset:2048 sc1
    buffer_load_dwordx4 v[148:151], v4, s[8:11], s79 offen offset:2304 sc1
    s_waitcnt vmcnt(0)
    v_max_u32 v0, v144, v148
    v_cmp_eq_u32 vcc, 0xffbfffbf, v0
    s_cbranch_vccnz SC_68
    s_branch SC_68_R
SC_68_X:
    s_mov_b32 s7, 0
    s_branch SC_68_R
SC_69:
    s_sub_u32 s7, s7, 1
    s_cbranch_scc1 SC_69_X
    s_and_b32 s60, s7, 31
    s_cbranch_scc1 SC_69_F
    buffer_wbl2 sc1
SC_69_F:
    buffer_load_dwordx4 v[152:155], v5, s[8:11], s82 offen offset:3072 sc1
    buffer_load_dwordx4 v[156:159], v5, s[8:11], s82 offen offset:3328 sc1
    s_waitcnt vmcnt(0)
    v_max3_u32 v0, v152, v154, v156
    v_max_u32 v0, v158, v0
    v_cmp_eq_u32 vcc, 0xffbfffbf, v0
    s_cbranch_vccnz SC_69
    s_branch SC_69_R
SC_69_X:
    s_mov_b32 s7, 0
    s_branch SC_69_R
SC_70:
    s_sub_u32 s7, s7, 1
    s_cbranch_scc1 SC_70_X
    s_and_b32 s60, s7, 31
    s_cbranch_scc1 SC_70_F
    buffer_wbl2 sc1
SC_70_F:
    buffer_load_dwordx4 v[160:163], v5, s[8:11], s83 offen offset:3072 sc1
    buffer_load_dwordx4 v[164:167], v5, s[8:11], s83 offen offset:3328 sc1
    s_waitcnt vmcnt(0)
    v_max3_u32 v0, v160, v162, v164
    v_max_u32 v0, v166, v0
    v_cmp_eq_u32 vcc, 0xffbfffbf, v0
    s_cbranch_vccnz SC_70
    s_branch SC_70_R
SC_70_X:
    s_mov_b32 s7, 0
    s_branch SC_70_R
P2_SLOW:
    s_movk_i32 s98, 4
    s_waitcnt vmcnt(0)
    s_nop 15
    s_barrier
    s_mov_b32 s60, 0x3f803f80
    s_mov_b32 s61, s60
    s_mov_b64 s[62:63], 0
    v_pk_mov_b32 v[52:53], s[62:63], s[62:63]
    s_mov_b32 exec_lo, 0x10001
    s_mov_b32 exec_hi, 0x10001
    v_pk_mov_b32 v[52:53], s[60:61], s[60:61]
    s_mov_b64 exec, -1
    v_pk_mov_b32 v[54:55], v[52:53], v[52:53]
    v_pk_mov_b32 v[60:61], v[52:53], v[52:53]
    v_pk_mov_b32 v[62:63], v[52:53], v[52:53]
    v_pk_mov_b32 v[68:69], v[52:53], v[52:53]
    v_pk_mov_b32 v[70:71], v[52:53], v[52:53]
    v_pk_mov_b32 v[76:77], v[52:53], v[52:53]
    v_pk_mov_b32 v[78:79], v[52:53], v[52:53]
    v_pk_mov_b32 v[84:85], v[52:53], v[52:53]
    v_pk_mov_b32 v[86:87], v[52:53], v[52:53]
    v_pk_mov_b32 v[92:93], v[52:53], v[52:53]
    v_pk_mov_b32 v[94:95], v[52:53], v[52:53]
    v_pk_mov_b32 v[100:101], v[52:53], v[52:53]
    v_pk_mov_b32 v[102:103], v[52:53], v[52:53]
    v_pk_mov_b32 v[108:109], v[52:53], v[52:53]
    v_pk_mov_b32 v[110:111], v[52:53], v[52:53]
    v_pk_mov_b32 v[240:241], s[62:63], s[62:63]
    v_pk_mov_b32 v[242:243], s[62:63], s[62:63]
    v_mov_b32 v13, 0xdddddddd
    s_lshl_b32 s60, s5, 11
    s_add_u32 s60, s60, 131072
    v_add_u32 v8, s60, v6
    s_lshl_b32 s60, s5, 10
    s_add_u32 s60, s60, 122880
    v_lshl_add_u32 v252, v1, 2, s60
    s_cmp_lt_u32 s5, 4
    s_cselect_b32 s62, 128, 0
    s_add_u32 s62, s62, 122880
    s_and_b32 s60, s5, 3
    s_lshl_b32 s61, s60, 9
    s_add_u32 s61, s61, 131072
    v_lshl_add_u32 v9, v1, 3, s61
    v_lshrrev_b32 v5, 1, v1
    v_lshl_add_u32 v253, v5, 2, s62
    v_and_b32 v5, 7, v5
    v_lshlrev_b32 v10, 4, v5
    v_lshrrev_b32 v5, 4, v1
    v_lshl_add_u32 v10, v5, 8, v10
    v_and_b32 v5, 1, v1
    v_lshl_add_u32 v10, v5, 2, v10
    s_lshr_b32 s61, s60, 1
    s_lshl_b32 s61, s61, 7
    s_and_b32 s60, s60, 1
    s_lshl_b32 s60, s60, 3
    s_add_u32 s60, s60, s61
    s_add_u32 s60, s60, 114944
    v_add_u32 v10, s60, v10
    v_and_b32 v5, 7, v1
    v_lshlrev_b32 v11, 4, v5
    v_lshrrev_b32 v5, 4, v1
    v_lshl_add_u32 v11, v5, 7, v11
    v_add_u32 v11, 114944, v11
    s_min_u32 s60, s5, 6
    s_lshl_b32 s54, s60, 10
    s_lshl_b32 s60, s60, 6
    v_add_u32 v4, s60, v1
    v_mul_u32_u24 v5, 9363, v4
    v_lshrrev_b32 v5, 16, v5
    v_mul_u32_u24 v14, 3472, v5
    v_lshl_add_u32 v14, v4, 4, v14
    s_mul_i32 s61, s4, 112
    v_add_u32 v14, s61, v14
    s_and_b32 s60, s4, 7
    s_mul_i32 s51, s60, 229376
    s_and_b32 s60, s4, 3
    s_lshl_b32 s60, s60, 12
    s_lshl_b32 s61, s5, 14
    s_add_u32 s61, s61, 65536
    s_add_u32 s40, s60, s61
    s_add_u32 s60, s60, 2048
    s_and_b32 s60, s60, 16383
    s_add_u32 s41, s60, s61
    s_add_u32 s60, s60, 2048
    s_and_b32 s60, s60, 16383
    s_add_u32 s42, s60, s61
    s_add_u32 s60, s60, 2048
    s_and_b32 s60, s60, 16383
    s_add_u32 s43, s60, s61
    s_add_u32 s60, s60, 2048
    s_and_b32 s60, s60, 16383
    s_add_u32 s44, s60, s61
    s_add_u32 s60, s60, 2048
    s_and_b32 s60, s60, 16383
    s_add_u32 s45, s60, s61
    s_add_u32 s60, s60, 2048
    s_and_b32 s60, s60, 16383
    s_add_u32 s46, s60, s61
    s_add_u32 s60, s60, 2048
    s_and_b32 s60, s60, 16383
    s_add_u32 s47, s60, s61
    s_lshl_b32 s55, s3, 5
    s_add_u32 s55, s55, s4
    s_lshl_b32 s55, s55, 13
    s_add_u32 s55, s55, 1048576
    s_and_b32 s56, s4, 3
    s_lshl_b32 s56, s56, 11
    s_lshl_b32 s57, s5, 12
    s_add_u32 s57, s57, 3145728
    v_mov_b32 v12, v14
    s_add_u32 s48, s55, s56
    buffer_load_dwordx4 v[160:163], v6, s[8:11], s48 offen sc1
    buffer_load_dwordx4 v[16:19], v6, s[8:11], s40 offen sc1
    buffer_load_dwordx4 v[48:51], v6, s[8:11], s40 offen offset:1024 sc1
    buffer_load_dwordx4 v[20:23], v6, s[8:11], s41 offen sc1
    buffer_load_dwordx4 v[56:59], v6, s[8:11], s41 offen offset:1024 sc1
    buffer_load_dwordx4 v[24:27], v6, s[8:11], s42 offen sc1
    buffer_load_dwordx4 v[64:67], v6, s[8:11], s42 offen offset:1024 sc1
    buffer_load_dwordx4 v[28:31], v6, s[8:11], s43 offen sc1
    v_mfma_f32_32x32x16_bf16 v[144:159], v[240:243], v[240:243], 0
    buffer_load_dwordx4 v[32:35], v6, s[8:11], s44 offen sc1
    buffer_load_dwordx4 v[36:39], v6, s[8:11], s45 offen sc1
    buffer_load_dwordx4 v[40:43], v6, s[8:11], s46 offen sc1
    buffer_load_dwordx4 v[44:47], v6, s[8:11], s47 offen sc1
    v_and_b32 v254, 31, v1
    v_lshlrev_b32 v254, 2, v254
    v_add_u32 v254, 119616, v254
    s_lshl_b32 s60, s5, 7
    v_add_u32 v3, s60, v254
    v_mov_b32 v4, 0xff800000
    ds_write_b32 v3, v4
    v_mov_b32 v3, v254
    s_mov_b32 s60, 0
    s_waitcnt lgkmcnt(0)
    s_barrier
P2_SL:
    s_add_u32 s61, s56, s60
    s_and_b32 s61, s61, 8191
    s_add_u32 s61, s61, s55
    buffer_load_dwordx4 v[164:167], v6, s[8:11], s61 offen sc1
    v_mov_b32 v4, 0xff800000
    s_waitcnt vmcnt(0)
    v_mfma_f32_32x32x16_bf16 v[112:127], v[16:19], v[164:167], 0
    s_nop 11
    v_max3_f32 v4, v112, v113, v4
    v_max3_f32 v4, v114, v115, v4
    v_max3_f32 v4, v116, v117, v4
    v_max3_f32 v4, v118, v119, v4
    v_max3_f32 v4, v120, v121, v4
    v_max3_f32 v4, v122, v123, v4
    v_max3_f32 v4, v124, v125, v4
    v_max3_f32 v4, v126, v127, v4
    v_mfma_f32_32x32x16_bf16 v[112:127], v[20:23], v[164:167], 0
    s_nop 11
    v_max3_f32 v4, v112, v113, v4
    v_max3_f32 v4, v114, v115, v4
    v_max3_f32 v4, v116, v117, v4
    v_max3_f32 v4, v118, v119, v4
    v_max3_f32 v4, v120, v121, v4
    v_max3_f32 v4, v122, v123, v4
    v_max3_f32 v4, v124, v125, v4
    v_max3_f32 v4, v126, v127, v4
    v_mfma_f32_32x32x16_bf16 v[112:127], v[24:27], v[164:167], 0
    s_nop 11
    v_max3_f32 v4, v112, v113, v4
    v_max3_f32 v4, v114, v115, v4
    v_max3_f32 v4, v116, v117, v4
    v_max3_f32 v4, v118, v119, v4
    v_max3_f32 v4, v120, v121, v4
    v_max3_f32 v4, v122, v123, v4
    v_max3_f32 v4, v124, v125, v4
    v_max3_f32 v4, v126, v127, v4
    v_mfma_f32_32x32x16_bf16 v[112:127], v[28:31], v[164:167], 0
    s_nop 11
    v_max3_f32 v4, v112, v113, v4
    v_max3_f32 v4, v114, v115, v4
    v_max3_f32 v4, v116, v117, v4
    v_max3_f32 v4, v118, v119, v4
    v_max3_f32 v4, v120, v121, v4
    v_max3_f32 v4, v122, v123, v4
    v_max3_f32 v4, v124, v125, v4
    v_max3_f32 v4, v126, v127, v4
    v_mfma_f32_32x32x16_bf16 v[112:127], v[32:35], v[164:167], 0
    s_nop 11
    v_max3_f32 v4, v112, v113, v4
    v_max3_f32 v4, v114, v115, v4
    v_max3_f32 v4, v116, v117, v4
    v_max3_f32 v4, v118, v119, v4
    v_max3_f32 v4, v120, v121, v4
    v_max3_f32 v4, v122, v123, v4
    v_max3_f32 v4, v124, v125, v4
    v_max3_f32 v4, v126, v127, v4
    v_mfma_f32_32x32x16_bf16 v[112:127], v[36:39], v[164:167], 0
    s_nop 11
    v_max3_f32 v4, v112, v113, v4
    v_max3_f32 v4, v114, v115, v4
    v_max3_f32 v4, v116, v117, v4
    v_max3_f32 v4, v118, v119, v4
    v_max3_f32 v4, v120, v121, v4
    v_max3_f32 v4, v122, v123, v4
    v_max3_f32 v4, v124, v125, v4
    v_max3_f32 v4, v126, v127, v4
    v_mfma_f32_32x32x16_bf16 v[112:127], v[40:43], v[164:167], 0
    s_nop 11
    v_max3_f32 v4, v112, v113, v4
    v_max3_f32 v4, v114, v115, v4
    v_max3_f32 v4, v116, v117, v4
    v_max3_f32 v4, v118, v119, v4
    v_max3_f32 v4, v120, v121, v4
    v_max3_f32 v4, v122, v123, v4
    v_max3_f32 v4, v124, v125, v4
    v_max3_f32 v4, v126, v127, v4
    v_mfma_f32_32x32x16_bf16 v[112:127], v[44:47], v[164:167], 0
    s_nop 11
    v_max3_f32 v4, v112, v113, v4
    v_max3_f32 v4, v114, v115, v4
    v_max3_f32 v4, v116, v117, v4
    v_max3_f32 v4, v118, v119, v4
    v_max3_f32 v4, v120, v121, v4
    v_max3_f32 v4, v122, v123, v4
    v_max3_f32 v4, v124, v125, v4
    v_max3_f32 v4, v126, v127, v4
    ds_max_f32 v3, v4
    v_add_u32 v3, 128, v3
    s_add_u32 s60, s60, 1024
    s_cmp_lt_u32 s60, 8192
    s_cbranch_scc1 P2_SL
    s_waitcnt lgkmcnt(0)
    s_barrier
    v_mfma_f32_32x32x16_bf16 v[112:127], v[16:19], v[160:163], 0
    s_setprio 3
    ds_read_b32 v14, v254 offset:0
    s_waitcnt lgkmcnt(0)
    s_nop 8
    v_sub_f32 v112, v112, v14
    v_exp_f32 v112, v112
    v_sub_f32 v113, v113, v14
    v_exp_f32 v113, v113
    v_sub_f32 v114, v114, v14
    v_exp_f32 v114, v114
    v_sub_f32 v115, v115, v14
    v_exp_f32 v115, v115
    s_waitcnt vmcnt(4)
    v_sub_f32 v116, v116, v14
    v_exp_f32 v116, v116
    v_mfma_f32_32x32x16_bf16 v[128:143], v[20:23], v[160:163], 0
    v_sub_f32 v117, v117, v14
    v_exp_f32 v117, v117
    v_permlane16_swap_b32 v48, v52
    v_sub_f32 v118, v118, v14
    v_exp_f32 v118, v118
    v_permlane16_swap_b32 v49, v53
    buffer_load_dwordx4 v[72:75], v6, s[8:11], s43 offen offset:1024 sc1
    v_sub_f32 v119, v119, v14
    v_exp_f32 v119, v119
    v_permlane16_swap_b32 v50, v54
    buffer_load_dwordx4 v[32:35], v6, s[8:11], s44 offen sc1
    v_sub_f32 v120, v120, v14
    v_exp_f32 v120, v120
    v_permlane16_swap_b32 v51, v55
    v_sub_f32 v121, v121, v14
    v_exp_f32 v121, v121
    v_sub_f32 v122, v122, v14
    v_exp_f32 v122, v122
    v_smfmac_f32_32x32x32_bf16 v[144:159], v[48:51], v[112:119], v13
    v_sub_f32 v123, v123, v14
    v_exp_f32 v123, v123
    v_sub_f32 v124, v124, v14
    v_exp_f32 v124, v124
    v_sub_f32 v125, v125, v14
    v_exp_f32 v125, v125
    v_sub_f32 v126, v126, v14
    v_exp_f32 v126, v126
    v_sub_f32 v127, v127, v14
    v_exp_f32 v127, v127
    s_setprio 2
    v_sub_f32 v128, v128, v14
    v_exp_f32 v128, v128
    v_sub_f32 v129, v129, v14
    v_exp_f32 v129, v129
    v_smfmac_f32_32x32x32_bf16 v[144:159], v[52:55], v[120:127], v13
    v_sub_f32 v130, v130, v14
    v_exp_f32 v130, v130
    v_sub_f32 v131, v131, v14
    v_exp_f32 v131, v131
    s_waitcnt vmcnt(4)
    v_sub_f32 v132, v132, v14
    v_exp_f32 v132, v132
    v_mfma_f32_32x32x16_bf16 v[112:127], v[24:27], v[160:163], 0
    v_sub_f32 v133, v133, v14
    v_exp_f32 v133, v133
    v_permlane16_swap_b32 v56, v60
    v_sub_f32 v134, v134, v14
    v_exp_f32 v134, v134
    v_permlane16_swap_b32 v57, v61
    buffer_load_dwordx4 v[80:83], v6, s[8:11], s44 offen offset:1024 sc1
    v_sub_f32 v135, v135, v14
    v_exp_f32 v135, v135
    v_permlane16_swap_b32 v58, v62
    buffer_load_dwordx4 v[36:39], v6, s[8:11], s45 offen sc1
    v_sub_f32 v136, v136, v14
    v_exp_f32 v136, v136
    v_permlane16_swap_b32 v59, v63
    v_sub_f32 v137, v137, v14
    v_exp_f32 v137, v137
    v_sub_f32 v138, v138, v14
    v_exp_f32 v138, v138
    v_smfmac_f32_32x32x32_bf16 v[144:159], v[56:59], v[128:135], v13
    v_sub_f32 v139, v139, v14
    v_exp_f32 v139, v139
    v_sub_f32 v140, v140, v14
    v_exp_f32 v140, v140
    v_sub_f32 v141, v141, v14
    v_exp_f32 v141, v141
    v_sub_f32 v142, v142, v14
    v_exp_f32 v142, v142
    v_sub_f32 v143, v143, v14
    v_exp_f32 v143, v143
    v_sub_f32 v112, v112, v14
    v_exp_f32 v112, v112
    v_sub_f32 v113, v113, v14
    v_exp_f32 v113, v113
    v_smfmac_f32_32x32x32_bf16 v[144:159], v[60:63], v[136:143], v13
    v_sub_f32 v114, v114, v14
    v_exp_f32 v114, v114
    s_add_u32 s48, s56, 1024
    s_and_b32 s48, s48, 8191
    s_add_u32 s48, s48, s55
    v_sub_f32 v115, v115, v14
    v_exp_f32 v115, v115
    s_waitcnt vmcnt(4)
    buffer_load_dwordx4 v[164:167], v6, s[8:11], s48 offen sc1
    v_sub_f32 v116, v116, v14
    v_exp_f32 v116, v116
    v_mfma_f32_32x32x16_bf16 v[128:143], v[28:31], v[160:163], 0
    v_sub_f32 v117, v117, v14
    v_exp_f32 v117, v117
    v_permlane16_swap_b32 v64, v68
    v_sub_f32 v118, v118, v14
    v_exp_f32 v118, v118
    v_permlane16_swap_b32 v65, v69
    buffer_load_dwordx4 v[88:91], v6, s[8:11], s45 offen offset:1024 sc1
    v_sub_f32 v119, v119, v14
    v_exp_f32 v119, v119
    v_permlane16_swap_b32 v66, v70
    buffer_load_dwordx4 v[40:43], v6, s[8:11], s46 offen sc1
    v_sub_f32 v120, v120, v14
    v_exp_f32 v120, v120
    v_permlane16_swap_b32 v67, v71
    v_sub_f32 v121, v121, v14
    v_exp_f32 v121, v121
    v_sub_f32 v122, v122, v14
    v_exp_f32 v122, v122
    v_smfmac_f32_32x32x32_bf16 v[144:159], v[64:67], v[112:119], v13
    v_sub_f32 v123, v123, v14
    v_exp_f32 v123, v123
    v_sub_f32 v124, v124, v14
    v_exp_f32 v124, v124
    v_sub_f32 v125, v125, v14
    v_exp_f32 v125, v125
    v_sub_f32 v126, v126, v14
    v_exp_f32 v126, v126
    v_sub_f32 v127, v127, v14
    v_exp_f32 v127, v127
    v_sub_f32 v128, v128, v14
    v_exp_f32 v128, v128
    v_sub_f32 v129, v129, v14
    v_exp_f32 v129, v129
    v_smfmac_f32_32x32x32_bf16 v[144:159], v[68:71], v[120:127], v13
    v_sub_f32 v130, v130, v14
    v_exp_f32 v130, v130
    v_sub_f32 v131, v131, v14
    v_exp_f32 v131, v131
    s_waitcnt vmcnt(5)
    v_sub_f32 v132, v132, v14
    v_exp_f32 v132, v132
    v_mfma_f32_32x32x16_bf16 v[112:127], v[32:35], v[160:163], 0
    v_sub_f32 v133, v133, v14
    v_exp_f32 v133, v133
    v_permlane16_swap_b32 v72, v76
    v_sub_f32 v134, v134, v14
    v_exp_f32 v134, v134
    v_permlane16_swap_b32 v73, v77
    buffer_load_dwordx4 v[96:99], v6, s[8:11], s46 offen offset:1024 sc1
    v_sub_f32 v135, v135, v14
    v_exp_f32 v135, v135
    v_permlane16_swap_b32 v74, v78
    buffer_load_dwordx4 v[44:47], v6, s[8:11], s47 offen sc1
    v_sub_f32 v136, v136, v14
    v_exp_f32 v136, v136
    v_permlane16_swap_b32 v75, v79
    v_sub_f32 v137, v137, v14
    v_exp_f32 v137, v137
    v_sub_f32 v138, v138, v14
    v_exp_f32 v138, v138
    v_smfmac_f32_32x32x32_bf16 v[144:159], v[72:75], v[128:135], v13
    v_sub_f32 v139, v139, v14
    v_exp_f32 v139, v139
    v_sub_f32 v140, v140, v14
    v_exp_f32 v140, v140
    v_sub_f32 v141, v141, v14
    v_exp_f32 v141, v141
    v_sub_f32 v142, v142, v14
    v_exp_f32 v142, v142
    v_sub_f32 v143, v143, v14
    v_exp_f32 v143, v143
    s_setprio 1
    v_sub_f32 v112, v112, v14
    v_exp_f32 v112, v112
    v_sub_f32 v113, v113, v14
    v_exp_f32 v113, v113
    v_smfmac_f32_32x32x32_bf16 v[144:159], v[76:79], v[136:143], v13
    v_sub_f32 v114, v114, v14
    v_exp_f32 v114, v114
    v_sub_f32 v115, v115, v14
    v_exp_f32 v115, v115
    s_waitcnt vmcnt(5)
    v_sub_f32 v116, v116, v14
    v_exp_f32 v116, v116
    v_mfma_f32_32x32x16_bf16 v[128:143], v[36:39], v[160:163], 0
    v_sub_f32 v117, v117, v14
    v_exp_f32 v117, v117
    v_permlane16_swap_b32 v80, v84
    v_sub_f32 v118, v118, v14
    v_exp_f32 v118, v118
    v_permlane16_swap_b32 v81, v85
    buffer_load_dwordx4 v[104:107], v6, s[8:11], s47 offen offset:1024 sc1
    v_sub_f32 v119, v119, v14
    v_exp_f32 v119, v119
    v_permlane16_swap_b32 v82, v86
    v_sub_f32 v120, v120, v14
    v_exp_f32 v120, v120
    v_permlane16_swap_b32 v83, v87
    v_sub_f32 v121, v121, v14
    v_exp_f32 v121, v121
    v_sub_f32 v122, v122, v14
    v_exp_f32 v122, v122
    v_smfmac_f32_32x32x32_bf16 v[144:159], v[80:83], v[112:119], v13
    v_sub_f32 v123, v123, v14
    v_exp_f32 v123, v123
    v_sub_f32 v124, v124, v14
    v_exp_f32 v124, v124
    v_sub_f32 v125, v125, v14
    v_exp_f32 v125, v125
    v_sub_f32 v126, v126, v14
    v_exp_f32 v126, v126
    v_sub_f32 v127, v127, v14
    v_exp_f32 v127, v127
    v_sub_f32 v128, v128, v14
    v_exp_f32 v128, v128
    v_sub_f32 v129, v129, v14
    v_exp_f32 v129, v129
    v_smfmac_f32_32x32x32_bf16 v[144:159], v[84:87], v[120:127], v13
    v_sub_f32 v130, v130, v14
    v_exp_f32 v130, v130
    v_sub_f32 v131, v131, v14
    v_exp_f32 v131, v131
    s_waitcnt vmcnt(3)
    v_sub_f32 v132, v132, v14
    v_exp_f32 v132, v132
    v_mfma_f32_32x32x16_bf16 v[112:127], v[40:43], v[160:163], 0
    v_sub_f32 v133, v133, v14
    v_exp_f32 v133, v133
    v_permlane16_swap_b32 v88, v92
    v_sub_f32 v134, v134, v14
    v_exp_f32 v134, v134
    v_permlane16_swap_b32 v89, v93
    v_sub_f32 v135, v135, v14
    v_exp_f32 v135, v135
    v_permlane16_swap_b32 v90, v94
    v_sub_f32 v136, v136, v14
    v_exp_f32 v136, v136
    v_permlane16_swap_b32 v91, v95
    v_sub_f32 v137, v137, v14
    v_exp_f32 v137, v137
    v_sub_f32 v138, v138, v14
    v_exp_f32 v138, v138
    v_smfmac_f32_32x32x32_bf16 v[144:159], v[88:91], v[128:135], v13
    v_sub_f32 v139, v139, v14
    v_exp_f32 v139, v139
    v_sub_f32 v140, v140, v14
    v_exp_f32 v140, v140
    v_sub_f32 v141, v141, v14
    v_exp_f32 v141, v141
    v_sub_f32 v142, v142, v14
    v_exp_f32 v142, v142
    v_sub_f32 v143, v143, v14
    v_exp_f32 v143, v143
    v_sub_f32 v112, v112, v14
    v_exp_f32 v112, v112
    v_sub_f32 v113, v113, v14
    v_exp_f32 v113, v113
    v_smfmac_f32_32x32x32_bf16 v[144:159], v[92:95], v[136:143], v13
    v_sub_f32 v114, v114, v14
    v_exp_f32 v114, v114
    v_sub_f32 v115, v115, v14
    v_exp_f32 v115, v115
    s_waitcnt vmcnt(1)
    v_sub_f32 v116, v116, v14
    v_exp_f32 v116, v116
    v_mfma_f32_32x32x16_bf16 v[128:143], v[44:47], v[160:163], 0
    v_sub_f32 v117, v117, v14
    v_exp_f32 v117, v117
    v_permlane16_swap_b32 v96, v100
    v_sub_f32 v118, v118, v14
    v_exp_f32 v118, v118
    v_permlane16_swap_b32 v97, v101
    v_sub_f32 v119, v119, v14
    v_exp_f32 v119, v119
    v_permlane16_swap_b32 v98, v102
    v_sub_f32 v120, v120, v14
    v_exp_f32 v120, v120
    v_permlane16_swap_b32 v99, v103
    v_sub_f32 v121, v121, v14
    v_exp_f32 v121, v121
    v_sub_f32 v122, v122, v14
    v_exp_f32 v122, v122
    v_smfmac_f32_32x32x32_bf16 v[144:159], v[96:99], v[112:119], v13
    v_sub_f32 v123, v123, v14
    v_exp_f32 v123, v123
    v_sub_f32 v124, v124, v14
    v_exp_f32 v124, v124
    v_sub_f32 v125, v125, v14
    v_exp_f32 v125, v125
    v_sub_f32 v126, v126, v14
    v_exp_f32 v126, v126
    v_sub_f32 v127, v127, v14
    v_exp_f32 v127, v127
    v_sub_f32 v128, v128, v14
    v_exp_f32 v128, v128
    v_sub_f32 v129, v129, v14
    v_exp_f32 v129, v129
    v_smfmac_f32_32x32x32_bf16 v[144:159], v[100:103], v[120:127], v13
    v_sub_f32 v130, v130, v14
    v_exp_f32 v130, v130
    v_sub_f32 v131, v131, v14
    v_exp_f32 v131, v131
    s_waitcnt vmcnt(0)
    s_waitcnt vmcnt(5)
    v_sub_f32 v132, v132, v14
    v_exp_f32 v132, v132
    v_mfma_f32_32x32x16_bf16 v[112:127], v[16:19], v[164:167], 0
    v_sub_f32 v133, v133, v14
    v_exp_f32 v133, v133
    v_permlane16_swap_b32 v104, v108
    v_sub_f32 v134, v134, v14
    v_exp_f32 v134, v134
    v_permlane16_swap_b32 v105, v109
    v_sub_f32 v135, v135, v14
    v_exp_f32 v135, v135
    v_permlane16_swap_b32 v106, v110
    v_sub_f32 v136, v136, v14
    v_exp_f32 v136, v136
    v_permlane16_swap_b32 v107, v111
    v_sub_f32 v137, v137, v14
    v_exp_f32 v137, v137
    v_sub_f32 v138, v138, v14
    v_exp_f32 v138, v138
    v_smfmac_f32_32x32x32_bf16 v[144:159], v[104:107], v[128:135], v13
    v_sub_f32 v139, v139, v14
    v_exp_f32 v139, v139
    v_sub_f32 v140, v140, v14
    v_exp_f32 v140, v140
    v_sub_f32 v141, v141, v14
    v_exp_f32 v141, v141
    v_sub_f32 v142, v142, v14
    v_exp_f32 v142, v142
    v_sub_f32 v143, v143, v14
    v_exp_f32 v143, v143
    ds_read_b32 v14, v254 offset:128
    s_waitcnt lgkmcnt(0)
    v_sub_f32 v112, v112, v14
    v_exp_f32 v112, v112
    v_sub_f32 v113, v113, v14
    v_exp_f32 v113, v113
    v_smfmac_f32_32x32x32_bf16 v[144:159], v[108:111], v[136:143], v13
    v_sub_f32 v114, v114, v14
    v_exp_f32 v114, v114
    v_sub_f32 v115, v115, v14
    v_exp_f32 v115, v115
    v_sub_f32 v116, v116, v14
    v_exp_f32 v116, v116
    v_mfma_f32_32x32x16_bf16 v[128:143], v[20:23], v[164:167], 0
    v_sub_f32 v117, v117, v14
    v_exp_f32 v117, v117
    v_sub_f32 v118, v118, v14
    v_exp_f32 v118, v118
    v_sub_f32 v119, v119, v14
    v_exp_f32 v119, v119
    v_sub_f32 v120, v120, v14
    v_exp_f32 v120, v120
    v_sub_f32 v121, v121, v14
    v_exp_f32 v121, v121
    v_sub_f32 v122, v122, v14
    v_exp_f32 v122, v122
    v_sub_f32 v123, v123, v14
    v_exp_f32 v123, v123
    v_sub_f32 v124, v124, v14
    v_exp_f32 v124, v124
    ds_write_b128 v8, v[144:147] offset:0
    v_sub_f32 v125, v125, v14
    v_exp_f32 v125, v125
    ds_write_b128 v8, v[148:151] offset:1024
    v_sub_f32 v126, v126, v14
    v_exp_f32 v126, v126
    s_mov_b32 exec_hi, 0
    ds_write_b32 v252, v152 offset:0
    s_mov_b32 exec_hi, -1
    v_sub_f32 v127, v127, v14
    v_exp_f32 v127, v127
    v_mfma_f32_32x32x16_bf16 v[144:159], v[240:243], v[240:243], 0
    v_smfmac_f32_32x32x32_bf16 v[144:159], v[48:51], v[112:119], v13
    s_setprio 0
    v_sub_f32 v128, v128, v14
    v_exp_f32 v128, v128
    v_sub_f32 v129, v129, v14
    v_exp_f32 v129, v129
    v_smfmac_f32_32x32x32_bf16 v[144:159], v[52:55], v[120:127], v13
    v_sub_f32 v130, v130, v14
    v_exp_f32 v130, v130
    v_sub_f32 v131, v131, v14
    v_exp_f32 v131, v131
    v_sub_f32 v132, v132, v14
    v_exp_f32 v132, v132
    v_mfma_f32_32x32x16_bf16 v[112:127], v[24:27], v[164:167], 0
    v_sub_f32 v133, v133, v14
    v_exp_f32 v133, v133
    v_sub_f32 v134, v134, v14
    v_exp_f32 v134, v134
    v_sub_f32 v135, v135, v14
    v_exp_f32 v135, v135
    v_sub_f32 v136, v136, v14
    v_exp_f32 v136, v136
    v_sub_f32 v137, v137, v14
    v_exp_f32 v137, v137
    v_sub_f32 v138, v138, v14
    v_exp_f32 v138, v138
    v_smfmac_f32_32x32x32_bf16 v[144:159], v[56:59], v[128:135], v13
    v_sub_f32 v139, v139, v14
    v_exp_f32 v139, v139
    v_sub_f32 v140, v140, v14
    v_exp_f32 v140, v140
    v_sub_f32 v141, v141, v14
    v_exp_f32 v141, v141
    v_sub_f32 v142, v142, v14
    v_exp_f32 v142, v142
    v_sub_f32 v143, v143, v14
    v_exp_f32 v143, v143
    s_setprio 3
    v_sub_f32 v112, v112, v14
    v_exp_f32 v112, v112
    v_sub_f32 v113, v113, v14
    v_exp_f32 v113, v113
    v_smfmac_f32_32x32x32_bf16 v[144:159], v[60:63], v[136:143], v13
    v_sub_f32 v114, v114, v14
    v_exp_f32 v114, v114
    s_add_u32 s48, s56, 2048
    s_and_b32 s48, s48, 8191
    s_add_u32 s48, s48, s55
    v_sub_f32 v115, v115, v14
    v_exp_f32 v115, v115
    buffer_load_dwordx4 v[160:163], v6, s[8:11], s48 offen sc1
    v_sub_f32 v116, v116, v14
    v_exp_f32 v116, v116
    v_mfma_f32_32x32x16_bf16 v[128:143], v[28:31], v[164:167], 0
    v_sub_f32 v117, v117, v14
    v_exp_f32 v117, v117
    v_sub_f32 v118, v118, v14
    v_exp_f32 v118, v118
    v_sub_f32 v119, v119, v14
    v_exp_f32 v119, v119
    v_sub_f32 v120, v120, v14
    v_exp_f32 v120, v120
    v_sub_f32 v121, v121, v14
    v_exp_f32 v121, v121
    v_sub_f32 v122, v122, v14
    v_exp_f32 v122, v122
    v_smfmac_f32_32x32x32_bf16 v[144:159], v[64:67], v[112:119], v13
    v_sub_f32 v123, v123, v14
    v_exp_f32 v123, v123
    v_sub_f32 v124, v124, v14
    v_exp_f32 v124, v124
    v_sub_f32 v125, v125, v14
    v_exp_f32 v125, v125
    v_sub_f32 v126, v126, v14
    v_exp_f32 v126, v126
    v_sub_f32 v127, v127, v14
    v_exp_f32 v127, v127
    s_waitcnt lgkmcnt(0)
    s_barrier
    v_sub_f32 v128, v128, v14
    v_exp_f32 v128, v128
    s_bitcmp0_b32 s5, 2
    s_cbranch_scc1 CB_71
    ds_read2st64_b32 v[244:245], v253 offset0:0 offset1:4
    ds_read2st64_b32 v[246:247], v253 offset0:8 offset1:12
    ds_read2st64_b32 v[248:249], v253 offset0:16 offset1:20
    ds_read2st64_b32 v[250:251], v253 offset0:24 offset1:28
    ds_read2st64_b64 v[224:227], v9 offset0:0 offset1:4
    ds_read2st64_b64 v[228:231], v9 offset0:8 offset1:12
    ds_read2st64_b64 v[232:235], v9 offset0:16 offset1:20
    ds_read2st64_b64 v[236:239], v9 offset0:24 offset1:28
CB_71:
    v_sub_f32 v129, v129, v14
    v_exp_f32 v129, v129
    v_smfmac_f32_32x32x32_bf16 v[144:159], v[68:71], v[120:127], v13
    v_sub_f32 v130, v130, v14
    v_exp_f32 v130, v130
    v_sub_f32 v131, v131, v14
    v_exp_f32 v131, v131
    v_sub_f32 v132, v132, v14
    v_exp_f32 v132, v132
    v_mfma_f32_32x32x16_bf16 v[112:127], v[32:35], v[164:167], 0
    v_sub_f32 v133, v133, v14
    v_exp_f32 v133, v133
    v_sub_f32 v134, v134, v14
    v_exp_f32 v134, v134
    v_sub_f32 v135, v135, v14
    v_exp_f32 v135, v135
    v_sub_f32 v136, v136, v14
    v_exp_f32 v136, v136
    v_sub_f32 v137, v137, v14
    v_exp_f32 v137, v137
    s_bitcmp0_b32 s5, 2
    s_cbranch_scc1 CB_72
    s_waitcnt lgkmcnt(4)
    v_pk_add_f32 v[244:245], v[244:245], v[246:247]
    v_pk_add_f32 v[248:249], v[248:249], v[250:251]
    v_pk_add_f32 v[244:245], v[244:245], v[248:249]
    v_add_f32 v245, v244, v245
    v_rcp_f32 v244, v245
    s_waitcnt lgkmcnt(0)
    v_pk_add_f32 v[224:225], v[224:225], v[226:227]
    v_pk_add_f32 v[228:229], v[228:229], v[230:231]
    v_pk_add_f32 v[232:233], v[232:233], v[234:235]
    v_pk_add_f32 v[236:237], v[236:237], v[238:239]
    v_pk_add_f32 v[224:225], v[224:225], v[228:229]
    v_pk_add_f32 v[232:233], v[232:233], v[236:237]
    v_pk_add_f32 v[224:225], v[224:225], v[232:233]
    v_mul_f32 v224, v224, v244
    v_mul_f32 v225, v225, v244
    v_cvt_pk_bf16_f32 v226, v224, v225
    ds_write_b32 v10, v226 offset:0
CB_72:
    v_sub_f32 v138, v138, v14
    v_exp_f32 v138, v138
    v_smfmac_f32_32x32x32_bf16 v[144:159], v[72:75], v[128:135], v13
    v_sub_f32 v139, v139, v14
    v_exp_f32 v139, v139
    s_add_u32 s49, s56, 0
    s_and_b32 s49, s49, 8191
    s_lshl_b32 s49, s49, 6
    s_add_u32 s49, s49, s57
    s_add_u32 s50, s49, 32768
    v_sub_f32 v140, v140, v14
    v_exp_f32 v140, v140
    v_sub_f32 v141, v141, v14
    v_exp_f32 v141, v141
    buffer_load_dwordx4 v[184:187], v6, s[8:11], s49 offen offset:0 sc1
    v_sub_f32 v142, v142, v14
    v_exp_f32 v142, v142
    v_sub_f32 v143, v143, v14
    v_exp_f32 v143, v143
    v_sub_f32 v112, v112, v14
    v_exp_f32 v112, v112
    v_sub_f32 v113, v113, v14
    v_exp_f32 v113, v113
    v_smfmac_f32_32x32x32_bf16 v[144:159], v[76:79], v[136:143], v13
    v_sub_f32 v114, v114, v14
    v_exp_f32 v114, v114
    v_sub_f32 v115, v115, v14
    v_exp_f32 v115, v115
    v_sub_f32 v116, v116, v14
    v_exp_f32 v116, v116
    v_mfma_f32_32x32x16_bf16 v[128:143], v[36:39], v[164:167], 0
    v_sub_f32 v117, v117, v14
    v_exp_f32 v117, v117
    v_sub_f32 v118, v118, v14
    v_exp_f32 v118, v118
    v_sub_f32 v119, v119, v14
    v_exp_f32 v119, v119
    v_sub_f32 v120, v120, v14
    v_exp_f32 v120, v120
    v_sub_f32 v121, v121, v14
    v_exp_f32 v121, v121
    v_sub_f32 v122, v122, v14
    v_exp_f32 v122, v122
    v_smfmac_f32_32x32x32_bf16 v[144:159], v[80:83], v[112:119], v13
    v_sub_f32 v123, v123, v14
    v_exp_f32 v123, v123
    v_sub_f32 v124, v124, v14
    v_exp_f32 v124, v124
    v_sub_f32 v125, v125, v14
    v_exp_f32 v125, v125
    buffer_load_dwordx4 v[188:191], v6, s[8:11], s49 offen offset:1024 sc1
    v_sub_f32 v126, v126, v14
    v_exp_f32 v126, v126
    v_sub_f32 v127, v127, v14
    v_exp_f32 v127, v127
    s_setprio 2
    v_sub_f32 v128, v128, v14
    v_exp_f32 v128, v128
    v_sub_f32 v129, v129, v14
    v_exp_f32 v129, v129
    v_smfmac_f32_32x32x32_bf16 v[144:159], v[84:87], v[120:127], v13
    v_sub_f32 v130, v130, v14
    v_exp_f32 v130, v130
    v_sub_f32 v131, v131, v14
    v_exp_f32 v131, v131
    v_sub_f32 v132, v132, v14
    v_exp_f32 v132, v132
    v_mfma_f32_32x32x16_bf16 v[112:127], v[40:43], v[164:167], 0
    v_sub_f32 v133, v133, v14
    v_exp_f32 v133, v133
    v_sub_f32 v134, v134, v14
    v_exp_f32 v134, v134
    v_sub_f32 v135, v135, v14
    v_exp_f32 v135, v135
    v_pk_mov_b32 v[216:217], v[240:241], v[240:241]
    v_sub_f32 v136, v136, v14
    v_exp_f32 v136, v136
    v_pk_mov_b32 v[218:219], v[240:241], v[240:241]
    v_sub_f32 v137, v137, v14
    v_exp_f32 v137, v137
    v_sub_f32 v138, v138, v14
    v_exp_f32 v138, v138
    v_smfmac_f32_32x32x32_bf16 v[144:159], v[88:91], v[128:135], v13
    v_sub_f32 v139, v139, v14
    v_exp_f32 v139, v139
    v_sub_f32 v140, v140, v14
    v_exp_f32 v140, v140
    v_sub_f32 v141, v141, v14
    v_exp_f32 v141, v141
    buffer_load_dwordx4 v[192:195], v6, s[8:11], s49 offen offset:2048 sc1
    v_sub_f32 v142, v142, v14
    v_exp_f32 v142, v142
    v_sub_f32 v143, v143, v14
    v_exp_f32 v143, v143
    v_sub_f32 v112, v112, v14
    v_exp_f32 v112, v112
    v_sub_f32 v113, v113, v14
    v_exp_f32 v113, v113
    v_smfmac_f32_32x32x32_bf16 v[144:159], v[92:95], v[136:143], v13
    v_sub_f32 v114, v114, v14
    v_exp_f32 v114, v114
    v_sub_f32 v115, v115, v14
    v_exp_f32 v115, v115
    v_sub_f32 v116, v116, v14
    v_exp_f32 v116, v116
    v_mfma_f32_32x32x16_bf16 v[128:143], v[44:47], v[164:167], 0
    v_sub_f32 v117, v117, v14
    v_exp_f32 v117, v117
    v_sub_f32 v118, v118, v14
    v_exp_f32 v118, v118
    s_mov_b32 s94, 0x00ff00ff
    s_mov_b32 s95, s94
    v_sub_f32 v119, v119, v14
    v_exp_f32 v119, v119
    v_pk_mov_b32 v[220:221], v[240:241], v[240:241]
    v_sub_f32 v120, v120, v14
    v_exp_f32 v120, v120
    v_pk_mov_b32 v[222:223], v[240:241], v[240:241]
    v_sub_f32 v121, v121, v14
    v_exp_f32 v121, v121
    v_sub_f32 v122, v122, v14
    v_exp_f32 v122, v122
    v_smfmac_f32_32x32x32_bf16 v[144:159], v[96:99], v[112:119], v13
    v_sub_f32 v123, v123, v14
    v_exp_f32 v123, v123
    v_sub_f32 v124, v124, v14
    v_exp_f32 v124, v124
    v_sub_f32 v125, v125, v14
    v_exp_f32 v125, v125
    buffer_load_dwordx4 v[196:199], v6, s[8:11], s49 offen offset:3072 sc1
    v_sub_f32 v126, v126, v14
    v_exp_f32 v126, v126
    v_sub_f32 v127, v127, v14
    v_exp_f32 v127, v127
    s_setprio 1
    v_sub_f32 v128, v128, v14
    v_exp_f32 v128, v128
    v_sub_f32 v129, v129, v14
    v_exp_f32 v129, v129
    v_smfmac_f32_32x32x32_bf16 v[144:159], v[100:103], v[120:127], v13
    v_sub_f32 v130, v130, v14
    v_exp_f32 v130, v130
    v_sub_f32 v131, v131, v14
    v_exp_f32 v131, v131
    s_waitcnt vmcnt(4)
    v_sub_f32 v132, v132, v14
    v_exp_f32 v132, v132
    v_mfma_f32_32x32x16_bf16 v[112:127], v[16:19], v[160:163], 0
    v_sub_f32 v133, v133, v14
    v_exp_f32 v133, v133
    v_sub_f32 v134, v134, v14
    v_exp_f32 v134, v134
    v_sub_f32 v135, v135, v14
    v_exp_f32 v135, v135
    v_sub_f32 v136, v136, v14
    v_exp_f32 v136, v136
    v_sub_f32 v137, v137, v14
    v_exp_f32 v137, v137
    v_sub_f32 v138, v138, v14
    v_exp_f32 v138, v138
    v_smfmac_f32_32x32x32_bf16 v[144:159], v[104:107], v[128:135], v13
    v_sub_f32 v139, v139, v14
    v_exp_f32 v139, v139
    v_sub_f32 v140, v140, v14
    v_exp_f32 v140, v140
    v_sub_f32 v141, v141, v14
    v_exp_f32 v141, v141
    buffer_load_dwordx4 v[200:203], v6, s[8:11], s50 offen offset:0 sc1
    v_sub_f32 v142, v142, v14
    v_exp_f32 v142, v142
    v_sub_f32 v143, v143, v14
    v_exp_f32 v143, v143
    ds_read_b32 v14, v254 offset:256
    s_waitcnt lgkmcnt(0)
    v_sub_f32 v112, v112, v14
    v_exp_f32 v112, v112
    v_sub_f32 v113, v113, v14
    v_exp_f32 v113, v113
    v_smfmac_f32_32x32x32_bf16 v[144:159], v[108:111], v[136:143], v13
    v_sub_f32 v114, v114, v14
    v_exp_f32 v114, v114
    v_sub_f32 v115, v115, v14
    v_exp_f32 v115, v115
    v_sub_f32 v116, v116, v14
    v_exp_f32 v116, v116
    v_mfma_f32_32x32x16_bf16 v[128:143], v[20:23], v[160:163], 0
    v_sub_f32 v117, v117, v14
    v_exp_f32 v117, v117
    v_sub_f32 v118, v118, v14
    v_exp_f32 v118, v118
    v_sub_f32 v119, v119, v14
    v_exp_f32 v119, v119
    v_sub_f32 v120, v120, v14
    v_exp_f32 v120, v120
    v_sub_f32 v121, v121, v14
    v_exp_f32 v121, v121
    v_sub_f32 v122, v122, v14
    v_exp_f32 v122, v122
    v_sub_f32 v123, v123, v14
    v_exp_f32 v123, v123
    v_sub_f32 v124, v124, v14
    v_exp_f32 v124, v124
    ds_write_b128 v8, v[144:147] offset:16384
    v_sub_f32 v125, v125, v14
    v_exp_f32 v125, v125
    ds_write_b128 v8, v[148:151] offset:17408
    buffer_load_dwordx4 v[204:207], v6, s[8:11], s50 offen offset:1024 sc1
    v_sub_f32 v126, v126, v14
    v_exp_f32 v126, v126
    s_mov_b32 exec_hi, 0
    ds_write_b32 v252, v152 offset:128
    s_mov_b32 exec_hi, -1
    v_sub_f32 v127, v127, v14
    v_exp_f32 v127, v127
    v_mfma_f32_32x32x16_bf16 v[144:159], v[240:243], v[240:243], 0
    v_smfmac_f32_32x32x32_bf16 v[144:159], v[48:51], v[112:119], v13
    s_setprio 0
    v_sub_f32 v128, v128, v14
    v_exp_f32 v128, v128
    v_sub_f32 v129, v129, v14
    v_exp_f32 v129, v129
    v_smfmac_f32_32x32x32_bf16 v[144:159], v[52:55], v[120:127], v13
    v_sub_f32 v130, v130, v14
    v_exp_f32 v130, v130
    v_sub_f32 v131, v131, v14
    v_exp_f32 v131, v131
    v_sub_f32 v132, v132, v14
    v_exp_f32 v132, v132
    v_mfma_f32_32x32x16_bf16 v[112:127], v[24:27], v[160:163], 0
    v_sub_f32 v133, v133, v14
    v_exp_f32 v133, v133
    v_sub_f32 v134, v134, v14
    v_exp_f32 v134, v134
    v_sub_f32 v135, v135, v14
    v_exp_f32 v135, v135
    v_sub_f32 v136, v136, v14
    v_exp_f32 v136, v136
    v_sub_f32 v137, v137, v14
    v_exp_f32 v137, v137
    v_sub_f32 v138, v138, v14
    v_exp_f32 v138, v138
    v_smfmac_f32_32x32x32_bf16 v[144:159], v[56:59], v[128:135], v13
    v_sub_f32 v139, v139, v14
    v_exp_f32 v139, v139
    v_sub_f32 v140, v140, v14
    v_exp_f32 v140, v140
    v_sub_f32 v141, v141, v14
    v_exp_f32 v141, v141
    buffer_load_dwordx4 v[208:211], v6, s[8:11], s50 offen offset:2048 sc1
    v_sub_f32 v142, v142, v14
    v_exp_f32 v142, v142
    v_sub_f32 v143, v143, v14
    v_exp_f32 v143, v143
    s_setprio 3
    v_sub_f32 v112, v112, v14
    v_exp_f32 v112, v112
    v_sub_f32 v113, v113, v14
    v_exp_f32 v113, v113
    v_smfmac_f32_32x32x32_bf16 v[144:159], v[60:63], v[136:143], v13
    v_sub_f32 v114, v114, v14
    v_exp_f32 v114, v114
    s_add_u32 s48, s56, 3072
    s_and_b32 s48, s48, 8191
    s_add_u32 s48, s48, s55
    v_sub_f32 v115, v115, v14
    v_exp_f32 v115, v115
    buffer_load_dwordx4 v[164:167], v6, s[8:11], s48 offen sc1
    v_sub_f32 v116, v116, v14
    v_exp_f32 v116, v116
    v_mfma_f32_32x32x16_bf16 v[128:143], v[28:31], v[160:163], 0
    v_sub_f32 v117, v117, v14
    v_exp_f32 v117, v117
    v_sub_f32 v118, v118, v14
    v_exp_f32 v118, v118
    v_sub_f32 v119, v119, v14
    v_exp_f32 v119, v119
    v_sub_f32 v120, v120, v14
    v_exp_f32 v120, v120
    v_sub_f32 v121, v121, v14
    v_exp_f32 v121, v121
    v_sub_f32 v122, v122, v14
    v_exp_f32 v122, v122
    v_smfmac_f32_32x32x32_bf16 v[144:159], v[64:67], v[112:119], v13
    v_sub_f32 v123, v123, v14
    v_exp_f32 v123, v123
    v_sub_f32 v124, v124, v14
    v_exp_f32 v124, v124
    v_sub_f32 v125, v125, v14
    v_exp_f32 v125, v125
    buffer_load_dwordx4 v[212:215], v6, s[8:11], s50 offen offset:3072 sc1
    v_sub_f32 v126, v126, v14
    v_exp_f32 v126, v126
    v_sub_f32 v127, v127, v14
    v_exp_f32 v127, v127
    s_waitcnt lgkmcnt(0)
    s_barrier
    s_mov_b64 exec, s[94:95]
    ds_read_b128 v[216:219], v11 offset:0
    ds_read_b128 v[220:223], v11 offset:512
    s_mov_b64 exec, -1
    v_sub_f32 v128, v128, v14
    v_exp_f32 v128, v128
    s_bitcmp1_b32 s5, 2
    s_cbranch_scc1 CB_73
    ds_read2st64_b32 v[244:245], v253 offset0:0 offset1:4
    ds_read2st64_b32 v[246:247], v253 offset0:8 offset1:12
    ds_read2st64_b32 v[248:249], v253 offset0:16 offset1:20
    ds_read2st64_b32 v[250:251], v253 offset0:24 offset1:28
    ds_read2st64_b64 v[224:227], v9 offset0:32 offset1:36
    ds_read2st64_b64 v[228:231], v9 offset0:40 offset1:44
    ds_read2st64_b64 v[232:235], v9 offset0:48 offset1:52
    ds_read2st64_b64 v[236:239], v9 offset0:56 offset1:60
CB_73:
    v_sub_f32 v129, v129, v14
    v_exp_f32 v129, v129
    v_smfmac_f32_32x32x32_bf16 v[144:159], v[68:71], v[120:127], v13
    v_sub_f32 v130, v130, v14
    v_exp_f32 v130, v130
    v_sub_f32 v131, v131, v14
    v_exp_f32 v131, v131
    v_sub_f32 v132, v132, v14
    v_exp_f32 v132, v132
    v_mfma_f32_32x32x16_bf16 v[112:127], v[32:35], v[160:163], 0
    v_sub_f32 v133, v133, v14
    v_exp_f32 v133, v133
    v_sub_f32 v134, v134, v14
    v_exp_f32 v134, v134
    v_sub_f32 v135, v135, v14
    v_exp_f32 v135, v135
    v_sub_f32 v136, v136, v14
    v_exp_f32 v136, v136
    v_sub_f32 v137, v137, v14
    v_exp_f32 v137, v137
    s_bitcmp1_b32 s5, 2
    s_cbranch_scc1 CB_74
    s_waitcnt lgkmcnt(4)
    v_pk_add_f32 v[244:245], v[244:245], v[246:247]
    v_pk_add_f32 v[248:249], v[248:249], v[250:251]
    v_pk_add_f32 v[244:245], v[244:245], v[248:249]
    v_add_f32 v245, v244, v245
    v_rcp_f32 v244, v245
    s_waitcnt lgkmcnt(0)
    v_pk_add_f32 v[224:225], v[224:225], v[226:227]
    v_pk_add_f32 v[228:229], v[228:229], v[230:231]
    v_pk_add_f32 v[232:233], v[232:233], v[234:235]
    v_pk_add_f32 v[236:237], v[236:237], v[238:239]
    v_pk_add_f32 v[224:225], v[224:225], v[228:229]
    v_pk_add_f32 v[232:233], v[232:233], v[236:237]
    v_pk_add_f32 v[224:225], v[224:225], v[232:233]
    v_mul_f32 v224, v224, v244
    v_mul_f32 v225, v225, v244
    v_cvt_pk_bf16_f32 v226, v224, v225
    ds_write_b32 v10, v226 offset:1024
CB_74:
    v_sub_f32 v138, v138, v14
    v_exp_f32 v138, v138
    v_smfmac_f32_32x32x32_bf16 v[144:159], v[72:75], v[128:135], v13
    v_sub_f32 v139, v139, v14
    v_exp_f32 v139, v139
    s_add_u32 s49, s56, 1024
    s_and_b32 s49, s49, 8191
    s_lshl_b32 s49, s49, 6
    s_add_u32 s49, s49, s57
    s_add_u32 s50, s49, 32768
    v_sub_f32 v140, v140, v14
    v_exp_f32 v140, v140
    v_sub_f32 v141, v141, v14
    v_exp_f32 v141, v141
    s_waitcnt lgkmcnt(0)
    s_waitcnt vmcnt(7)
    v_mfma_f32_16x16x32_bf16 v[168:171], v[184:187], v[216:219], 0
    buffer_load_dwordx4 v[184:187], v6, s[8:11], s49 offen offset:0 sc1
    v_sub_f32 v142, v142, v14
    v_exp_f32 v142, v142
    v_sub_f32 v143, v143, v14
    v_exp_f32 v143, v143
    v_sub_f32 v112, v112, v14
    v_exp_f32 v112, v112
    v_sub_f32 v113, v113, v14
    v_exp_f32 v113, v113
    v_smfmac_f32_32x32x32_bf16 v[144:159], v[76:79], v[136:143], v13
    v_sub_f32 v114, v114, v14
    v_exp_f32 v114, v114
    v_sub_f32 v115, v115, v14
    v_exp_f32 v115, v115
    v_sub_f32 v116, v116, v14
    v_exp_f32 v116, v116
    v_mfma_f32_32x32x16_bf16 v[128:143], v[36:39], v[160:163], 0
    v_sub_f32 v117, v117, v14
    v_exp_f32 v117, v117
    v_sub_f32 v118, v118, v14
    v_exp_f32 v118, v118
    v_sub_f32 v119, v119, v14
    v_exp_f32 v119, v119
    v_sub_f32 v120, v120, v14
    v_exp_f32 v120, v120
    v_sub_f32 v121, v121, v14
    v_exp_f32 v121, v121
    v_sub_f32 v122, v122, v14
    v_exp_f32 v122, v122
    v_smfmac_f32_32x32x32_bf16 v[144:159], v[80:83], v[112:119], v13
    v_sub_f32 v123, v123, v14
    v_exp_f32 v123, v123
    v_sub_f32 v124, v124, v14
    v_exp_f32 v124, v124
    v_sub_f32 v125, v125, v14
    v_exp_f32 v125, v125
    v_mfma_f32_16x16x32_bf16 v[172:175], v[188:191], v[216:219], 0
    buffer_load_dwordx4 v[188:191], v6, s[8:11], s49 offen offset:1024 sc1
    v_sub_f32 v126, v126, v14
    v_exp_f32 v126, v126
    v_sub_f32 v127, v127, v14
    v_exp_f32 v127, v127
    s_setprio 2
    v_sub_f32 v128, v128, v14
    v_exp_f32 v128, v128
    v_sub_f32 v129, v129, v14
    v_exp_f32 v129, v129
    v_smfmac_f32_32x32x32_bf16 v[144:159], v[84:87], v[120:127], v13
    v_sub_f32 v130, v130, v14
    v_exp_f32 v130, v130
    v_sub_f32 v131, v131, v14
    v_exp_f32 v131, v131
    v_sub_f32 v132, v132, v14
    v_exp_f32 v132, v132
    v_mfma_f32_32x32x16_bf16 v[112:127], v[40:43], v[160:163], 0
    v_sub_f32 v133, v133, v14
    v_exp_f32 v133, v133
    v_sub_f32 v134, v134, v14
    v_exp_f32 v134, v134
    v_sub_f32 v135, v135, v14
    v_exp_f32 v135, v135
    v_sub_f32 v136, v136, v14
    v_exp_f32 v136, v136
    v_sub_f32 v137, v137, v14
    v_exp_f32 v137, v137
    v_sub_f32 v138, v138, v14
    v_exp_f32 v138, v138
    v_smfmac_f32_32x32x32_bf16 v[144:159], v[88:91], v[128:135], v13
    v_sub_f32 v139, v139, v14
    v_exp_f32 v139, v139
    v_sub_f32 v140, v140, v14
    v_exp_f32 v140, v140
    v_sub_f32 v141, v141, v14
    v_exp_f32 v141, v141
    s_waitcnt vmcnt(7)
    v_mfma_f32_16x16x32_bf16 v[176:179], v[192:195], v[216:219], 0
    buffer_load_dwordx4 v[192:195], v6, s[8:11], s49 offen offset:2048 sc1
    v_sub_f32 v142, v142, v14
    v_exp_f32 v142, v142
    v_sub_f32 v143, v143, v14
    v_exp_f32 v143, v143
    v_sub_f32 v112, v112, v14
    v_exp_f32 v112, v112
    v_sub_f32 v113, v113, v14
    v_exp_f32 v113, v113
    v_smfmac_f32_32x32x32_bf16 v[144:159], v[92:95], v[136:143], v13
    v_sub_f32 v114, v114, v14
    v_exp_f32 v114, v114
    v_sub_f32 v115, v115, v14
    v_exp_f32 v115, v115
    v_sub_f32 v116, v116, v14
    v_exp_f32 v116, v116
    v_mfma_f32_32x32x16_bf16 v[128:143], v[44:47], v[160:163], 0
    v_sub_f32 v117, v117, v14
    v_exp_f32 v117, v117
    v_sub_f32 v118, v118, v14
    v_exp_f32 v118, v118
    v_sub_f32 v119, v119, v14
    v_exp_f32 v119, v119
    v_sub_f32 v120, v120, v14
    v_exp_f32 v120, v120
    v_sub_f32 v121, v121, v14
    v_exp_f32 v121, v121
    v_sub_f32 v122, v122, v14
    v_exp_f32 v122, v122
    v_smfmac_f32_32x32x32_bf16 v[144:159], v[96:99], v[112:119], v13
    v_sub_f32 v123, v123, v14
    v_exp_f32 v123, v123
    s_and_b32 s42, s5, 3
    s_lshl_b32 s40, s42, 11
    s_lshr_b32 s31, s5, 2
    s_lshl_b32 s44, s31, 10
    v_sub_f32 v124, v124, v14
    v_exp_f32 v124, v124
    v_sub_f32 v125, v125, v14
    v_exp_f32 v125, v125
    v_mfma_f32_16x16x32_bf16 v[180:183], v[196:199], v[216:219], 0
    buffer_load_dwordx4 v[196:199], v6, s[8:11], s49 offen offset:3072 sc1
    v_sub_f32 v126, v126, v14
    v_exp_f32 v126, v126
    v_sub_f32 v127, v127, v14
    v_exp_f32 v127, v127
    s_setprio 1
    v_sub_f32 v128, v128, v14
    v_exp_f32 v128, v128
    v_sub_f32 v129, v129, v14
    v_exp_f32 v129, v129
    v_smfmac_f32_32x32x32_bf16 v[144:159], v[100:103], v[120:127], v13
    v_sub_f32 v130, v130, v14
    v_exp_f32 v130, v130
    v_sub_f32 v131, v131, v14
    v_exp_f32 v131, v131
    s_waitcnt vmcnt(5)
    v_sub_f32 v132, v132, v14
    v_exp_f32 v132, v132
    v_mfma_f32_32x32x16_bf16 v[112:127], v[16:19], v[164:167], 0
    v_sub_f32 v133, v133, v14
    v_exp_f32 v133, v133
    v_sub_f32 v134, v134, v14
    v_exp_f32 v134, v134
    v_sub_f32 v135, v135, v14
    v_exp_f32 v135, v135
    v_sub_f32 v136, v136, v14
    v_exp_f32 v136, v136
    v_sub_f32 v137, v137, v14
    v_exp_f32 v137, v137
    v_sub_f32 v138, v138, v14
    v_exp_f32 v138, v138
    v_smfmac_f32_32x32x32_bf16 v[144:159], v[104:107], v[128:135], v13
    v_sub_f32 v139, v139, v14
    v_exp_f32 v139, v139
    s_add_u32 s44, s44, s40
    s_mul_i32 s35, s42, 458752
    s_lshl_b32 s46, s31, 15
    s_add_u32 s46, s46, 98304
    v_sub_f32 v140, v140, v14
    v_exp_f32 v140, v140
    v_sub_f32 v141, v141, v14
    v_exp_f32 v141, v141
    s_waitcnt vmcnt(7)
    v_mfma_f32_16x16x32_bf16 v[168:171], v[200:203], v[220:223], v[168:171]
    buffer_load_dwordx4 v[200:203], v6, s[8:11], s50 offen offset:0 sc1
    v_sub_f32 v142, v142, v14
    v_exp_f32 v142, v142
    v_sub_f32 v143, v143, v14
    v_exp_f32 v143, v143
    ds_read_b32 v14, v254 offset:384
    s_waitcnt lgkmcnt(0)
    v_sub_f32 v112, v112, v14
    v_exp_f32 v112, v112
    v_sub_f32 v113, v113, v14
    v_exp_f32 v113, v113
    v_smfmac_f32_32x32x32_bf16 v[144:159], v[108:111], v[136:143], v13
    v_sub_f32 v114, v114, v14
    v_exp_f32 v114, v114
    v_sub_f32 v115, v115, v14
    v_exp_f32 v115, v115
    v_sub_f32 v116, v116, v14
    v_exp_f32 v116, v116
    v_mfma_f32_32x32x16_bf16 v[128:143], v[20:23], v[164:167], 0
    v_sub_f32 v117, v117, v14
    v_exp_f32 v117, v117
    v_sub_f32 v118, v118, v14
    v_exp_f32 v118, v118
    v_sub_f32 v119, v119, v14
    v_exp_f32 v119, v119
    v_sub_f32 v120, v120, v14
    v_exp_f32 v120, v120
    v_sub_f32 v121, v121, v14
    v_exp_f32 v121, v121
    v_sub_f32 v122, v122, v14
    v_exp_f32 v122, v122
    v_sub_f32 v123, v123, v14
    v_exp_f32 v123, v123
    s_add_u32 s45, s46, s40
    s_add_u32 s40, s40, 98304
    s_mul_i32 s60, s42, 640
    s_and_b32 s60, s60, 1152
    s_add_u32 s46, s46, s60
    v_sub_f32 v124, v124, v14
    v_exp_f32 v124, v124
    ds_write_b128 v8, v[144:147] offset:0
    v_sub_f32 v125, v125, v14
    v_exp_f32 v125, v125
    ds_write_b128 v8, v[148:151] offset:1024
    v_mfma_f32_16x16x32_bf16 v[172:175], v[204:207], v[220:223], v[172:175]
    buffer_load_dwordx4 v[204:207], v6, s[8:11], s50 offen offset:1024 sc1
    v_sub_f32 v126, v126, v14
    v_exp_f32 v126, v126
    s_mov_b32 exec_hi, 0
    ds_write_b32 v252, v152 offset:256
    s_mov_b32 exec_hi, -1
    v_sub_f32 v127, v127, v14
    v_exp_f32 v127, v127
    v_mfma_f32_32x32x16_bf16 v[144:159], v[240:243], v[240:243], 0
    v_smfmac_f32_32x32x32_bf16 v[144:159], v[48:51], v[112:119], v13
    s_setprio 0
    v_sub_f32 v128, v128, v14
    v_exp_f32 v128, v128
    v_sub_f32 v129, v129, v14
    v_exp_f32 v129, v129
    v_smfmac_f32_32x32x32_bf16 v[144:159], v[52:55], v[120:127], v13
    v_sub_f32 v130, v130, v14
    v_exp_f32 v130, v130
    v_sub_f32 v131, v131, v14
    v_exp_f32 v131, v131
    v_sub_f32 v132, v132, v14
    v_exp_f32 v132, v132
    v_mfma_f32_32x32x16_bf16 v[112:127], v[24:27], v[164:167], 0
    v_sub_f32 v133, v133, v14
    v_exp_f32 v133, v133
    v_sub_f32 v134, v134, v14
    v_exp_f32 v134, v134
    v_sub_f32 v135, v135, v14
    v_exp_f32 v135, v135
    v_sub_f32 v136, v136, v14
    v_exp_f32 v136, v136
    v_sub_f32 v137, v137, v14
    v_exp_f32 v137, v137
    v_sub_f32 v138, v138, v14
    v_exp_f32 v138, v138
    v_smfmac_f32_32x32x32_bf16 v[144:159], v[56:59], v[128:135], v13
    v_sub_f32 v139, v139, v14
    v_exp_f32 v139, v139
    s_xor_b32 s60, s4, 0
    s_and_b32 s60, s60, 3
    s_mul_i32 s60, s60, 114688
    s_add_u32 s32, s60, s35
    v_sub_f32 v140, v140, v14
    v_exp_f32 v140, v140
    v_sub_f32 v141, v141, v14
    v_exp_f32 v141, v141
    s_waitcnt vmcnt(6)
    v_mfma_f32_16x16x32_bf16 v[176:179], v[208:211], v[220:223], v[176:179]
    buffer_load_dwordx4 v[208:211], v6, s[8:11], s50 offen offset:2048 sc1
    v_sub_f32 v142, v142, v14
    v_exp_f32 v142, v142
    v_sub_f32 v143, v143, v14
    v_exp_f32 v143, v143
    s_setprio 3
    v_sub_f32 v112, v112, v14
    v_exp_f32 v112, v112
    v_sub_f32 v113, v113, v14
    v_exp_f32 v113, v113
    v_smfmac_f32_32x32x32_bf16 v[144:159], v[60:63], v[136:143], v13
    v_sub_f32 v114, v114, v14
    v_exp_f32 v114, v114
    s_add_u32 s48, s56, 4096
    s_and_b32 s48, s48, 8191
    s_add_u32 s48, s48, s55
    v_sub_f32 v115, v115, v14
    v_exp_f32 v115, v115
    buffer_load_dwordx4 v[160:163], v6, s[8:11], s48 offen sc1
    v_sub_f32 v116, v116, v14
    v_exp_f32 v116, v116
    v_mfma_f32_32x32x16_bf16 v[128:143], v[28:31], v[164:167], 0
    v_sub_f32 v117, v117, v14
    v_exp_f32 v117, v117
    v_sub_f32 v118, v118, v14
    v_exp_f32 v118, v118
    v_sub_f32 v119, v119, v14
    v_exp_f32 v119, v119
    v_sub_f32 v120, v120, v14
    v_exp_f32 v120, v120
    v_sub_f32 v121, v121, v14
    v_exp_f32 v121, v121
    v_sub_f32 v122, v122, v14
    v_exp_f32 v122, v122
    v_smfmac_f32_32x32x32_bf16 v[144:159], v[64:67], v[112:119], v13
    v_sub_f32 v123, v123, v14
    v_exp_f32 v123, v123
    s_xor_b32 s60, s4, 1
    s_and_b32 s60, s60, 3
    s_mul_i32 s60, s60, 114688
    s_add_u32 s33, s60, s35
    v_sub_f32 v124, v124, v14
    v_exp_f32 v124, v124
    v_sub_f32 v125, v125, v14
    v_exp_f32 v125, v125
    v_mfma_f32_16x16x32_bf16 v[180:183], v[212:215], v[220:223], v[180:183]
    buffer_load_dwordx4 v[212:215], v6, s[8:11], s50 offen offset:3072 sc1
    v_sub_f32 v126, v126, v14
    v_exp_f32 v126, v126
    v_sub_f32 v127, v127, v14
    v_exp_f32 v127, v127
    s_waitcnt lgkmcnt(0)
    s_barrier
    s_mov_b64 exec, s[94:95]
    ds_read_b128 v[216:219], v11 offset:1024
    ds_read_b128 v[220:223], v11 offset:1536
    s_mov_b64 exec, -1
    v_sub_f32 v128, v128, v14
    v_exp_f32 v128, v128
    s_bitcmp0_b32 s5, 2
    s_cbranch_scc1 CB_75
    ds_read2st64_b32 v[244:245], v253 offset0:1 offset1:5
    ds_read2st64_b32 v[246:247], v253 offset0:9 offset1:13
    ds_read2st64_b32 v[248:249], v253 offset0:17 offset1:21
    ds_read2st64_b32 v[250:251], v253 offset0:25 offset1:29
    ds_read2st64_b64 v[224:227], v9 offset0:0 offset1:4
    ds_read2st64_b64 v[228:231], v9 offset0:8 offset1:12
    ds_read2st64_b64 v[232:235], v9 offset0:16 offset1:20
    ds_read2st64_b64 v[236:239], v9 offset0:24 offset1:28
CB_75:
    v_sub_f32 v129, v129, v14
    v_exp_f32 v129, v129
    v_smfmac_f32_32x32x32_bf16 v[144:159], v[68:71], v[120:127], v13
    v_sub_f32 v130, v130, v14
    v_exp_f32 v130, v130
    v_sub_f32 v131, v131, v14
    v_exp_f32 v131, v131
    v_sub_f32 v132, v132, v14
    v_exp_f32 v132, v132
    v_mfma_f32_32x32x16_bf16 v[112:127], v[32:35], v[164:167], 0
    v_sub_f32 v133, v133, v14
    v_exp_f32 v133, v133
    v_sub_f32 v134, v134, v14
    v_exp_f32 v134, v134
    v_sub_f32 v135, v135, v14
    v_exp_f32 v135, v135
    v_sub_f32 v136, v136, v14
    v_exp_f32 v136, v136
    v_sub_f32 v137, v137, v14
    v_exp_f32 v137, v137
    s_bitcmp0_b32 s5, 2
    s_cbranch_scc1 CB_76
    s_waitcnt lgkmcnt(4)
    v_pk_add_f32 v[244:245], v[244:245], v[246:247]
    v_pk_add_f32 v[248:249], v[248:249], v[250:251]
    v_pk_add_f32 v[244:245], v[244:245], v[248:249]
    v_add_f32 v245, v244, v245
    v_rcp_f32 v244, v245
    s_waitcnt lgkmcnt(0)
    v_pk_add_f32 v[224:225], v[224:225], v[226:227]
    v_pk_add_f32 v[228:229], v[228:229], v[230:231]
    v_pk_add_f32 v[232:233], v[232:233], v[234:235]
    v_pk_add_f32 v[236:237], v[236:237], v[238:239]
    v_pk_add_f32 v[224:225], v[224:225], v[228:229]
    v_pk_add_f32 v[232:233], v[232:233], v[236:237]
    v_pk_add_f32 v[224:225], v[224:225], v[232:233]
    v_mul_f32 v224, v224, v244
    v_mul_f32 v225, v225, v244
    v_cvt_pk_bf16_f32 v226, v224, v225
    ds_write_b32 v10, v226 offset:0
CB_76:
    v_sub_f32 v138, v138, v14
    v_exp_f32 v138, v138
    v_smfmac_f32_32x32x32_bf16 v[144:159], v[72:75], v[128:135], v13
    v_sub_f32 v139, v139, v14
    v_exp_f32 v139, v139
    s_add_u32 s49, s56, 2048
    s_and_b32 s49, s49, 8191
    s_lshl_b32 s49, s49, 6
    s_add_u32 s49, s49, s57
    s_add_u32 s50, s49, 32768
    s_xor_b32 s60, s4, 2
    s_and_b32 s60, s60, 3
    s_mul_i32 s60, s60, 114688
    s_add_u32 s34, s60, s35
    v_sub_f32 v140, v140, v14
    v_exp_f32 v140, v140
    v_sub_f32 v141, v141, v14
    v_exp_f32 v141, v141
    s_waitcnt lgkmcnt(0)
    s_waitcnt vmcnt(7)
    v_mfma_f32_16x16x32_bf16 v[168:171], v[184:187], v[216:219], v[168:171]
    buffer_load_dwordx4 v[184:187], v6, s[8:11], s49 offen offset:0 sc1
    v_sub_f32 v142, v142, v14
    v_exp_f32 v142, v142
    v_sub_f32 v143, v143, v14
    v_exp_f32 v143, v143
    v_sub_f32 v112, v112, v14
    v_exp_f32 v112, v112
    v_sub_f32 v113, v113, v14
    v_exp_f32 v113, v113
    v_smfmac_f32_32x32x32_bf16 v[144:159], v[76:79], v[136:143], v13
    v_sub_f32 v114, v114, v14
    v_exp_f32 v114, v114
    v_sub_f32 v115, v115, v14
    v_exp_f32 v115, v115
    v_sub_f32 v116, v116, v14
    v_exp_f32 v116, v116
    v_mfma_f32_32x32x16_bf16 v[128:143], v[36:39], v[164:167], 0
    v_sub_f32 v117, v117, v14
    v_exp_f32 v117, v117
    v_sub_f32 v118, v118, v14
    v_exp_f32 v118, v118
    v_sub_f32 v119, v119, v14
    v_exp_f32 v119, v119
    v_sub_f32 v120, v120, v14
    v_exp_f32 v120, v120
    v_sub_f32 v121, v121, v14
    v_exp_f32 v121, v121
    v_sub_f32 v122, v122, v14
    v_exp_f32 v122, v122
    v_smfmac_f32_32x32x32_bf16 v[144:159], v[80:83], v[112:119], v13
    v_sub_f32 v123, v123, v14
    v_exp_f32 v123, v123
    s_xor_b32 s60, s4, 3
    s_and_b32 s60, s60, 3
    s_mul_i32 s60, s60, 114688
    s_add_u32 s35, s60, s35
    v_sub_f32 v124, v124, v14
    v_exp_f32 v124, v124
    v_sub_f32 v125, v125, v14
    v_exp_f32 v125, v125
    v_mfma_f32_16x16x32_bf16 v[172:175], v[188:191], v[216:219], v[172:175]
    buffer_load_dwordx4 v[188:191], v6, s[8:11], s49 offen offset:1024 sc1
    v_sub_f32 v126, v126, v14
    v_exp_f32 v126, v126
    v_sub_f32 v127, v127, v14
    v_exp_f32 v127, v127
    s_setprio 2
    v_sub_f32 v128, v128, v14
    v_exp_f32 v128, v128
    v_sub_f32 v129, v129, v14
    v_exp_f32 v129, v129
    v_smfmac_f32_32x32x32_bf16 v[144:159], v[84:87], v[120:127], v13
    v_sub_f32 v130, v130, v14
    v_exp_f32 v130, v130
    v_sub_f32 v131, v131, v14
    v_exp_f32 v131, v131
    v_sub_f32 v132, v132, v14
    v_exp_f32 v132, v132
    v_mfma_f32_32x32x16_bf16 v[112:127], v[40:43], v[164:167], 0
    v_sub_f32 v133, v133, v14
    v_exp_f32 v133, v133
    v_sub_f32 v134, v134, v14
    v_exp_f32 v134, v134
    v_sub_f32 v135, v135, v14
    v_exp_f32 v135, v135
    v_sub_f32 v136, v136, v14
    v_exp_f32 v136, v136
    v_sub_f32 v137, v137, v14
    v_exp_f32 v137, v137
    v_sub_f32 v138, v138, v14
    v_exp_f32 v138, v138
    v_smfmac_f32_32x32x32_bf16 v[144:159], v[88:91], v[128:135], v13
    v_sub_f32 v139, v139, v14
    v_exp_f32 v139, v139
    s_lshr_b32 s60, s4, 3
    s_lshl_b32 s60, s60, 1
    s_add_u32 s31, s31, s60
    s_lshl_b32 s30, s3, 3
    v_sub_f32 v140, v140, v14
    v_exp_f32 v140, v140
    v_sub_f32 v141, v141, v14
    v_exp_f32 v141, v141
    s_waitcnt vmcnt(7)
    v_mfma_f32_16x16x32_bf16 v[176:179], v[192:195], v[216:219], v[176:179]
    buffer_load_dwordx4 v[192:195], v6, s[8:11], s49 offen offset:2048 sc1
    v_sub_f32 v142, v142, v14
    v_exp_f32 v142, v142
    v_sub_f32 v143, v143, v14
    v_exp_f32 v143, v143
    v_sub_f32 v112, v112, v14
    v_exp_f32 v112, v112
    v_sub_f32 v113, v113, v14
    v_exp_f32 v113, v113
    v_smfmac_f32_32x32x32_bf16 v[144:159], v[92:95], v[136:143], v13
    v_sub_f32 v114, v114, v14
    v_exp_f32 v114, v114
    v_sub_f32 v115, v115, v14
    v_exp_f32 v115, v115
    v_sub_f32 v116, v116, v14
    v_exp_f32 v116, v116
    v_mfma_f32_32x32x16_bf16 v[128:143], v[44:47], v[164:167], 0
    v_sub_f32 v117, v117, v14
    v_exp_f32 v117, v117
    v_sub_f32 v118, v118, v14
    v_exp_f32 v118, v118
    v_sub_f32 v119, v119, v14
    v_exp_f32 v119, v119
    v_sub_f32 v120, v120, v14
    v_exp_f32 v120, v120
    v_sub_f32 v121, v121, v14
    v_exp_f32 v121, v121
    v_sub_f32 v122, v122, v14
    v_exp_f32 v122, v122
    v_smfmac_f32_32x32x32_bf16 v[144:159], v[96:99], v[112:119], v13
    v_sub_f32 v123, v123, v14
    v_exp_f32 v123, v123
    s_add_u32 s31, s31, s30
    s_mul_i32 s29, s31, 114688
    s_add_u32 s29, s29, 8388608
    v_sub_f32 v124, v124, v14
    v_exp_f32 v124, v124
    v_sub_f32 v125, v125, v14
    v_exp_f32 v125, v125
    v_mfma_f32_16x16x32_bf16 v[180:183], v[196:199], v[216:219], v[180:183]
    buffer_load_dwordx4 v[196:199], v6, s[8:11], s49 offen offset:3072 sc1
    v_sub_f32 v126, v126, v14
    v_exp_f32 v126, v126
    v_sub_f32 v127, v127, v14
    v_exp_f32 v127, v127
    s_setprio 1
    v_sub_f32 v128, v128, v14
    v_exp_f32 v128, v128
    v_sub_f32 v129, v129, v14
    v_exp_f32 v129, v129
    v_smfmac_f32_32x32x32_bf16 v[144:159], v[100:103], v[120:127], v13
    v_sub_f32 v130, v130, v14
    v_exp_f32 v130, v130
    v_sub_f32 v131, v131, v14
    v_exp_f32 v131, v131
    s_waitcnt vmcnt(5)
    v_sub_f32 v132, v132, v14
    v_exp_f32 v132, v132
    v_mfma_f32_32x32x16_bf16 v[112:127], v[16:19], v[160:163], 0
    v_sub_f32 v133, v133, v14
    v_exp_f32 v133, v133
    v_sub_f32 v134, v134, v14
    v_exp_f32 v134, v134
    v_sub_f32 v135, v135, v14
    v_exp_f32 v135, v135
    v_sub_f32 v136, v136, v14
    v_exp_f32 v136, v136
    v_sub_f32 v137, v137, v14
    v_exp_f32 v137, v137
    v_sub_f32 v138, v138, v14
    v_exp_f32 v138, v138
    v_smfmac_f32_32x32x32_bf16 v[144:159], v[104:107], v[128:135], v13
    v_sub_f32 v139, v139, v14
    v_exp_f32 v139, v139
    s_lshr_b32 s60, s32, 4
    s_add_u32 s76, s29, s60
    s_lshr_b32 s60, s33, 4
    s_add_u32 s77, s29, s60
    s_min_u32 s82, s76, s77
    v_sub_f32 v140, v140, v14
    v_exp_f32 v140, v140
    v_sub_f32 v141, v141, v14
    v_exp_f32 v141, v141
    s_waitcnt vmcnt(7)
    v_mfma_f32_16x16x32_bf16 v[168:171], v[200:203], v[220:223], v[168:171]
    buffer_load_dwordx4 v[200:203], v6, s[8:11], s50 offen offset:0 sc1
    v_sub_f32 v142, v142, v14
    v_exp_f32 v142, v142
    v_sub_f32 v143, v143, v14
    v_exp_f32 v143, v143
    ds_read_b32 v14, v254 offset:512
    s_waitcnt lgkmcnt(0)
    v_sub_f32 v112, v112, v14
    v_exp_f32 v112, v112
    v_sub_f32 v113, v113, v14
    v_exp_f32 v113, v113
    v_smfmac_f32_32x32x32_bf16 v[144:159], v[108:111], v[136:143], v13
    v_sub_f32 v114, v114, v14
    v_exp_f32 v114, v114
    v_sub_f32 v115, v115, v14
    v_exp_f32 v115, v115
    v_sub_f32 v116, v116, v14
    v_exp_f32 v116, v116
    v_mfma_f32_32x32x16_bf16 v[128:143], v[20:23], v[160:163], 0
    v_sub_f32 v117, v117, v14
    v_exp_f32 v117, v117
    v_sub_f32 v118, v118, v14
    v_exp_f32 v118, v118
    v_sub_f32 v119, v119, v14
    v_exp_f32 v119, v119
    v_sub_f32 v120, v120, v14
    v_exp_f32 v120, v120
    v_sub_f32 v121, v121, v14
    v_exp_f32 v121, v121
    v_sub_f32 v122, v122, v14
    v_exp_f32 v122, v122
    v_sub_f32 v123, v123, v14
    v_exp_f32 v123, v123
    s_lshr_b32 s60, s34, 4
    s_add_u32 s78, s29, s60
    s_lshr_b32 s60, s35, 4
    s_add_u32 s79, s29, s60
    s_min_u32 s83, s78, s79
    v_sub_f32 v124, v124, v14
    v_exp_f32 v124, v124
    ds_write_b128 v8, v[144:147] offset:16384
    v_sub_f32 v125, v125, v14
    v_exp_f32 v125, v125
    ds_write_b128 v8, v[148:151] offset:17408
    v_mfma_f32_16x16x32_bf16 v[172:175], v[204:207], v[220:223], v[172:175]
    buffer_load_dwordx4 v[204:207], v6, s[8:11], s50 offen offset:1024 sc1
    v_sub_f32 v126, v126, v14
    v_exp_f32 v126, v126
    s_mov_b32 exec_hi, 0
    ds_write_b32 v252, v152 offset:384
    s_mov_b32 exec_hi, -1
    v_sub_f32 v127, v127, v14
    v_exp_f32 v127, v127
    v_mfma_f32_32x32x16_bf16 v[144:159], v[240:243], v[240:243], 0
    v_smfmac_f32_32x32x32_bf16 v[144:159], v[48:51], v[112:119], v13
    s_setprio 0
    v_sub_f32 v128, v128, v14
    v_exp_f32 v128, v128
    v_sub_f32 v129, v129, v14
    v_exp_f32 v129, v129
    v_smfmac_f32_32x32x32_bf16 v[144:159], v[52:55], v[120:127], v13
    v_sub_f32 v130, v130, v14
    v_exp_f32 v130, v130
    v_sub_f32 v131, v131, v14
    v_exp_f32 v131, v131
    v_sub_f32 v132, v132, v14
    v_exp_f32 v132, v132
    v_mfma_f32_32x32x16_bf16 v[112:127], v[24:27], v[160:163], 0
    v_sub_f32 v133, v133, v14
    v_exp_f32 v133, v133
    v_sub_f32 v134, v134, v14
    v_exp_f32 v134, v134
    v_sub_f32 v135, v135, v14
    v_exp_f32 v135, v135
    v_sub_f32 v136, v136, v14
    v_exp_f32 v136, v136
    v_sub_f32 v137, v137, v14
    v_exp_f32 v137, v137
    v_sub_f32 v138, v138, v14
    v_exp_f32 v138, v138
    v_smfmac_f32_32x32x32_bf16 v[144:159], v[56:59], v[128:135], v13
    v_sub_f32 v139, v139, v14
    v_exp_f32 v139, v139
    s_and_b32 s29, s4, 7
    s_lshl_b32 s41, s29, 8
    s_add_u32 s41, s41, 117568
    s_lshl_b32 s74, s31, 2
    v_sub_f32 v140, v140, v14
    v_exp_f32 v140, v140
    v_sub_f32 v141, v141, v14
    v_exp_f32 v141, v141
    s_waitcnt vmcnt(6)
    v_mfma_f32_16x16x32_bf16 v[176:179], v[208:211], v[220:223], v[176:179]
    buffer_load_dwordx4 v[208:211], v6, s[8:11], s50 offen offset:2048 sc1
    v_sub_f32 v142, v142, v14
    v_exp_f32 v142, v142
    v_sub_f32 v143, v143, v14
    v_exp_f32 v143, v143
    s_setprio 3
    v_sub_f32 v112, v112, v14
    v_exp_f32 v112, v112
    v_sub_f32 v113, v113, v14
    v_exp_f32 v113, v113
    v_smfmac_f32_32x32x32_bf16 v[144:159], v[60:63], v[136:143], v13
    v_sub_f32 v114, v114, v14
    v_exp_f32 v114, v114
    s_add_u32 s48, s56, 5120
    s_and_b32 s48, s48, 8191
    s_add_u32 s48, s48, s55
    v_sub_f32 v115, v115, v14
    v_exp_f32 v115, v115
    buffer_load_dwordx4 v[164:167], v6, s[8:11], s48 offen sc1
    v_sub_f32 v116, v116, v14
    v_exp_f32 v116, v116
    v_mfma_f32_32x32x16_bf16 v[128:143], v[28:31], v[160:163], 0
    v_sub_f32 v117, v117, v14
    v_exp_f32 v117, v117
    v_sub_f32 v118, v118, v14
    v_exp_f32 v118, v118
    v_sub_f32 v119, v119, v14
    v_exp_f32 v119, v119
    v_sub_f32 v120, v120, v14
    v_exp_f32 v120, v120
    v_sub_f32 v121, v121, v14
    v_exp_f32 v121, v121
    v_sub_f32 v122, v122, v14
    v_exp_f32 v122, v122
    v_smfmac_f32_32x32x32_bf16 v[144:159], v[64:67], v[112:119], v13
    v_sub_f32 v123, v123, v14
    v_exp_f32 v123, v123
    s_add_u32 s74, s74, s42
    s_lshl_b32 s74, s74, 6
    s_add_u32 s74, s74, s29
    s_lshl_b32 s74, s74, 7
    s_add_u32 s75, s74, 4194304
    v_sub_f32 v124, v124, v14
    v_exp_f32 v124, v124
    v_sub_f32 v125, v125, v14
    v_exp_f32 v125, v125
    v_mfma_f32_16x16x32_bf16 v[180:183], v[212:215], v[220:223], v[180:183]
    buffer_load_dwordx4 v[212:215], v6, s[8:11], s50 offen offset:3072 sc1
    v_sub_f32 v126, v126, v14
    v_exp_f32 v126, v126
    v_sub_f32 v127, v127, v14
    v_exp_f32 v127, v127
    s_waitcnt lgkmcnt(0)
    s_barrier
    s_mov_b64 exec, s[94:95]
    ds_read_b128 v[216:219], v11 offset:0
    ds_read_b128 v[220:223], v11 offset:512
    s_mov_b64 exec, -1
    v_sub_f32 v128, v128, v14
    v_exp_f32 v128, v128
    s_bitcmp1_b32 s5, 2
    s_cbranch_scc1 CB_77
    ds_read2st64_b32 v[244:245], v253 offset0:1 offset1:5
    ds_read2st64_b32 v[246:247], v253 offset0:9 offset1:13
    ds_read2st64_b32 v[248:249], v253 offset0:17 offset1:21
    ds_read2st64_b32 v[250:251], v253 offset0:25 offset1:29
    ds_read2st64_b64 v[224:227], v9 offset0:32 offset1:36
    ds_read2st64_b64 v[228:231], v9 offset0:40 offset1:44
    ds_read2st64_b64 v[232:235], v9 offset0:48 offset1:52
    ds_read2st64_b64 v[236:239], v9 offset0:56 offset1:60
CB_77:
    v_sub_f32 v129, v129, v14
    v_exp_f32 v129, v129
    v_smfmac_f32_32x32x32_bf16 v[144:159], v[68:71], v[120:127], v13
    v_sub_f32 v130, v130, v14
    v_exp_f32 v130, v130
    v_sub_f32 v131, v131, v14
    v_exp_f32 v131, v131
    v_sub_f32 v132, v132, v14
    v_exp_f32 v132, v132
    v_mfma_f32_32x32x16_bf16 v[112:127], v[32:35], v[160:163], 0
    v_sub_f32 v133, v133, v14
    v_exp_f32 v133, v133
    v_sub_f32 v134, v134, v14
    v_exp_f32 v134, v134
    v_sub_f32 v135, v135, v14
    v_exp_f32 v135, v135
    v_sub_f32 v136, v136, v14
    v_exp_f32 v136, v136
    v_sub_f32 v137, v137, v14
    v_exp_f32 v137, v137
    s_bitcmp1_b32 s5, 2
    s_cbranch_scc1 CB_78
    s_waitcnt lgkmcnt(4)
    v_pk_add_f32 v[244:245], v[244:245], v[246:247]
    v_pk_add_f32 v[248:249], v[248:249], v[250:251]
    v_pk_add_f32 v[244:245], v[244:245], v[248:249]
    v_add_f32 v245, v244, v245
    v_rcp_f32 v244, v245
    s_waitcnt lgkmcnt(0)
    v_pk_add_f32 v[224:225], v[224:225], v[226:227]
    v_pk_add_f32 v[228:229], v[228:229], v[230:231]
    v_pk_add_f32 v[232:233], v[232:233], v[234:235]
    v_pk_add_f32 v[236:237], v[236:237], v[238:239]
    v_pk_add_f32 v[224:225], v[224:225], v[228:229]
    v_pk_add_f32 v[232:233], v[232:233], v[236:237]
    v_pk_add_f32 v[224:225], v[224:225], v[232:233]
    v_mul_f32 v224, v224, v244
    v_mul_f32 v225, v225, v244
    v_cvt_pk_bf16_f32 v226, v224, v225
    ds_write_b32 v10, v226 offset:1024
CB_78:
    v_sub_f32 v138, v138, v14
    v_exp_f32 v138, v138
    v_smfmac_f32_32x32x32_bf16 v[144:159], v[72:75], v[128:135], v13
    v_sub_f32 v139, v139, v14
    v_exp_f32 v139, v139
    s_add_u32 s49, s56, 3072
    s_and_b32 s49, s49, 8191
    s_lshl_b32 s49, s49, 6
    s_add_u32 s49, s49, s57
    s_add_u32 s50, s49, 32768
    s_add_u32 s31, s30, s5
    s_mul_i32 s43, s31, 112
    s_lshl_b32 s31, s31, 15
    s_add_u32 s31, s31, 6291456
    s_lshl_b32 s29, s29, 12
    v_sub_f32 v140, v140, v14
    v_exp_f32 v140, v140
    v_sub_f32 v141, v141, v14
    v_exp_f32 v141, v141
    s_waitcnt lgkmcnt(0)
    s_waitcnt vmcnt(7)
    v_mfma_f32_16x16x32_bf16 v[168:171], v[184:187], v[216:219], v[168:171]
    buffer_load_dwordx4 v[184:187], v6, s[8:11], s49 offen offset:0 sc1
    v_sub_f32 v142, v142, v14
    v_exp_f32 v142, v142
    v_sub_f32 v143, v143, v14
    v_exp_f32 v143, v143
    v_sub_f32 v112, v112, v14
    v_exp_f32 v112, v112
    v_sub_f32 v113, v113, v14
    v_exp_f32 v113, v113
    v_smfmac_f32_32x32x32_bf16 v[144:159], v[76:79], v[136:143], v13
    v_sub_f32 v114, v114, v14
    v_exp_f32 v114, v114
    v_sub_f32 v115, v115, v14
    v_exp_f32 v115, v115
    v_sub_f32 v116, v116, v14
    v_exp_f32 v116, v116
    v_mfma_f32_32x32x16_bf16 v[128:143], v[36:39], v[160:163], 0
    v_sub_f32 v117, v117, v14
    v_exp_f32 v117, v117
    v_sub_f32 v118, v118, v14
    v_exp_f32 v118, v118
    v_sub_f32 v119, v119, v14
    v_exp_f32 v119, v119
    v_sub_f32 v120, v120, v14
    v_exp_f32 v120, v120
    v_sub_f32 v121, v121, v14
    v_exp_f32 v121, v121
    v_sub_f32 v122, v122, v14
    v_exp_f32 v122, v122
    v_smfmac_f32_32x32x32_bf16 v[144:159], v[80:83], v[112:119], v13
    v_sub_f32 v123, v123, v14
    v_exp_f32 v123, v123
    s_add_u32 s66, s31, s29
    s_add_u32 s29, s29, 4096
    s_and_b32 s29, s29, 0x7fff
    v_sub_f32 v124, v124, v14
    v_exp_f32 v124, v124
    v_sub_f32 v125, v125, v14
    v_exp_f32 v125, v125
    v_mfma_f32_16x16x32_bf16 v[172:175], v[188:191], v[216:219], v[172:175]
    buffer_load_dwordx4 v[188:191], v6, s[8:11], s49 offen offset:1024 sc1
    v_sub_f32 v126, v126, v14
    v_exp_f32 v126, v126
    v_sub_f32 v127, v127, v14
    v_exp_f32 v127, v127
    s_setprio 2
    v_sub_f32 v128, v128, v14
    v_exp_f32 v128, v128
    v_sub_f32 v129, v129, v14
    v_exp_f32 v129, v129
    v_smfmac_f32_32x32x32_bf16 v[144:159], v[84:87], v[120:127], v13
    v_sub_f32 v130, v130, v14
    v_exp_f32 v130, v130
    v_sub_f32 v131, v131, v14
    v_exp_f32 v131, v131
    v_sub_f32 v132, v132, v14
    v_exp_f32 v132, v132
    v_mfma_f32_32x32x16_bf16 v[112:127], v[40:43], v[160:163], 0
    v_sub_f32 v133, v133, v14
    v_exp_f32 v133, v133
    v_sub_f32 v134, v134, v14
    v_exp_f32 v134, v134
    v_sub_f32 v135, v135, v14
    v_exp_f32 v135, v135
    v_sub_f32 v136, v136, v14
    v_exp_f32 v136, v136
    v_sub_f32 v137, v137, v14
    v_exp_f32 v137, v137
    v_sub_f32 v138, v138, v14
    v_exp_f32 v138, v138
    v_smfmac_f32_32x32x32_bf16 v[144:159], v[88:91], v[128:135], v13
    v_sub_f32 v139, v139, v14
    v_exp_f32 v139, v139
    s_add_u32 s67, s31, s29
    s_add_u32 s29, s29, 4096
    s_and_b32 s29, s29, 0x7fff
    v_sub_f32 v140, v140, v14
    v_exp_f32 v140, v140
    v_sub_f32 v141, v141, v14
    v_exp_f32 v141, v141
    s_waitcnt vmcnt(7)
    v_mfma_f32_16x16x32_bf16 v[176:179], v[192:195], v[216:219], v[176:179]
    buffer_load_dwordx4 v[192:195], v6, s[8:11], s49 offen offset:2048 sc1
    v_sub_f32 v142, v142, v14
    v_exp_f32 v142, v142
    v_sub_f32 v143, v143, v14
    v_exp_f32 v143, v143
    v_sub_f32 v112, v112, v14
    v_exp_f32 v112, v112
    v_sub_f32 v113, v113, v14
    v_exp_f32 v113, v113
    v_smfmac_f32_32x32x32_bf16 v[144:159], v[92:95], v[136:143], v13
    v_sub_f32 v114, v114, v14
    v_exp_f32 v114, v114
    v_sub_f32 v115, v115, v14
    v_exp_f32 v115, v115
    v_sub_f32 v116, v116, v14
    v_exp_f32 v116, v116
    v_mfma_f32_32x32x16_bf16 v[128:143], v[44:47], v[160:163], 0
    v_sub_f32 v117, v117, v14
    v_exp_f32 v117, v117
    v_sub_f32 v118, v118, v14
    v_exp_f32 v118, v118
    v_sub_f32 v119, v119, v14
    v_exp_f32 v119, v119
    v_sub_f32 v120, v120, v14
    v_exp_f32 v120, v120
    v_sub_f32 v121, v121, v14
    v_exp_f32 v121, v121
    v_sub_f32 v122, v122, v14
    v_exp_f32 v122, v122
    v_smfmac_f32_32x32x32_bf16 v[144:159], v[96:99], v[112:119], v13
    v_sub_f32 v123, v123, v14
    v_exp_f32 v123, v123
    s_add_u32 s68, s31, s29
    s_add_u32 s29, s29, 4096
    s_and_b32 s29, s29, 0x7fff
    v_sub_f32 v124, v124, v14
    v_exp_f32 v124, v124
    v_sub_f32 v125, v125, v14
    v_exp_f32 v125, v125
    v_mfma_f32_16x16x32_bf16 v[180:183], v[196:199], v[216:219], v[180:183]
    buffer_load_dwordx4 v[196:199], v6, s[8:11], s49 offen offset:3072 sc1
    v_sub_f32 v126, v126, v14
    v_exp_f32 v126, v126
    v_sub_f32 v127, v127, v14
    v_exp_f32 v127, v127
    s_setprio 1
    v_sub_f32 v128, v128, v14
    v_exp_f32 v128, v128
    v_sub_f32 v129, v129, v14
    v_exp_f32 v129, v129
    v_smfmac_f32_32x32x32_bf16 v[144:159], v[100:103], v[120:127], v13
    v_sub_f32 v130, v130, v14
    v_exp_f32 v130, v130
    v_sub_f32 v131, v131, v14
    v_exp_f32 v131, v131
    s_waitcnt vmcnt(5)
    v_sub_f32 v132, v132, v14
    v_exp_f32 v132, v132
    v_mfma_f32_32x32x16_bf16 v[112:127], v[16:19], v[164:167], 0
    v_sub_f32 v133, v133, v14
    v_exp_f32 v133, v133
    v_sub_f32 v134, v134, v14
    v_exp_f32 v134, v134
    v_sub_f32 v135, v135, v14
    v_exp_f32 v135, v135
    v_sub_f32 v136, v136, v14
    v_exp_f32 v136, v136
    v_sub_f32 v137, v137, v14
    v_exp_f32 v137, v137
    v_sub_f32 v138, v138, v14
    v_exp_f32 v138, v138
    v_smfmac_f32_32x32x32_bf16 v[144:159], v[104:107], v[128:135], v13
    v_sub_f32 v139, v139, v14
    v_exp_f32 v139, v139
    s_add_u32 s69, s31, s29
    s_add_u32 s29, s29, 4096
    s_and_b32 s29, s29, 0x7fff
    v_sub_f32 v140, v140, v14
    v_exp_f32 v140, v140
    v_sub_f32 v141, v141, v14
    v_exp_f32 v141, v141
    s_waitcnt vmcnt(7)
    v_mfma_f32_16x16x32_bf16 v[168:171], v[200:203], v[220:223], v[168:171]
    buffer_load_dwordx4 v[200:203], v6, s[8:11], s50 offen offset:0 sc1
    v_sub_f32 v142, v142, v14
    v_exp_f32 v142, v142
    v_sub_f32 v143, v143, v14
    v_exp_f32 v143, v143
    ds_read_b32 v14, v254 offset:640
    s_waitcnt lgkmcnt(0)
    v_sub_f32 v112, v112, v14
    v_exp_f32 v112, v112
    v_sub_f32 v113, v113, v14
    v_exp_f32 v113, v113
    v_smfmac_f32_32x32x32_bf16 v[144:159], v[108:111], v[136:143], v13
    v_sub_f32 v114, v114, v14
    v_exp_f32 v114, v114
    v_sub_f32 v115, v115, v14
    v_exp_f32 v115, v115
    v_sub_f32 v116, v116, v14
    v_exp_f32 v116, v116
    v_mfma_f32_32x32x16_bf16 v[128:143], v[20:23], v[164:167], 0
    v_sub_f32 v117, v117, v14
    v_exp_f32 v117, v117
    v_sub_f32 v118, v118, v14
    v_exp_f32 v118, v118
    v_sub_f32 v119, v119, v14
    v_exp_f32 v119, v119
    v_sub_f32 v120, v120, v14
    v_exp_f32 v120, v120
    v_sub_f32 v121, v121, v14
    v_exp_f32 v121, v121
    v_sub_f32 v122, v122, v14
    v_exp_f32 v122, v122
    v_sub_f32 v123, v123, v14
    v_exp_f32 v123, v123
    s_add_u32 s70, s31, s29
    s_add_u32 s29, s29, 4096
    s_and_b32 s29, s29, 0x7fff
    v_sub_f32 v124, v124, v14
    v_exp_f32 v124, v124
    ds_write_b128 v8, v[144:147] offset:0
    v_sub_f32 v125, v125, v14
    v_exp_f32 v125, v125
    ds_write_b128 v8, v[148:151] offset:1024
    v_mfma_f32_16x16x32_bf16 v[172:175], v[204:207], v[220:223], v[172:175]
    buffer_load_dwordx4 v[204:207], v6, s[8:11], s50 offen offset:1024 sc1
    v_sub_f32 v126, v126, v14
    v_exp_f32 v126, v126
    s_mov_b32 exec_hi, 0
    ds_write_b32 v252, v152 offset:512
    s_mov_b32 exec_hi, -1
    v_sub_f32 v127, v127, v14
    v_exp_f32 v127, v127
    v_mfma_f32_32x32x16_bf16 v[144:159], v[240:243], v[240:243], 0
    v_smfmac_f32_32x32x32_bf16 v[144:159], v[48:51], v[112:119], v13
    s_setprio 0
    v_sub_f32 v128, v128, v14
    v_exp_f32 v128, v128
    v_sub_f32 v129, v129, v14
    v_exp_f32 v129, v129
    v_smfmac_f32_32x32x32_bf16 v[144:159], v[52:55], v[120:127], v13
    v_sub_f32 v130, v130, v14
    v_exp_f32 v130, v130
    v_sub_f32 v131, v131, v14
    v_exp_f32 v131, v131
    v_sub_f32 v132, v132, v14
    v_exp_f32 v132, v132
    v_mfma_f32_32x32x16_bf16 v[112:127], v[24:27], v[164:167], 0
    v_sub_f32 v133, v133, v14
    v_exp_f32 v133, v133
    v_sub_f32 v134, v134, v14
    v_exp_f32 v134, v134
    v_sub_f32 v135, v135, v14
    v_exp_f32 v135, v135
    v_sub_f32 v136, v136, v14
    v_exp_f32 v136, v136
    v_sub_f32 v137, v137, v14
    v_exp_f32 v137, v137
    v_sub_f32 v138, v138, v14
    v_exp_f32 v138, v138
    v_smfmac_f32_32x32x32_bf16 v[144:159], v[56:59], v[128:135], v13
    v_sub_f32 v139, v139, v14
    v_exp_f32 v139, v139
    s_add_u32 s71, s31, s29
    s_add_u32 s29, s29, 4096
    s_and_b32 s29, s29, 0x7fff
    v_sub_f32 v140, v140, v14
    v_exp_f32 v140, v140
    v_sub_f32 v141, v141, v14
    v_exp_f32 v141, v141
    s_waitcnt vmcnt(6)
    v_mfma_f32_16x16x32_bf16 v[176:179], v[208:211], v[220:223], v[176:179]
    buffer_load_dwordx4 v[208:211], v6, s[8:11], s50 offen offset:2048 sc1
    v_sub_f32 v142, v142, v14
    v_exp_f32 v142, v142
    v_sub_f32 v143, v143, v14
    v_exp_f32 v143, v143
    s_setprio 3
    v_sub_f32 v112, v112, v14
    v_exp_f32 v112, v112
    v_sub_f32 v113, v113, v14
    v_exp_f32 v113, v113
    v_smfmac_f32_32x32x32_bf16 v[144:159], v[60:63], v[136:143], v13
    v_sub_f32 v114, v114, v14
    v_exp_f32 v114, v114
    s_add_u32 s48, s56, 6144
    s_and_b32 s48, s48, 8191
    s_add_u32 s48, s48, s55
    v_sub_f32 v115, v115, v14
    v_exp_f32 v115, v115
    buffer_load_dwordx4 v[160:163], v6, s[8:11], s48 offen sc1
    v_sub_f32 v116, v116, v14
    v_exp_f32 v116, v116
    v_mfma_f32_32x32x16_bf16 v[128:143], v[28:31], v[164:167], 0
    v_sub_f32 v117, v117, v14
    v_exp_f32 v117, v117
    v_sub_f32 v118, v118, v14
    v_exp_f32 v118, v118
    v_sub_f32 v119, v119, v14
    v_exp_f32 v119, v119
    v_sub_f32 v120, v120, v14
    v_exp_f32 v120, v120
    v_sub_f32 v121, v121, v14
    v_exp_f32 v121, v121
    v_sub_f32 v122, v122, v14
    v_exp_f32 v122, v122
    v_smfmac_f32_32x32x32_bf16 v[144:159], v[64:67], v[112:119], v13
    v_sub_f32 v123, v123, v14
    v_exp_f32 v123, v123
    s_add_u32 s72, s31, s29
    s_add_u32 s29, s29, 4096
    s_and_b32 s29, s29, 0x7fff
    v_sub_f32 v124, v124, v14
    v_exp_f32 v124, v124
    v_sub_f32 v125, v125, v14
    v_exp_f32 v125, v125
    v_mfma_f32_16x16x32_bf16 v[180:183], v[212:215], v[220:223], v[180:183]
    buffer_load_dwordx4 v[212:215], v6, s[8:11], s50 offen offset:3072 sc1
    v_sub_f32 v126, v126, v14
    v_exp_f32 v126, v126
    v_sub_f32 v127, v127, v14
    v_exp_f32 v127, v127
    s_waitcnt lgkmcnt(0)
    s_barrier
    s_mov_b64 exec, s[94:95]
    ds_read_b128 v[216:219], v11 offset:1024
    ds_read_b128 v[220:223], v11 offset:1536
    s_mov_b64 exec, -1
    v_sub_f32 v128, v128, v14
    v_exp_f32 v128, v128
    s_bitcmp0_b32 s5, 2
    s_cbranch_scc1 CB_79
    ds_read2st64_b32 v[244:245], v253 offset0:2 offset1:6
    ds_read2st64_b32 v[246:247], v253 offset0:10 offset1:14
    ds_read2st64_b32 v[248:249], v253 offset0:18 offset1:22
    ds_read2st64_b32 v[250:251], v253 offset0:26 offset1:30
    ds_read2st64_b64 v[224:227], v9 offset0:0 offset1:4
    ds_read2st64_b64 v[228:231], v9 offset0:8 offset1:12
    ds_read2st64_b64 v[232:235], v9 offset0:16 offset1:20
    ds_read2st64_b64 v[236:239], v9 offset0:24 offset1:28
CB_79:
    v_sub_f32 v129, v129, v14
    v_exp_f32 v129, v129
    v_smfmac_f32_32x32x32_bf16 v[144:159], v[68:71], v[120:127], v13
    v_sub_f32 v130, v130, v14
    v_exp_f32 v130, v130
    v_sub_f32 v131, v131, v14
    v_exp_f32 v131, v131
    v_sub_f32 v132, v132, v14
    v_exp_f32 v132, v132
    v_mfma_f32_32x32x16_bf16 v[112:127], v[32:35], v[164:167], 0
    v_sub_f32 v133, v133, v14
    v_exp_f32 v133, v133
    v_sub_f32 v134, v134, v14
    v_exp_f32 v134, v134
    v_sub_f32 v135, v135, v14
    v_exp_f32 v135, v135
    v_sub_f32 v136, v136, v14
    v_exp_f32 v136, v136
    v_sub_f32 v137, v137, v14
    v_exp_f32 v137, v137
    s_bitcmp0_b32 s5, 2
    s_cbranch_scc1 CB_80
    s_waitcnt lgkmcnt(4)
    v_pk_add_f32 v[244:245], v[244:245], v[246:247]
    v_pk_add_f32 v[248:249], v[248:249], v[250:251]
    v_pk_add_f32 v[244:245], v[244:245], v[248:249]
    v_add_f32 v245, v244, v245
    v_rcp_f32 v244, v245
    s_waitcnt lgkmcnt(0)
    v_pk_add_f32 v[224:225], v[224:225], v[226:227]
    v_pk_add_f32 v[228:229], v[228:229], v[230:231]
    v_pk_add_f32 v[232:233], v[232:233], v[234:235]
    v_pk_add_f32 v[236:237], v[236:237], v[238:239]
    v_pk_add_f32 v[224:225], v[224:225], v[228:229]
    v_pk_add_f32 v[232:233], v[232:233], v[236:237]
    v_pk_add_f32 v[224:225], v[224:225], v[232:233]
    v_mul_f32 v224, v224, v244
    v_mul_f32 v225, v225, v244
    v_cvt_pk_bf16_f32 v226, v224, v225
    ds_write_b32 v10, v226 offset:0
CB_80:
    v_sub_f32 v138, v138, v14
    v_exp_f32 v138, v138
    v_smfmac_f32_32x32x32_bf16 v[144:159], v[72:75], v[128:135], v13
    v_sub_f32 v139, v139, v14
    v_exp_f32 v139, v139
    s_add_u32 s49, s56, 4096
    s_and_b32 s49, s49, 8191
    s_lshl_b32 s49, s49, 6
    s_add_u32 s49, s49, s57
    s_add_u32 s50, s49, 32768
    s_add_u32 s73, s31, s29
    v_sub_f32 v140, v140, v14
    v_exp_f32 v140, v140
    v_sub_f32 v141, v141, v14
    v_exp_f32 v141, v141
    s_waitcnt lgkmcnt(0)
    s_waitcnt vmcnt(7)
    v_mfma_f32_16x16x32_bf16 v[168:171], v[184:187], v[216:219], v[168:171]
    buffer_load_dwordx4 v[184:187], v6, s[8:11], s49 offen offset:0 sc1
    v_sub_f32 v142, v142, v14
    v_exp_f32 v142, v142
    v_sub_f32 v143, v143, v14
    v_exp_f32 v143, v143
    v_sub_f32 v112, v112, v14
    v_exp_f32 v112, v112
    v_sub_f32 v113, v113, v14
    v_exp_f32 v113, v113
    v_smfmac_f32_32x32x32_bf16 v[144:159], v[76:79], v[136:143], v13
    v_sub_f32 v114, v114, v14
    v_exp_f32 v114, v114
    v_lshrrev_b32 v15, 4, v1
    v_lshlrev_b32 v15, 11, v15
    v_and_b32 v2, 15, v1
    v_lshl_add_u32 v15, v2, 4, v15
    s_lshl_b32 s39, s5, 8
    s_add_u32 s39, s39, 20480
    v_sub_f32 v115, v115, v14
    v_exp_f32 v115, v115
    buffer_load_dwordx4 v[2:5], v15, s[8:11], s39 offen sc1
    v_sub_f32 v116, v116, v14
    v_exp_f32 v116, v116
    v_mfma_f32_32x32x16_bf16 v[128:143], v[36:39], v[164:167], 0
    v_sub_f32 v117, v117, v14
    v_exp_f32 v117, v117
    v_sub_f32 v118, v118, v14
    v_exp_f32 v118, v118
    v_sub_f32 v119, v119, v14
    v_exp_f32 v119, v119
    v_sub_f32 v120, v120, v14
    v_exp_f32 v120, v120
    v_sub_f32 v121, v121, v14
    v_exp_f32 v121, v121
    v_sub_f32 v122, v122, v14
    v_exp_f32 v122, v122
    v_smfmac_f32_32x32x32_bf16 v[144:159], v[80:83], v[112:119], v13
    v_sub_f32 v123, v123, v14
    v_exp_f32 v123, v123
    s_mul_i32 s60, s4, 7
    s_add_u32 s60, s60, 1
    s_lshr_b32 s60, s60, 1
    s_add_u32 s43, s43, s60
    v_sub_f32 v124, v124, v14
    v_exp_f32 v124, v124
    v_sub_f32 v125, v125, v14
    v_exp_f32 v125, v125
    v_mfma_f32_16x16x32_bf16 v[172:175], v[188:191], v[216:219], v[172:175]
    buffer_load_dwordx4 v[188:191], v6, s[8:11], s49 offen offset:1024 sc1
    v_sub_f32 v126, v126, v14
    v_exp_f32 v126, v126
    v_sub_f32 v127, v127, v14
    v_exp_f32 v127, v127
    s_setprio 2
    v_sub_f32 v128, v128, v14
    v_exp_f32 v128, v128
    v_sub_f32 v129, v129, v14
    v_exp_f32 v129, v129
    v_smfmac_f32_32x32x32_bf16 v[144:159], v[84:87], v[120:127], v13
    v_sub_f32 v130, v130, v14
    v_exp_f32 v130, v130
    v_sub_f32 v131, v131, v14
    v_exp_f32 v131, v131
    v_sub_f32 v132, v132, v14
    v_exp_f32 v132, v132
    v_mfma_f32_32x32x16_bf16 v[112:127], v[40:43], v[164:167], 0
    v_sub_f32 v133, v133, v14
    v_exp_f32 v133, v133
    v_sub_f32 v134, v134, v14
    v_exp_f32 v134, v134
    v_sub_f32 v135, v135, v14
    v_exp_f32 v135, v135
    v_sub_f32 v136, v136, v14
    v_exp_f32 v136, v136
    v_sub_f32 v137, v137, v14
    v_exp_f32 v137, v137
    v_sub_f32 v138, v138, v14
    v_exp_f32 v138, v138
    v_smfmac_f32_32x32x32_bf16 v[144:159], v[88:91], v[128:135], v13
    v_sub_f32 v139, v139, v14
    v_exp_f32 v139, v139
    s_lshl_b32 s43, s43, 10
    s_add_u32 s43, s43, 8388608
    s_movk_i32 s47, 3072
    v_sub_f32 v140, v140, v14
    v_exp_f32 v140, v140
    v_sub_f32 v141, v141, v14
    v_exp_f32 v141, v141
    s_waitcnt vmcnt(8)
    v_mfma_f32_16x16x32_bf16 v[176:179], v[192:195], v[216:219], v[176:179]
    buffer_load_dwordx4 v[192:195], v6, s[8:11], s49 offen offset:2048 sc1
    v_sub_f32 v142, v142, v14
    v_exp_f32 v142, v142
    v_sub_f32 v143, v143, v14
    v_exp_f32 v143, v143
    v_sub_f32 v112, v112, v14
    v_exp_f32 v112, v112
    v_sub_f32 v113, v113, v14
    v_exp_f32 v113, v113
    v_smfmac_f32_32x32x32_bf16 v[144:159], v[92:95], v[136:143], v13
    v_sub_f32 v114, v114, v14
    v_exp_f32 v114, v114
    v_sub_f32 v115, v115, v14
    v_exp_f32 v115, v115
    v_sub_f32 v116, v116, v14
    v_exp_f32 v116, v116
    v_mfma_f32_32x32x16_bf16 v[128:143], v[44:47], v[164:167], 0
    v_sub_f32 v117, v117, v14
    v_exp_f32 v117, v117
    v_sub_f32 v118, v118, v14
    v_exp_f32 v118, v118
    v_sub_f32 v119, v119, v14
    v_exp_f32 v119, v119
    v_sub_f32 v120, v120, v14
    v_exp_f32 v120, v120
    v_sub_f32 v121, v121, v14
    v_exp_f32 v121, v121
    v_sub_f32 v122, v122, v14
    v_exp_f32 v122, v122
    v_smfmac_f32_32x32x32_bf16 v[144:159], v[96:99], v[112:119], v13
    v_sub_f32 v123, v123, v14
    v_exp_f32 v123, v123
    s_bitcmp1_b32 s4, 0
    s_cselect_b32 s84, 16, 0
    s_cselect_b32 s85, 0, 96
    s_cselect_b32 s47, -512, s47
    s_add_u32 s47, s47, s43
    v_sub_f32 v124, v124, v14
    v_exp_f32 v124, v124
    v_sub_f32 v125, v125, v14
    v_exp_f32 v125, v125
    v_mfma_f32_16x16x32_bf16 v[180:183], v[196:199], v[216:219], v[180:183]
    buffer_load_dwordx4 v[196:199], v6, s[8:11], s49 offen offset:3072 sc1
    v_sub_f32 v126, v126, v14
    v_exp_f32 v126, v126
    v_sub_f32 v127, v127, v14
    v_exp_f32 v127, v127
    s_setprio 1
    v_sub_f32 v128, v128, v14
    v_exp_f32 v128, v128
    v_sub_f32 v129, v129, v14
    v_exp_f32 v129, v129
    v_smfmac_f32_32x32x32_bf16 v[144:159], v[100:103], v[120:127], v13
    v_sub_f32 v130, v130, v14
    v_exp_f32 v130, v130
    v_sub_f32 v131, v131, v14
    v_exp_f32 v131, v131
    s_waitcnt vmcnt(6)
    v_sub_f32 v132, v132, v14
    v_exp_f32 v132, v132
    v_mfma_f32_32x32x16_bf16 v[112:127], v[16:19], v[160:163], 0
    v_sub_f32 v133, v133, v14
    v_exp_f32 v133, v133
    v_sub_f32 v134, v134, v14
    v_exp_f32 v134, v134
    v_sub_f32 v135, v135, v14
    v_exp_f32 v135, v135
    v_sub_f32 v136, v136, v14
    v_exp_f32 v136, v136
    v_sub_f32 v137, v137, v14
    v_exp_f32 v137, v137
    v_sub_f32 v138, v138, v14
    v_exp_f32 v138, v138
    v_smfmac_f32_32x32x32_bf16 v[144:159], v[104:107], v[128:135], v13
    v_sub_f32 v139, v139, v14
    v_exp_f32 v139, v139
    s_lshr_b32 s28, s4, 2
    s_add_u32 s28, s28, s30
    s_lshl_b32 s28, s28, 3
    s_add_u32 s28, s28, s5
    v_sub_f32 v140, v140, v14
    v_exp_f32 v140, v140
    v_sub_f32 v141, v141, v14
    v_exp_f32 v141, v141
    s_waitcnt vmcnt(8)
    v_mfma_f32_16x16x32_bf16 v[168:171], v[200:203], v[220:223], v[168:171]
    buffer_load_dwordx4 v[200:203], v6, s[8:11], s50 offen offset:0 sc1
    v_sub_f32 v142, v142, v14
    v_exp_f32 v142, v142
    v_sub_f32 v143, v143, v14
    v_exp_f32 v143, v143
    ds_read_b32 v14, v254 offset:768
    s_waitcnt lgkmcnt(0)
    v_sub_f32 v112, v112, v14
    v_exp_f32 v112, v112
    v_sub_f32 v113, v113, v14
    v_exp_f32 v113, v113
    v_smfmac_f32_32x32x32_bf16 v[144:159], v[108:111], v[136:143], v13
    v_sub_f32 v114, v114, v14
    v_exp_f32 v114, v114
    v_sub_f32 v115, v115, v14
    v_exp_f32 v115, v115
    v_sub_f32 v116, v116, v14
    v_exp_f32 v116, v116
    v_mfma_f32_32x32x16_bf16 v[128:143], v[20:23], v[160:163], 0
    v_sub_f32 v117, v117, v14
    v_exp_f32 v117, v117
    v_sub_f32 v118, v118, v14
    v_exp_f32 v118, v118
    v_sub_f32 v119, v119, v14
    v_exp_f32 v119, v119
    v_sub_f32 v120, v120, v14
    v_exp_f32 v120, v120
    v_sub_f32 v121, v121, v14
    v_exp_f32 v121, v121
    v_sub_f32 v122, v122, v14
    v_exp_f32 v122, v122
    v_sub_f32 v123, v123, v14
    v_exp_f32 v123, v123
    s_lshl_b32 s28, s28, 5
    s_and_b32 s60, s4, 3
    s_add_u32 s28, s28, s60
    s_lshl_b32 s28, s28, 7
    s_add_u32 s28, s28, 6291456
    v_sub_f32 v124, v124, v14
    v_exp_f32 v124, v124
    ds_write_b128 v8, v[144:147] offset:16384
    v_sub_f32 v125, v125, v14
    v_exp_f32 v125, v125
    ds_write_b128 v8, v[148:151] offset:17408
    v_mfma_f32_16x16x32_bf16 v[172:175], v[204:207], v[220:223], v[172:175]
    buffer_load_dwordx4 v[204:207], v6, s[8:11], s50 offen offset:1024 sc1
    v_sub_f32 v126, v126, v14
    v_exp_f32 v126, v126
    s_mov_b32 exec_hi, 0
    ds_write_b32 v252, v152 offset:640
    s_mov_b32 exec_hi, -1
    v_sub_f32 v127, v127, v14
    v_exp_f32 v127, v127
    v_mfma_f32_32x32x16_bf16 v[144:159], v[240:243], v[240:243], 0
    v_smfmac_f32_32x32x32_bf16 v[144:159], v[48:51], v[112:119], v13
    s_setprio 0
    v_sub_f32 v128, v128, v14
    v_exp_f32 v128, v128
    v_sub_f32 v129, v129, v14
    v_exp_f32 v129, v129
    v_smfmac_f32_32x32x32_bf16 v[144:159], v[52:55], v[120:127], v13
    v_sub_f32 v130, v130, v14
    v_exp_f32 v130, v130
    v_sub_f32 v131, v131, v14
    v_exp_f32 v131, v131
    v_sub_f32 v132, v132, v14
    v_exp_f32 v132, v132
    v_mfma_f32_32x32x16_bf16 v[112:127], v[24:27], v[160:163], 0
    v_sub_f32 v133, v133, v14
    v_exp_f32 v133, v133
    v_sub_f32 v134, v134, v14
    v_exp_f32 v134, v134
    v_sub_f32 v135, v135, v14
    v_exp_f32 v135, v135
    v_sub_f32 v136, v136, v14
    v_exp_f32 v136, v136
    v_sub_f32 v137, v137, v14
    v_exp_f32 v137, v137
    v_sub_f32 v138, v138, v14
    v_exp_f32 v138, v138
    v_smfmac_f32_32x32x32_bf16 v[144:159], v[56:59], v[128:135], v13
    v_sub_f32 v139, v139, v14
    v_exp_f32 v139, v139
    v_sub_f32 v140, v140, v14
    v_exp_f32 v140, v140
    v_sub_f32 v141, v141, v14
    v_exp_f32 v141, v141
    s_waitcnt vmcnt(7)
    v_mfma_f32_16x16x32_bf16 v[176:179], v[208:211], v[220:223], v[176:179]
    buffer_load_dwordx4 v[208:211], v6, s[8:11], s50 offen offset:2048 sc1
    v_sub_f32 v142, v142, v14
    v_exp_f32 v142, v142
    v_sub_f32 v143, v143, v14
    v_exp_f32 v143, v143
    s_setprio 3
    v_sub_f32 v112, v112, v14
    v_exp_f32 v112, v112
    v_sub_f32 v113, v113, v14
    v_exp_f32 v113, v113
    v_smfmac_f32_32x32x32_bf16 v[144:159], v[60:63], v[136:143], v13
    v_sub_f32 v114, v114, v14
    v_exp_f32 v114, v114
    s_add_u32 s48, s56, 7168
    s_and_b32 s48, s48, 8191
    s_add_u32 s48, s48, s55
    v_sub_f32 v115, v115, v14
    v_exp_f32 v115, v115
    buffer_load_dwordx4 v[164:167], v6, s[8:11], s48 offen sc1
    v_sub_f32 v116, v116, v14
    v_exp_f32 v116, v116
    v_mfma_f32_32x32x16_bf16 v[128:143], v[28:31], v[160:163], 0
    v_sub_f32 v117, v117, v14
    v_exp_f32 v117, v117
    v_sub_f32 v118, v118, v14
    v_exp_f32 v118, v118
    v_sub_f32 v119, v119, v14
    v_exp_f32 v119, v119
    v_sub_f32 v120, v120, v14
    v_exp_f32 v120, v120
    v_sub_f32 v121, v121, v14
    v_exp_f32 v121, v121
    v_sub_f32 v122, v122, v14
    v_exp_f32 v122, v122
    v_smfmac_f32_32x32x32_bf16 v[144:159], v[64:67], v[112:119], v13
    v_sub_f32 v123, v123, v14
    v_exp_f32 v123, v123
    v_sub_f32 v124, v124, v14
    v_exp_f32 v124, v124
    v_sub_f32 v125, v125, v14
    v_exp_f32 v125, v125
    v_mfma_f32_16x16x32_bf16 v[180:183], v[212:215], v[220:223], v[180:183]
    buffer_load_dwordx4 v[212:215], v6, s[8:11], s50 offen offset:3072 sc1
    v_sub_f32 v126, v126, v14
    v_exp_f32 v126, v126
    v_sub_f32 v127, v127, v14
    v_exp_f32 v127, v127
    s_waitcnt lgkmcnt(0)
    s_barrier
    s_mov_b64 exec, s[94:95]
    ds_read_b128 v[216:219], v11 offset:0
    ds_read_b128 v[220:223], v11 offset:512
    s_mov_b64 exec, -1
    v_sub_f32 v128, v128, v14
    v_exp_f32 v128, v128
    s_bitcmp1_b32 s5, 2
    s_cbranch_scc1 CB_81
    ds_read2st64_b32 v[244:245], v253 offset0:2 offset1:6
    ds_read2st64_b32 v[246:247], v253 offset0:10 offset1:14
    ds_read2st64_b32 v[248:249], v253 offset0:18 offset1:22
    ds_read2st64_b32 v[250:251], v253 offset0:26 offset1:30
    ds_read2st64_b64 v[224:227], v9 offset0:32 offset1:36
    ds_read2st64_b64 v[228:231], v9 offset0:40 offset1:44
    ds_read2st64_b64 v[232:235], v9 offset0:48 offset1:52
    ds_read2st64_b64 v[236:239], v9 offset0:56 offset1:60
CB_81:
    v_sub_f32 v129, v129, v14
    v_exp_f32 v129, v129
    v_smfmac_f32_32x32x32_bf16 v[144:159], v[68:71], v[120:127], v13
    v_sub_f32 v130, v130, v14
    v_exp_f32 v130, v130
    v_sub_f32 v131, v131, v14
    v_exp_f32 v131, v131
    v_sub_f32 v132, v132, v14
    v_exp_f32 v132, v132
    v_mfma_f32_32x32x16_bf16 v[112:127], v[32:35], v[160:163], 0
    v_sub_f32 v133, v133, v14
    v_exp_f32 v133, v133
    v_sub_f32 v134, v134, v14
    v_exp_f32 v134, v134
    v_sub_f32 v135, v135, v14
    v_exp_f32 v135, v135
    v_sub_f32 v136, v136, v14
    v_exp_f32 v136, v136
    v_sub_f32 v137, v137, v14
    v_exp_f32 v137, v137
    s_bitcmp1_b32 s5, 2
    s_cbranch_scc1 CB_82
    s_waitcnt lgkmcnt(4)
    v_pk_add_f32 v[244:245], v[244:245], v[246:247]
    v_pk_add_f32 v[248:249], v[248:249], v[250:251]
    v_pk_add_f32 v[244:245], v[244:245], v[248:249]
    v_add_f32 v245, v244, v245
    v_rcp_f32 v244, v245
    s_waitcnt lgkmcnt(0)
    v_pk_add_f32 v[224:225], v[224:225], v[226:227]
    v_pk_add_f32 v[228:229], v[228:229], v[230:231]
    v_pk_add_f32 v[232:233], v[232:233], v[234:235]
    v_pk_add_f32 v[236:237], v[236:237], v[238:239]
    v_pk_add_f32 v[224:225], v[224:225], v[228:229]
    v_pk_add_f32 v[232:233], v[232:233], v[236:237]
    v_pk_add_f32 v[224:225], v[224:225], v[232:233]
    v_mul_f32 v224, v224, v244
    v_mul_f32 v225, v225, v244
    v_cvt_pk_bf16_f32 v226, v224, v225
    ds_write_b32 v10, v226 offset:1024
CB_82:
    v_sub_f32 v138, v138, v14
    v_exp_f32 v138, v138
    v_smfmac_f32_32x32x32_bf16 v[144:159], v[72:75], v[128:135], v13
    v_sub_f32 v139, v139, v14
    v_exp_f32 v139, v139
    s_add_u32 s49, s56, 5120
    s_and_b32 s49, s49, 8191
    s_lshl_b32 s49, s49, 6
    s_add_u32 s49, s49, s57
    s_add_u32 s50, s49, 32768
    v_sub_f32 v140, v140, v14
    v_exp_f32 v140, v140
    v_sub_f32 v141, v141, v14
    v_exp_f32 v141, v141
    s_waitcnt lgkmcnt(0)
    s_waitcnt vmcnt(7)
    v_mfma_f32_16x16x32_bf16 v[168:171], v[184:187], v[216:219], v[168:171]
    buffer_load_dwordx4 v[184:187], v6, s[8:11], s49 offen offset:0 sc1
    v_sub_f32 v142, v142, v14
    v_exp_f32 v142, v142
    v_sub_f32 v143, v143, v14
    v_exp_f32 v143, v143
    v_sub_f32 v112, v112, v14
    v_exp_f32 v112, v112
    v_sub_f32 v113, v113, v14
    v_exp_f32 v113, v113
    v_smfmac_f32_32x32x32_bf16 v[144:159], v[76:79], v[136:143], v13
    v_sub_f32 v114, v114, v14
    v_exp_f32 v114, v114
    v_sub_f32 v115, v115, v14
    v_exp_f32 v115, v115
    v_sub_f32 v116, v116, v14
    v_exp_f32 v116, v116
    v_mfma_f32_32x32x16_bf16 v[128:143], v[36:39], v[160:163], 0
    v_sub_f32 v117, v117, v14
    v_exp_f32 v117, v117
    v_sub_f32 v118, v118, v14
    v_exp_f32 v118, v118
    v_sub_f32 v119, v119, v14
    v_exp_f32 v119, v119
    v_sub_f32 v120, v120, v14
    v_exp_f32 v120, v120
    v_sub_f32 v121, v121, v14
    v_exp_f32 v121, v121
    v_sub_f32 v122, v122, v14
    v_exp_f32 v122, v122
    v_smfmac_f32_32x32x32_bf16 v[144:159], v[80:83], v[112:119], v13
    v_sub_f32 v123, v123, v14
    v_exp_f32 v123, v123
    v_sub_f32 v124, v124, v14
    v_exp_f32 v124, v124
    v_sub_f32 v125, v125, v14
    v_exp_f32 v125, v125
    v_mfma_f32_16x16x32_bf16 v[172:175], v[188:191], v[216:219], v[172:175]
    buffer_load_dwordx4 v[188:191], v6, s[8:11], s49 offen offset:1024 sc1
    v_sub_f32 v126, v126, v14
    v_exp_f32 v126, v126
    v_sub_f32 v127, v127, v14
    v_exp_f32 v127, v127
    s_setprio 2
    v_sub_f32 v128, v128, v14
    v_exp_f32 v128, v128
    v_sub_f32 v129, v129, v14
    v_exp_f32 v129, v129
    v_smfmac_f32_32x32x32_bf16 v[144:159], v[84:87], v[120:127], v13
    v_sub_f32 v130, v130, v14
    v_exp_f32 v130, v130
    s_waitcnt vmcnt(10)
    v_perm_b32 v244, v3, v2, s58
    v_perm_b32 v245, v5, v4, s59
    v_or_b32 v244, v244, v245
    v_cmp_ne_u32 vcc, s6, v244
    s_cbranch_vccnz MC_83
MC_83_R:
    v_and_b32 v2, 0xffff0000, v2
    v_and_b32 v3, 0xffff0000, v3
    v_and_b32 v4, 0xffff0000, v4
    v_and_b32 v5, 0xffff0000, v5
    s_mov_b32 exec_lo, 0xffff0000
    s_mov_b32 exec_hi, 0xffff
    v_mul_f32 v2, 0xbfb8aa3b, v2
    v_mul_f32 v3, 0xbfb8aa3b, v3
    v_mul_f32 v4, 0xbfb8aa3b, v4
    v_mul_f32 v5, 0xbfb8aa3b, v5
    s_mov_b64 exec, -1
    v_sub_f32 v131, v131, v14
    v_exp_f32 v131, v131
    v_sub_f32 v132, v132, v14
    v_exp_f32 v132, v132
    v_mfma_f32_32x32x16_bf16 v[112:127], v[40:43], v[160:163], 0
    v_sub_f32 v133, v133, v14
    v_exp_f32 v133, v133
    v_sub_f32 v134, v134, v14
    v_exp_f32 v134, v134
    v_sub_f32 v135, v135, v14
    v_exp_f32 v135, v135
    v_sub_f32 v136, v136, v14
    v_exp_f32 v136, v136
    v_sub_f32 v137, v137, v14
    v_exp_f32 v137, v137
    v_sub_f32 v138, v138, v14
    v_exp_f32 v138, v138
    v_smfmac_f32_32x32x32_bf16 v[144:159], v[88:91], v[128:135], v13
    v_sub_f32 v139, v139, v14
    v_exp_f32 v139, v139
    v_sub_f32 v140, v140, v14
    v_exp_f32 v140, v140
    v_sub_f32 v141, v141, v14
    v_exp_f32 v141, v141
    s_waitcnt vmcnt(7)
    v_mfma_f32_16x16x32_bf16 v[176:179], v[192:195], v[216:219], v[176:179]
    buffer_load_dwordx4 v[192:195], v6, s[8:11], s49 offen offset:2048 sc1
    v_sub_f32 v142, v142, v14
    v_exp_f32 v142, v142
    v_sub_f32 v143, v143, v14
    v_exp_f32 v143, v143
    v_sub_f32 v112, v112, v14
    v_exp_f32 v112, v112
    v_sub_f32 v113, v113, v14
    v_exp_f32 v113, v113
    v_smfmac_f32_32x32x32_bf16 v[144:159], v[92:95], v[136:143], v13
    v_sub_f32 v114, v114, v14
    v_exp_f32 v114, v114
    v_sub_f32 v115, v115, v14
    v_exp_f32 v115, v115
    v_sub_f32 v116, v116, v14
    v_exp_f32 v116, v116
    v_mfma_f32_32x32x16_bf16 v[128:143], v[44:47], v[160:163], 0
    v_sub_f32 v117, v117, v14
    v_exp_f32 v117, v117
    v_lshrrev_b32 v0, 3, v1
    v_and_b32 v7, 7, v1
    v_bfe_u32 v12, v1, 4, 1
    v_lshlrev_b32 v12, 2, v12
    v_xor_b32 v7, v7, v12
    v_lshlrev_b32 v12, 10, v0
    s_and_b32 s60, s4, 7
    s_lshl_b32 s61, s60, 7
    v_lshl_add_u32 v7, v7, 4, s61
    s_lshr_b32 s62, s5, 2
    s_mul_i32 s62, s62, 8224
    v_add_u32 v7, v7, v12
    v_xor_b32 v12, s62, v7
    v_sub_f32 v118, v118, v14
    v_exp_f32 v118, v118
    v_sub_f32 v119, v119, v14
    v_exp_f32 v119, v119
    v_sub_f32 v120, v120, v14
    v_exp_f32 v120, v120
    v_sub_f32 v121, v121, v14
    v_exp_f32 v121, v121
    v_sub_f32 v122, v122, v14
    v_exp_f32 v122, v122
    v_smfmac_f32_32x32x32_bf16 v[144:159], v[96:99], v[112:119], v13
    v_sub_f32 v123, v123, v14
    v_exp_f32 v123, v123
    v_sub_f32 v124, v124, v14
    v_exp_f32 v124, v124
    v_sub_f32 v125, v125, v14
    v_exp_f32 v125, v125
    v_mfma_f32_16x16x32_bf16 v[180:183], v[196:199], v[216:219], v[180:183]
    buffer_load_dwordx4 v[196:199], v6, s[8:11], s49 offen offset:3072 sc1
    v_sub_f32 v126, v126, v14
    v_exp_f32 v126, v126
    v_sub_f32 v127, v127, v14
    v_exp_f32 v127, v127
    s_setprio 1
    v_sub_f32 v128, v128, v14
    v_exp_f32 v128, v128
    v_sub_f32 v129, v129, v14
    v_exp_f32 v129, v129
    v_smfmac_f32_32x32x32_bf16 v[144:159], v[100:103], v[120:127], v13
    v_sub_f32 v130, v130, v14
    v_exp_f32 v130, v130
    v_sub_f32 v131, v131, v14
    v_exp_f32 v131, v131
    s_waitcnt vmcnt(5)
    v_sub_f32 v132, v132, v14
    v_exp_f32 v132, v132
    v_mfma_f32_32x32x16_bf16 v[112:127], v[16:19], v[164:167], 0
    v_sub_f32 v133, v133, v14
    v_exp_f32 v133, v133
    s_mov_b32 s12, s86
    s_mov_b32 s13, s87
    s_mov_b32 s14, 2097152
    s_mov_b32 s15, 0x00020000
    v_sub_f32 v134, v134, v14
    v_exp_f32 v134, v134
    v_sub_f32 v135, v135, v14
    v_exp_f32 v135, v135
    v_sub_f32 v136, v136, v14
    v_exp_f32 v136, v136
    v_sub_f32 v137, v137, v14
    v_exp_f32 v137, v137
    v_sub_f32 v138, v138, v14
    v_exp_f32 v138, v138
    v_smfmac_f32_32x32x32_bf16 v[144:159], v[104:107], v[128:135], v13
    v_sub_f32 v139, v139, v14
    v_exp_f32 v139, v139
    v_sub_f32 v140, v140, v14
    v_exp_f32 v140, v140
    v_sub_f32 v141, v141, v14
    v_exp_f32 v141, v141
    s_waitcnt vmcnt(7)
    v_mfma_f32_16x16x32_bf16 v[168:171], v[200:203], v[220:223], v[168:171]
    buffer_load_dwordx4 v[200:203], v6, s[8:11], s50 offen offset:0 sc1
    v_sub_f32 v142, v142, v14
    v_exp_f32 v142, v142
    v_sub_f32 v143, v143, v14
    v_exp_f32 v143, v143
    ds_read_b32 v14, v254 offset:896
    s_waitcnt lgkmcnt(0)
    v_sub_f32 v112, v112, v14
    v_exp_f32 v112, v112
    v_sub_f32 v113, v113, v14
    v_exp_f32 v113, v113
    v_smfmac_f32_32x32x32_bf16 v[144:159], v[108:111], v[136:143], v13
    v_sub_f32 v114, v114, v14
    v_exp_f32 v114, v114
    v_sub_f32 v115, v115, v14
    v_exp_f32 v115, v115
    v_sub_f32 v116, v116, v14
    v_exp_f32 v116, v116
    v_mfma_f32_32x32x16_bf16 v[128:143], v[20:23], v[164:167], 0
    v_sub_f32 v117, v117, v14
    v_exp_f32 v117, v117
    v_sub_f32 v118, v118, v14
    v_exp_f32 v118, v118
    v_sub_f32 v119, v119, v14
    v_exp_f32 v119, v119
    v_mfma_f32_16x16x32_bf16 v[172:175], v[204:207], v[220:223], v[172:175]
    buffer_load_dwordx4 v[204:207], v6, s[8:11], s50 offen offset:1024 sc1
    v_sub_f32 v120, v120, v14
    v_exp_f32 v120, v120
    v_sub_f32 v121, v121, v14
    v_exp_f32 v121, v121
    v_sub_f32 v122, v122, v14
    v_exp_f32 v122, v122
    v_sub_f32 v123, v123, v14
    v_exp_f32 v123, v123
    v_sub_f32 v124, v124, v14
    v_exp_f32 v124, v124
    ds_write_b128 v8, v[144:147] offset:0
    v_sub_f32 v125, v125, v14
    v_exp_f32 v125, v125
    ds_write_b128 v8, v[148:151] offset:1024
    s_waitcnt vmcnt(6)
    v_mfma_f32_16x16x32_bf16 v[176:179], v[208:211], v[220:223], v[176:179]
    buffer_load_dwordx4 v[208:211], v6, s[8:11], s50 offen offset:2048 sc1
    v_sub_f32 v126, v126, v14
    v_exp_f32 v126, v126
    s_mov_b32 exec_hi, 0
    ds_write_b32 v252, v152 offset:768
    s_mov_b32 exec_hi, -1
    v_sub_f32 v127, v127, v14
    v_exp_f32 v127, v127
    v_mfma_f32_32x32x16_bf16 v[144:159], v[240:243], v[240:243], 0
    v_smfmac_f32_32x32x32_bf16 v[144:159], v[48:51], v[112:119], v13
    s_setprio 0
    v_sub_f32 v128, v128, v14
    v_exp_f32 v128, v128
    v_sub_f32 v129, v129, v14
    v_exp_f32 v129, v129
    v_smfmac_f32_32x32x32_bf16 v[144:159], v[52:55], v[120:127], v13
    v_sub_f32 v130, v130, v14
    v_exp_f32 v130, v130
    s_add_u32 s36, s56, 7168
    s_and_b32 s36, s36, 8191
    s_lshl_b32 s36, s36, 6
    s_add_u32 s36, s36, s57
    s_add_u32 s37, s36, 32768
    v_sub_f32 v131, v131, v14
    v_exp_f32 v131, v131
    buffer_load_dwordx4 v[48:51], v6, s[8:11], s36 offen offset:0 sc1
    v_sub_f32 v132, v132, v14
    v_exp_f32 v132, v132
    v_mfma_f32_32x32x16_bf16 v[112:127], v[24:27], v[164:167], 0
    v_sub_f32 v133, v133, v14
    v_exp_f32 v133, v133
    s_mov_b32 s20, s64
    s_mov_b32 s21, s65
    s_mov_b32 s22, 2097152
    s_mov_b32 s23, 0x00020000
    v_and_b32 v24, 7, v1
    v_lshlrev_b32 v24, 10, v24
    v_bfe_u32 v25, v1, 3, 1
    v_lshrrev_b32 v26, 4, v1
    v_lshl_add_u32 v25, v25, 2, v26
    v_lshl_add_u32 v24, v25, 4, v24
    v_lshlrev_b32 v25, 5, v25
    s_sub_u32 s38, s55, 1048576
    s_lshl_b32 s39, s5, 7
    s_add_u32 s38, s38, s39
    s_lshl_b32 s39, s5, 11
    s_add_u32 s39, s39, 147456
    v_add_u32 v26, s39, v25
    s_lshl_b32 s39, s5, 8
    s_add_u32 s39, s39, 116800
    v_add_u32 v27, s39, v6
    v_sub_f32 v134, v134, v14
    v_exp_f32 v134, v134
    buffer_load_dwordx4 v[16:19], v24, s[20:23], s38 offen
    v_sub_f32 v135, v135, v14
    v_exp_f32 v135, v135
    v_mfma_f32_16x16x32_bf16 v[180:183], v[212:215], v[220:223], v[180:183]
    buffer_load_dwordx4 v[212:215], v6, s[8:11], s50 offen offset:3072 sc1
    v_sub_f32 v136, v136, v14
    v_exp_f32 v136, v136
    v_sub_f32 v137, v137, v14
    v_exp_f32 v137, v137
    buffer_load_dwordx4 v[52:55], v6, s[8:11], s36 offen offset:1024 sc1
    v_sub_f32 v138, v138, v14
    v_exp_f32 v138, v138
    v_smfmac_f32_32x32x32_bf16 v[144:159], v[56:59], v[128:135], v13
    v_sub_f32 v139, v139, v14
    v_exp_f32 v139, v139
    v_sub_f32 v140, v140, v14
    v_exp_f32 v140, v140
    v_sub_f32 v141, v141, v14
    v_exp_f32 v141, v141
    v_sub_f32 v142, v142, v14
    v_exp_f32 v142, v142
    v_sub_f32 v143, v143, v14
    v_exp_f32 v143, v143
    s_waitcnt lgkmcnt(0)
    s_barrier
    s_setprio 3
    s_mov_b64 exec, s[94:95]
    ds_read_b128 v[216:219], v11 offset:1024
    ds_read_b128 v[220:223], v11 offset:1536
    s_mov_b64 exec, -1
    v_sub_f32 v112, v112, v14
    v_exp_f32 v112, v112
    s_bitcmp0_b32 s5, 2
    s_cbranch_scc1 CB_84
    ds_read2st64_b32 v[244:245], v253 offset0:3 offset1:7
    ds_read2st64_b32 v[246:247], v253 offset0:11 offset1:15
    ds_read2st64_b32 v[248:249], v253 offset0:19 offset1:23
    ds_read2st64_b32 v[250:251], v253 offset0:27 offset1:31
    ds_read2st64_b64 v[224:227], v9 offset0:0 offset1:4
    ds_read2st64_b64 v[228:231], v9 offset0:8 offset1:12
    ds_read2st64_b64 v[232:235], v9 offset0:16 offset1:20
    ds_read2st64_b64 v[236:239], v9 offset0:24 offset1:28
CB_84:
    v_sub_f32 v113, v113, v14
    v_exp_f32 v113, v113
    v_smfmac_f32_32x32x32_bf16 v[144:159], v[60:63], v[136:143], v13
    v_sub_f32 v114, v114, v14
    v_exp_f32 v114, v114
    v_sub_f32 v115, v115, v14
    v_exp_f32 v115, v115
    v_sub_f32 v116, v116, v14
    v_exp_f32 v116, v116
    v_mfma_f32_32x32x16_bf16 v[128:143], v[28:31], v[164:167], 0
    v_sub_f32 v117, v117, v14
    v_exp_f32 v117, v117
    s_add_u32 s38, s38, 4194304
    v_sub_f32 v118, v118, v14
    v_exp_f32 v118, v118
    v_sub_f32 v119, v119, v14
    v_exp_f32 v119, v119
    v_sub_f32 v120, v120, v14
    v_exp_f32 v120, v120
    v_sub_f32 v121, v121, v14
    v_exp_f32 v121, v121
    s_bitcmp0_b32 s5, 2
    s_cbranch_scc1 CB_85
    s_waitcnt lgkmcnt(4)
    v_pk_add_f32 v[244:245], v[244:245], v[246:247]
    v_pk_add_f32 v[248:249], v[248:249], v[250:251]
    v_pk_add_f32 v[244:245], v[244:245], v[248:249]
    v_add_f32 v245, v244, v245
    v_rcp_f32 v244, v245
    s_waitcnt lgkmcnt(0)
    v_pk_add_f32 v[224:225], v[224:225], v[226:227]
    v_pk_add_f32 v[228:229], v[228:229], v[230:231]
    v_pk_add_f32 v[232:233], v[232:233], v[234:235]
    v_pk_add_f32 v[236:237], v[236:237], v[238:239]
    v_pk_add_f32 v[224:225], v[224:225], v[228:229]
    v_pk_add_f32 v[232:233], v[232:233], v[236:237]
    v_pk_add_f32 v[224:225], v[224:225], v[232:233]
    v_mul_f32 v224, v224, v244
    v_mul_f32 v225, v225, v244
    v_cvt_pk_bf16_f32 v226, v224, v225
    ds_write_b32 v10, v226 offset:0
CB_85:
    v_sub_f32 v122, v122, v14
    v_exp_f32 v122, v122
    v_smfmac_f32_32x32x32_bf16 v[144:159], v[64:67], v[112:119], v13
    v_sub_f32 v123, v123, v14
    v_exp_f32 v123, v123
    s_add_u32 s49, s56, 6144
    s_and_b32 s49, s49, 8191
    s_lshl_b32 s49, s49, 6
    s_add_u32 s49, s49, s57
    s_add_u32 s50, s49, 32768
    v_sub_f32 v124, v124, v14
    v_exp_f32 v124, v124
    v_sub_f32 v125, v125, v14
    v_exp_f32 v125, v125
    s_waitcnt lgkmcnt(0)
    s_waitcnt vmcnt(10)
    v_mfma_f32_16x16x32_bf16 v[168:171], v[184:187], v[216:219], v[168:171]
    buffer_load_dwordx4 v[184:187], v6, s[8:11], s49 offen offset:0 sc1
    v_sub_f32 v126, v126, v14
    v_exp_f32 v126, v126
    v_sub_f32 v127, v127, v14
    v_exp_f32 v127, v127
    v_sub_f32 v128, v128, v14
    v_exp_f32 v128, v128
    v_sub_f32 v129, v129, v14
    v_exp_f32 v129, v129
    v_smfmac_f32_32x32x32_bf16 v[144:159], v[68:71], v[120:127], v13
    v_sub_f32 v130, v130, v14
    v_exp_f32 v130, v130
    v_sub_f32 v131, v131, v14
    v_exp_f32 v131, v131
    v_sub_f32 v132, v132, v14
    v_exp_f32 v132, v132
    v_mfma_f32_32x32x16_bf16 v[112:127], v[32:35], v[164:167], 0
    v_sub_f32 v133, v133, v14
    v_exp_f32 v133, v133
    v_sub_f32 v134, v134, v14
    v_exp_f32 v134, v134
    v_sub_f32 v135, v135, v14
    v_exp_f32 v135, v135
    s_waitcnt vmcnt(10)
    v_mfma_f32_16x16x32_bf16 v[172:175], v[188:191], v[216:219], v[172:175]
    buffer_load_dwordx4 v[188:191], v6, s[8:11], s49 offen offset:1024 sc1
    v_sub_f32 v136, v136, v14
    v_exp_f32 v136, v136
    v_sub_f32 v137, v137, v14
    v_exp_f32 v137, v137
    v_sub_f32 v138, v138, v14
    v_exp_f32 v138, v138
    v_smfmac_f32_32x32x32_bf16 v[144:159], v[72:75], v[128:135], v13
    v_sub_f32 v139, v139, v14
    v_exp_f32 v139, v139
    v_sub_f32 v140, v140, v14
    v_exp_f32 v140, v140
    v_sub_f32 v141, v141, v14
    v_exp_f32 v141, v141
    s_waitcnt vmcnt(10)
    v_mfma_f32_16x16x32_bf16 v[176:179], v[192:195], v[216:219], v[176:179]
    buffer_load_dwordx4 v[192:195], v6, s[8:11], s49 offen offset:2048 sc1
    v_sub_f32 v142, v142, v14
    v_exp_f32 v142, v142
    v_sub_f32 v143, v143, v14
    v_exp_f32 v143, v143
    v_sub_f32 v112, v112, v14
    v_exp_f32 v112, v112
    v_sub_f32 v113, v113, v14
    v_exp_f32 v113, v113
    v_smfmac_f32_32x32x32_bf16 v[144:159], v[76:79], v[136:143], v13
    v_sub_f32 v114, v114, v14
    v_exp_f32 v114, v114
    v_sub_f32 v115, v115, v14
    v_exp_f32 v115, v115
    v_sub_f32 v116, v116, v14
    v_exp_f32 v116, v116
    v_mfma_f32_32x32x16_bf16 v[128:143], v[36:39], v[164:167], 0
    v_sub_f32 v117, v117, v14
    v_exp_f32 v117, v117
    v_sub_f32 v118, v118, v14
    v_exp_f32 v118, v118
    v_sub_f32 v119, v119, v14
    v_exp_f32 v119, v119
    s_waitcnt vmcnt(10)
    v_mfma_f32_16x16x32_bf16 v[180:183], v[196:199], v[216:219], v[180:183]
    buffer_load_dwordx4 v[196:199], v6, s[8:11], s49 offen offset:3072 sc1
    v_sub_f32 v120, v120, v14
    v_exp_f32 v120, v120
    v_sub_f32 v121, v121, v14
    v_exp_f32 v121, v121
    v_sub_f32 v122, v122, v14
    v_exp_f32 v122, v122
    v_smfmac_f32_32x32x32_bf16 v[144:159], v[80:83], v[112:119], v13
    v_sub_f32 v123, v123, v14
    v_exp_f32 v123, v123
    v_sub_f32 v124, v124, v14
    v_exp_f32 v124, v124
    v_sub_f32 v125, v125, v14
    v_exp_f32 v125, v125
    s_waitcnt vmcnt(10)
    v_mfma_f32_16x16x32_bf16 v[168:171], v[200:203], v[220:223], v[168:171]
    buffer_load_dwordx4 v[200:203], v6, s[8:11], s50 offen offset:0 sc1
    v_sub_f32 v126, v126, v14
    v_exp_f32 v126, v126
    v_sub_f32 v127, v127, v14
    v_exp_f32 v127, v127
    s_setprio 2
    v_sub_f32 v128, v128, v14
    v_exp_f32 v128, v128
    v_sub_f32 v129, v129, v14
    v_exp_f32 v129, v129
    v_smfmac_f32_32x32x32_bf16 v[144:159], v[84:87], v[120:127], v13
    v_sub_f32 v130, v130, v14
    v_exp_f32 v130, v130
    v_sub_f32 v131, v131, v14
    v_exp_f32 v131, v131
    buffer_load_dwordx4 v[56:59], v6, s[8:11], s36 offen offset:2048 sc1
    v_sub_f32 v132, v132, v14
    v_exp_f32 v132, v132
    v_mfma_f32_32x32x16_bf16 v[112:127], v[40:43], v[164:167], 0
    v_sub_f32 v133, v133, v14
    v_exp_f32 v133, v133
    s_mov_b32 exec_lo, 0
    s_mov_b32 exec_hi, 0xffff0000
    ds_write_b128 v27, v[2:5]
    s_mov_b64 exec, -1
    v_sub_f32 v134, v134, v14
    v_exp_f32 v134, v134
    v_sub_f32 v135, v135, v14
    v_exp_f32 v135, v135
    s_waitcnt vmcnt(11)
    v_mfma_f32_16x16x32_bf16 v[172:175], v[204:207], v[220:223], v[172:175]
    buffer_load_dwordx4 v[204:207], v6, s[8:11], s50 offen offset:1024 sc1
    v_sub_f32 v136, v136, v14
    v_exp_f32 v136, v136
    v_sub_f32 v137, v137, v14
    v_exp_f32 v137, v137
    v_sub_f32 v138, v138, v14
    v_exp_f32 v138, v138
    v_smfmac_f32_32x32x32_bf16 v[144:159], v[88:91], v[128:135], v13
    v_sub_f32 v139, v139, v14
    v_exp_f32 v139, v139
    v_sub_f32 v140, v140, v14
    v_exp_f32 v140, v140
    v_sub_f32 v141, v141, v14
    v_exp_f32 v141, v141
    s_waitcnt vmcnt(11)
    v_mfma_f32_16x16x32_bf16 v[176:179], v[208:211], v[220:223], v[176:179]
    buffer_load_dwordx4 v[208:211], v6, s[8:11], s50 offen offset:2048 sc1
    v_sub_f32 v142, v142, v14
    v_exp_f32 v142, v142
    v_sub_f32 v143, v143, v14
    v_exp_f32 v143, v143
    s_setprio 1
    v_sub_f32 v112, v112, v14
    v_exp_f32 v112, v112
    v_sub_f32 v113, v113, v14
    v_exp_f32 v113, v113
    v_smfmac_f32_32x32x32_bf16 v[144:159], v[92:95], v[136:143], v13
    v_sub_f32 v114, v114, v14
    v_exp_f32 v114, v114
    ds_write_b128 v8, v[2:5] offset:16384
    v_sub_f32 v115, v115, v14
    v_exp_f32 v115, v115
    buffer_load_dwordx4 v[60:63], v6, s[8:11], s36 offen offset:3072 sc1
    v_sub_f32 v116, v116, v14
    v_exp_f32 v116, v116
    v_mfma_f32_32x32x16_bf16 v[128:143], v[44:47], v[164:167], 0
    ds_read_b128 v[80:83], v26 offset:0
    v_sub_f32 v117, v117, v14
    v_exp_f32 v117, v117
    v_sub_f32 v118, v118, v14
    v_exp_f32 v118, v118
    ds_read_b128 v[84:87], v26 offset:16
    v_sub_f32 v119, v119, v14
    v_exp_f32 v119, v119
    s_waitcnt vmcnt(10)
    v_mfma_f32_16x16x32_bf16 v[180:183], v[212:215], v[220:223], v[180:183]
    buffer_load_dwordx4 v[212:215], v6, s[8:11], s50 offen offset:3072 sc1
    v_sub_f32 v120, v120, v14
    v_exp_f32 v120, v120
    ds_read_b128 v[88:91], v26 offset:256
    v_sub_f32 v121, v121, v14
    v_exp_f32 v121, v121
    buffer_load_dwordx4 v[64:67], v6, s[8:11], s37 offen offset:0 sc1
    v_sub_f32 v122, v122, v14
    v_exp_f32 v122, v122
    v_smfmac_f32_32x32x32_bf16 v[144:159], v[96:99], v[112:119], v13
    ds_read_b128 v[92:95], v26 offset:272
    v_sub_f32 v123, v123, v14
    v_exp_f32 v123, v123
    v_sub_f32 v124, v124, v14
    v_exp_f32 v124, v124
    v_sub_f32 v125, v125, v14
    v_exp_f32 v125, v125
    v_sub_f32 v126, v126, v14
    v_exp_f32 v126, v126
    v_sub_f32 v127, v127, v14
    v_exp_f32 v127, v127
    s_setprio 0
    v_sub_f32 v128, v128, v14
    v_exp_f32 v128, v128
    v_sub_f32 v129, v129, v14
    v_exp_f32 v129, v129
    v_smfmac_f32_32x32x32_bf16 v[144:159], v[100:103], v[120:127], v13
    v_sub_f32 v130, v130, v14
    v_exp_f32 v130, v130
    v_sub_f32 v131, v131, v14
    v_exp_f32 v131, v131
    buffer_load_dwordx4 v[68:71], v6, s[8:11], s37 offen offset:1024 sc1
    v_sub_f32 v132, v132, v14
    v_exp_f32 v132, v132
    ds_read_b128 v[96:99], v26 offset:512
    v_sub_f32 v133, v133, v14
    v_exp_f32 v133, v133
    v_sub_f32 v134, v134, v14
    v_exp_f32 v134, v134
    ds_read_b128 v[100:103], v26 offset:528
    v_sub_f32 v135, v135, v14
    v_exp_f32 v135, v135
    v_sub_f32 v136, v136, v14
    v_exp_f32 v136, v136
    v_sub_f32 v137, v137, v14
    v_exp_f32 v137, v137
    buffer_load_dwordx4 v[72:75], v6, s[8:11], s37 offen offset:2048 sc1
    v_sub_f32 v138, v138, v14
    v_exp_f32 v138, v138
    v_smfmac_f32_32x32x32_bf16 v[144:159], v[104:107], v[128:135], v13
    v_sub_f32 v139, v139, v14
    v_exp_f32 v139, v139
    v_sub_f32 v140, v140, v14
    v_exp_f32 v140, v140
    v_sub_f32 v141, v141, v14
    v_exp_f32 v141, v141
    v_sub_f32 v142, v142, v14
    v_exp_f32 v142, v142
    v_sub_f32 v143, v143, v14
    v_exp_f32 v143, v143
    s_nop 1
    s_branch P2_TAIL
MC_83:
    s_mov_b32 s61, 200000
MC_83_L:
    buffer_load_dwordx4 v[2:5], v15, s[8:11], s39 offen sc1
    s_waitcnt vmcnt(0)
    v_perm_b32 v244, v3, v2, s58
    v_perm_b32 v245, v5, v4, s59
    v_or_b32 v244, v244, v245
    v_cmp_ne_u32 vcc, s6, v244
    s_nop 4
    s_cbranch_vccz MC_83_R
    s_sub_u32 s61, s61, 1
    s_cbranch_scc0 MC_83_L
    s_branch MC_83_R
.section .rodata,"a"
.p2align 6
.amdhsa_kernel adaLN_cond__grouped_kv_mqa__glu_gated_glu__prompt_kernel
  .amdhsa_next_free_vgpr 256
  .amdhsa_next_free_sgpr 102
  .amdhsa_accum_offset 256
  .amdhsa_group_segment_fixed_size 0
  .amdhsa_kernarg_size 112
  .amdhsa_user_sgpr_count 2
  .amdhsa_user_sgpr_kernarg_segment_ptr 1
  .amdhsa_system_sgpr_workgroup_id_x 1
.end_amdhsa_kernel
```
